```python
import torch

def _softmax(x, axis=-1):
    return torch.softmax(x, dim=axis)
def _gelu(x):
    return torch.nn.functional.gelu(x, approximate="tanh")
def _silu(x):
    return torch.nn.functional.silu(x)
def _sigmoid(x):
    return torch.sigmoid(x)
def _layernorm(x, axis=-1, eps=1e-5):
    m = x.mean(dim=axis, keepdim=True)
    v = x.var(dim=axis, keepdim=True, unbiased=False)
    return (x - m) / torch.sqrt(v + eps)
def _scatter_add(tgt, idx, src, axis=0):
    return tgt.clone().index_add_(axis, idx, src)
def _segment_sum(src, seg, n):
    out = torch.zeros((n,) + src.shape[1:], dtype=src.dtype)
    return out.index_add_(0, seg, src)
def _pad(x, pw):
    flat = tuple(v for pair in reversed(pw) for v in pair)
    return torch.nn.functional.pad(x, flat)

kernel_name = 'concat_heads__grouped_kv_mqa__grouped_kv_mqa__prompt'

def setup_inputs():

    _w = (lambda a: (lambda t: t.to(torch.bfloat16) if t.is_floating_point() else t)(torch.as_tensor(a)))
    def _A_setup():
        B, S, D, H = 1, 2048, 1024, 32
        Dh = D // H
        return {
            "x": _w((lambda *s: torch.randn(*s, dtype=torch.bfloat16) * 0.05)(B, S, D)),
            "wq": _w((lambda *s: torch.randn(*s, dtype=torch.bfloat16) * 0.8)(D, H * Dh)),
            "wk": _w((lambda *s: torch.randn(*s, dtype=torch.bfloat16) * 0.8)(D, Dh)),
            "wv": _w((lambda *s: torch.randn(*s, dtype=torch.bfloat16) * 0.05)(D, Dh)),
            "wo": _w((lambda *s: torch.randn(*s, dtype=torch.bfloat16) * 0.05)(H * Dh, D)),
        }
    _A_in = _A_setup()

    def _B_setup():
        B, S, D, H = 1, 2048, 1024, 32
        Dh = D // H
        return {
            "x": _w((lambda *s: torch.randn(*s, dtype=torch.bfloat16) * 0.05)(B, S, D)),
            "wq": _w((lambda *s: torch.randn(*s, dtype=torch.bfloat16) * 0.8)(D, H * Dh)),
            "wk": _w((lambda *s: torch.randn(*s, dtype=torch.bfloat16) * 0.8)(D, Dh)),
            "wv": _w((lambda *s: torch.randn(*s, dtype=torch.bfloat16) * 0.05)(D, Dh)),
            "wo": _w((lambda *s: torch.randn(*s, dtype=torch.bfloat16) * 0.05)(H * Dh, D)),
        }
    _B_in = _B_setup()

    return {
        "A_x": _A_in["x"],
        "A_wq": _A_in["wq"],
        "A_wk": _A_in["wk"],
        "A_wv": _A_in["wv"],
        "A_wo": _A_in["wo"],
        "B_x": _B_in["x"],
        "B_wq": _B_in["wq"],
        "B_wk": _B_in["wk"],
        "B_wv": _B_in["wv"],
        "B_wo": _B_in["wo"],
    }

def reference(A_x, A_wq, A_wk, A_wv, A_wo, B_x, B_wq, B_wk, B_wv, B_wo):
    def _A_ref(x, wq, wk, wv, wo):
        B, S, D = x.shape
        H = 32
        Dh = D // H
        q = (lambda x, *d: x.permute(*d))((x @ wq).reshape(B, S, H, Dh), 0, 2, 1, 3)
        k = x @ wk
        v = x @ wv
        scores = torch.einsum("bhqd,bkd->bhqk", q, k) * (Dh ** -0.5)
        p = _softmax(scores, axis=-1)
        o = torch.einsum("bhqk,bkd->bhqd", p, v)
        return (lambda x, *d: x.permute(*d))(o, 0, 2, 1, 3).reshape(B, S, H * Dh) @ wo

    def _B_ref(x, wq, wk, wv, wo):
        B, S, D = x.shape
        H = 32
        Dh = D // H
        q = (lambda x, *d: x.permute(*d))((x @ wq).reshape(B, S, H, Dh), 0, 2, 1, 3)
        k = x @ wk
        v = x @ wv
        scores = torch.einsum("bhqd,bkd->bhqk", q, k) * (Dh ** -0.5)
        p = _softmax(scores, axis=-1)
        o = torch.einsum("bhqk,bkd->bhqd", p, v)
        return (lambda x, *d: x.permute(*d))(o, 0, 2, 1, 3).reshape(B, S, H * Dh) @ wo

    a = _A_ref(A_x, A_wq, A_wk, A_wv, A_wo)
    b = _B_ref(B_x, B_wq, B_wk, B_wv, B_wo)
    return torch.concatenate([a, b], axis=-1)
```

```asm
; @launch grid=(256,1,1) block=(512,1,1) lds=163840
.amdgcn_target "amdgcn-amd-amdhsa--gfx950"
.text
  .globl concat_heads__grouped_kv_mqa__grouped_kv_mqa__prompt_kernel
.p2align 8
.type concat_heads__grouped_kv_mqa__grouped_kv_mqa__prompt_kernel,@function
concat_heads__grouped_kv_mqa__grouped_kv_mqa__prompt_kernel:
  s_cmp_ge_u32 s2, 256
  s_cbranch_scc1 L_end
  s_load_dwordx16 s[36:51], s[0:1], 0
  s_load_dwordx8 s[52:59], s[0:1], 64
  s_load_dwordx2 s[60:61], s[0:1], 96
  s_and_b32 s30, s2, 7
  s_lshr_b32 s31, s2, 3
  s_lshr_b32 s27, s30, 2
  s_and_b32 s30, s30, 3
  s_lshl_b32 s30, s30, 2
  s_lshr_b32 s28, s31, 3
  s_add_u32 s28, s28, s30
  s_and_b32 s29, s31, 7
  v_lshrrev_b32 v26, 6, v0
  v_and_b32 v0, 63, v0
  s_nop 0
  v_readfirstlane_b32 s83, v26
  s_nop 3
  s_and_b32 s26, s83, 3
  s_and_b32 s73, s26, 1
  s_lshr_b32 s72, s26, 1
  s_and_b32 s82, s29, 1
  s_lshl_b32 s66, s26, 12
  s_cmp_ge_u32 s83, 4
  s_cbranch_scc1 L_loader
  v_lshrrev_b32 v28, 4, v0
  v_and_b32 v29, 15, v0
  v_lshrrev_b32 v30, 1, v29
  v_lshlrev_b32 v31, 7, v29
  s_lshl_b32 s30, s72, 13
  s_lshl_b32 s31, s72, 11
  v_add_u32 v27, 0, v28
  v_xor_b32 v27, v27, v30
  v_lshlrev_b32 v27, 4, v27
  v_add_u32 v27, v27, v31
  v_add_u32 v2, s30, v27
  v_add_u32 v4, 0x10000, v2
  v_add_u32 v6, 0x20000, v2
  v_add_u32 v20, s31, v27
  v_add_u32 v27, 4, v28
  v_xor_b32 v27, v27, v30
  v_lshlrev_b32 v27, 4, v27
  v_add_u32 v27, v27, v31
  v_add_u32 v3, s30, v27
  v_add_u32 v5, 0x10000, v3
  v_add_u32 v7, 0x20000, v3
  v_add_u32 v21, s31, v27
  v_lshrrev_b32 v30, 2, v29
  v_and_b32 v27, 1, v28
  v_lshlrev_b32 v31, 2, v27
  v_or_b32 v31, v31, v30
  v_lshlrev_b32 v26, 3, v28
  v_add_u32 v26, v26, v30
  v_and_b32 v29, 3, v29
  v_lshlrev_b32 v29, 3, v29
  s_lshl_b32 s30, s73, 2
  v_xor_b32 v27, s73, v27
  v_lshlrev_b32 v27, 5, v27
  v_lshlrev_b32 v30, 6, v26
  v_add3_u32 v22, v27, v30, v29
  v_add_u32 v22, 16384, v22
  v_lshlrev_b32 v26, 8, v26
  v_add_u32 v26, v26, v29
  v_add_u32 v26, 16384, v26
  s_add_u32 s31, s30, 0
  v_xor_b32 v30, s31, v31
  v_lshlrev_b32 v30, 5, v30
  v_add_u32 v8, v30, v26
  v_add_u32 v12, 0x10000, v8
  v_add_u32 v16, 0x20000, v8
  s_add_u32 s31, s30, 1
  v_xor_b32 v30, s31, v31
  v_lshlrev_b32 v30, 5, v30
  v_add_u32 v9, v30, v26
  v_add_u32 v13, 0x10000, v9
  v_add_u32 v17, 0x20000, v9
  s_add_u32 s31, s30, 2
  v_xor_b32 v30, s31, v31
  v_lshlrev_b32 v30, 5, v30
  v_add_u32 v10, v30, v26
  v_add_u32 v14, 0x10000, v10
  v_add_u32 v18, 0x20000, v10
  s_add_u32 s31, s30, 3
  v_xor_b32 v30, s31, v31
  v_lshlrev_b32 v30, 5, v30
  v_add_u32 v11, v30, v26
  v_add_u32 v15, 0x10000, v11
  v_add_u32 v19, 0x20000, v11
  s_cmp_ge_u32 s2, 16
  s_cbranch_scc1 L_pf_done
  s_getpc_b64 s[32:33]
L_pc_anchor:
  s_sub_u32 s32, s32, L_pc_anchor-concat_heads__grouped_kv_mqa__grouped_kv_mqa__prompt_kernel
  s_subb_u32 s33, s33, 0
  v_lshlrev_b32 v29, 7, v0
  s_lshl_b32 s30, s26, 13
  v_add_u32 v29, s30, v29
  v_cmp_gt_u32 vcc, L_code_end-concat_heads__grouped_kv_mqa__grouped_kv_mqa__prompt_kernel, v29
  s_and_saveexec_b64 s[76:77], vcc
  s_cbranch_execz L_pf_skip0
  global_load_dword v23, v29, s[32:33]
L_pf_skip0:
  s_mov_b64 exec, s[76:77]
  v_add_u32 v29, 0x8000, v29
  v_cmp_gt_u32 vcc, L_code_end-concat_heads__grouped_kv_mqa__grouped_kv_mqa__prompt_kernel, v29
  s_and_saveexec_b64 s[76:77], vcc
  s_cbranch_execz L_pf_skip1
  global_load_dword v23, v29, s[32:33]
L_pf_skip1:
  s_mov_b64 exec, s[76:77]
L_pf_done:
  v_mov_b32 v160, 0
  v_mov_b32 v161, 0
  v_mov_b32 v162, 0
  v_mov_b32 v163, 0
  v_mov_b32 v32, 0
  v_mov_b32 v33, 0
  v_mov_b32 v34, 0
  v_mov_b32 v35, 0
  v_mov_b32 v36, 0
  v_mov_b32 v37, 0
  v_mov_b32 v38, 0
  v_mov_b32 v39, 0
  v_mov_b32 v40, 0
  v_mov_b32 v41, 0
  v_mov_b32 v42, 0
  v_mov_b32 v43, 0
  v_mov_b32 v44, 0
  v_mov_b32 v45, 0
  v_mov_b32 v46, 0
  v_mov_b32 v47, 0
  v_mov_b32 v48, 0
  v_mov_b32 v49, 0
  v_mov_b32 v50, 0
  v_mov_b32 v51, 0
  v_mov_b32 v52, 0
  v_mov_b32 v53, 0
  v_mov_b32 v54, 0
  v_mov_b32 v55, 0
  v_mov_b32 v56, 0
  v_mov_b32 v57, 0
  v_mov_b32 v58, 0
  v_mov_b32 v59, 0
  v_mov_b32 v60, 0
  v_mov_b32 v61, 0
  v_mov_b32 v62, 0
  v_mov_b32 v63, 0
  v_mov_b32 v64, 0
  v_mov_b32 v65, 0
  v_mov_b32 v66, 0
  v_mov_b32 v67, 0
  v_mov_b32 v68, 0
  v_mov_b32 v69, 0
  v_mov_b32 v70, 0
  v_mov_b32 v71, 0
  v_mov_b32 v72, 0
  v_mov_b32 v73, 0
  v_mov_b32 v74, 0
  v_mov_b32 v75, 0
  v_mov_b32 v76, 0
  v_mov_b32 v77, 0
  v_mov_b32 v78, 0
  v_mov_b32 v79, 0
  v_mov_b32 v80, 0
  v_mov_b32 v81, 0
  v_mov_b32 v82, 0
  v_mov_b32 v83, 0
  v_mov_b32 v84, 0
  v_mov_b32 v85, 0
  v_mov_b32 v86, 0
  v_mov_b32 v87, 0
  v_mov_b32 v88, 0
  v_mov_b32 v89, 0
  v_mov_b32 v90, 0
  v_mov_b32 v91, 0
  v_mov_b32 v92, 0
  v_mov_b32 v93, 0
  v_mov_b32 v94, 0
  v_mov_b32 v95, 0
  v_lshlrev_b32 v254, 4, v0
  v_and_b32 v29, 15, v0
  v_mov_b32 v30, 0x3f803f80
  v_cmp_gt_u32 vcc, 2, v29
  v_lshrrev_b32 v31, 1, v29
  s_nop 0
  v_cndmask_b32 v240, 0, v30, vcc
  v_cndmask_b32 v241, 0, v30, vcc
  v_cmp_eq_u32 vcc, 1, v31
  v_and_b32 v31, 1, v29
  s_nop 0
  v_cndmask_b32 v242, 0, v30, vcc
  v_cndmask_b32 v243, 0, v30, vcc
  v_cmp_eq_u32 vcc, 1, v31
  v_mov_b32 v30, 0x4444
  v_mov_b32 v31, 0xeeee
  v_cndmask_b32 v244, v30, v31, vcc
  v_lshlrev_b32 v29, 4, v29
  v_lshrrev_b32 v30, 5, v0
  v_lshlrev_b32 v30, 8, v30
  v_add_u32 v29, v29, v30
  v_bfe_u32 v30, v0, 4, 1
  v_lshlrev_b32 v31, 15, v30
  v_add_u32 v251, v29, v31
  v_lshlrev_b32 v31, 11, v30
  v_add_u32 v252, v29, v31
  s_lshl_b32 s30, s73, 14
  s_lshl_b32 s31, s72, 13
  s_add_u32 s30, s30, s31
  s_add_u32 s30, s30, 0x20000
  v_add_u32 v252, s30, v252
  v_add_u32 v245, s31, v254
  v_add_u32 v246, 0x20000, v245
  v_and_b32 v29, 15, v0
  v_lshrrev_b32 v30, 2, v29
  v_and_b32 v31, 1, v28
  v_lshlrev_b32 v31, 2, v31
  v_add_u32 v31, v31, v30
  v_lshrrev_b32 v26, 1, v28
  v_lshlrev_b32 v26, 4, v26
  v_add_u32 v26, v26, v31
  v_lshlrev_b32 v26, 8, v26
  v_and_b32 v29, 3, v29
  v_lshlrev_b32 v29, 3, v29
  v_add_u32 v26, v26, v29
  v_add_u32 v26, 0x10000, v26
  s_lshl_b32 s30, s73, 2
  s_add_u32 s31, s30, 0
  v_xor_b32 v30, s31, v31
  v_lshlrev_b32 v30, 5, v30
  v_add_u32 v247, v30, v26
  s_add_u32 s31, s30, 1
  v_xor_b32 v30, s31, v31
  v_lshlrev_b32 v30, 5, v30
  v_add_u32 v248, v30, v26
  s_add_u32 s31, s30, 2
  v_xor_b32 v30, s31, v31
  v_lshlrev_b32 v30, 5, v30
  v_add_u32 v249, v30, v26
  s_add_u32 s31, s30, 3
  v_xor_b32 v30, s31, v31
  v_lshlrev_b32 v30, 5, v30
  v_add_u32 v250, v30, v26
  v_and_b32 v29, 15, v0
  v_and_b32 v30, 1, v28
  v_lshlrev_b32 v30, 1, v30
  v_lshrrev_b32 v31, 1, v28
  v_add_u32 v30, v30, v31
  v_and_b32 v31, 7, v29
  v_lshlrev_b32 v29, 7, v29
  s_lshl_b32 s30, s26, 13
  v_add_u32 v29, s30, v29
  v_add_u32 v26, 0, v30
  v_xor_b32 v26, v26, v31
  v_lshlrev_b32 v26, 4, v26
  v_add_u32 v24, v26, v29
  v_add_u32 v26, 4, v30
  v_xor_b32 v26, v26, v31
  v_lshlrev_b32 v26, 4, v26
  v_add_u32 v25, v26, v29
  v_lshrrev_b32 v29, 3, v0
  v_and_b32 v30, 7, v0
  v_lshlrev_b32 v31, 12, v29
  v_lshlrev_b32 v26, 4, v30
  v_add_u32 v253, v31, v26
  v_xor_b32 v30, v30, v29
  v_lshlrev_b32 v30, 4, v30
  v_lshlrev_b32 v29, 7, v29
  v_add3_u32 v255, v29, v30, s30
  s_lshl_b32 s30, s28, 3
  s_lshl_b32 s31, s72, 2
  s_add_u32 s30, s30, s31
  s_lshl_b32 s30, s30, 5
  s_lshl_b32 s31, s29, 2
  s_add_u32 s30, s30, s31
  s_lshl_b32 s31, s73, 1
  s_add_u32 s30, s30, s31
  s_lshl_b32 s62, s30, 10
  s_lshl_b32 s30, s28, 19
  s_lshl_b32 s31, s72, 18
  s_add_u32 s30, s30, s31
  s_lshl_b32 s31, s27, 11
  s_add_u32 s30, s30, s31
  s_lshl_b32 s31, s29, 8
  s_add_u32 s30, s30, s31
  s_lshl_b32 s31, s73, 7
  s_add_u32 s63, s30, s31
  s_waitcnt lgkmcnt(0)
  s_lshl_b32 s30, s27, 18
  s_add_u32 s16, s60, s30
  s_addc_u32 s17, s61, 0
  s_and_b32 s17, s17, 0xffff
  s_mov_b32 s18, 262144
  s_mov_b32 s19, 0x00020000
  s_lshl_b32 s30, s27, 22
  s_add_u32 s30, s30, 1048576
  s_add_u32 s20, s60, s30
  s_addc_u32 s21, s61, 0
  s_and_b32 s21, s21, 0xffff
  s_mov_b32 s22, 4194304
  s_mov_b32 s23, 0x00020000
  s_lshl_b32 s30, s27, 7
  s_add_u32 s24, s58, s30
  s_addc_u32 s25, s59, 0
  s_mov_b32 s4, s56
  s_mov_b32 s5, s57
  s_and_b32 s5, s5, 0xffff
  s_mov_b32 s6, 8388608
  s_mov_b32 s7, 0x00020000
  s_barrier
  v_add_u32 v27, 0, v20
  v_add_u32 v28, 0, v21
  v_add_u32 v29, 0, v22
  ds_read_b128 v[164:167], v27 offset:0
  ds_read_b64_tr_b16 v[196:197], v29 offset:0
  ds_read_b64_tr_b16 v[198:199], v29 offset:256
  ds_read_b128 v[168:171], v28 offset:0
  ds_read_b64_tr_b16 v[200:201], v29 offset:2048
  ds_read_b64_tr_b16 v[202:203], v29 offset:2304
  ds_read_b128 v[172:175], v27 offset:4096
  ds_read_b64_tr_b16 v[204:205], v29 offset:4096
  ds_read_b64_tr_b16 v[206:207], v29 offset:4352
  ds_read_b128 v[176:179], v28 offset:4096
  ds_read_b64_tr_b16 v[208:209], v29 offset:6144
  ds_read_b64_tr_b16 v[210:211], v29 offset:6400
  ds_read_b128 v[180:183], v27 offset:8192
  ds_read_b64_tr_b16 v[212:213], v29 offset:8192
  ds_read_b64_tr_b16 v[214:215], v29 offset:8448
  ds_read_b128 v[184:187], v28 offset:8192
  ds_read_b64_tr_b16 v[216:217], v29 offset:10240
  ds_read_b64_tr_b16 v[218:219], v29 offset:10496
  ds_read_b128 v[188:191], v27 offset:12288
  ds_read_b64_tr_b16 v[220:221], v29 offset:12288
  ds_read_b64_tr_b16 v[222:223], v29 offset:12544
  ds_read_b128 v[192:195], v28 offset:12288
  ds_read_b64_tr_b16 v[224:225], v29 offset:14336
  ds_read_b64_tr_b16 v[226:227], v29 offset:14592
  s_cmp_lg_u32 s82, 0
  s_cbranch_scc1 L_kv_v0
  s_waitcnt lgkmcnt(12)
  v_mfma_f32_16x16x32_bf16 v[160:163], v[196:199], v[164:167], v[160:163]
  v_mfma_f32_16x16x32_bf16 v[160:163], v[200:203], v[168:171], v[160:163]
  v_mfma_f32_16x16x32_bf16 v[160:163], v[204:207], v[172:175], v[160:163]
  v_mfma_f32_16x16x32_bf16 v[160:163], v[208:211], v[176:179], v[160:163]
  s_waitcnt lgkmcnt(0)
  v_mfma_f32_16x16x32_bf16 v[160:163], v[212:215], v[180:183], v[160:163]
  v_mfma_f32_16x16x32_bf16 v[160:163], v[216:219], v[184:187], v[160:163]
  v_mfma_f32_16x16x32_bf16 v[160:163], v[220:223], v[188:191], v[160:163]
  v_mfma_f32_16x16x32_bf16 v[160:163], v[224:227], v[192:195], v[160:163]
  s_branch L_kv_e0
L_kv_v0:
  s_waitcnt lgkmcnt(12)
  v_mfma_f32_16x16x32_bf16 v[160:163], v[164:167], v[196:199], v[160:163]
  v_mfma_f32_16x16x32_bf16 v[160:163], v[168:171], v[200:203], v[160:163]
  v_mfma_f32_16x16x32_bf16 v[160:163], v[172:175], v[204:207], v[160:163]
  v_mfma_f32_16x16x32_bf16 v[160:163], v[176:179], v[208:211], v[160:163]
  s_waitcnt lgkmcnt(0)
  v_mfma_f32_16x16x32_bf16 v[160:163], v[180:183], v[212:215], v[160:163]
  v_mfma_f32_16x16x32_bf16 v[160:163], v[184:187], v[216:219], v[160:163]
  v_mfma_f32_16x16x32_bf16 v[160:163], v[188:191], v[220:223], v[160:163]
  v_mfma_f32_16x16x32_bf16 v[160:163], v[192:195], v[224:227], v[160:163]
L_kv_e0:
  s_waitcnt lgkmcnt(0)
  s_barrier
  v_add_u32 v27, 0, v20
  v_add_u32 v28, 0, v21
  v_add_u32 v29, 0, v22
  ds_read_b128 v[164:167], v27 offset:32768
  ds_read_b64_tr_b16 v[196:197], v29 offset:32768
  ds_read_b64_tr_b16 v[198:199], v29 offset:33024
  ds_read_b128 v[168:171], v28 offset:32768
  ds_read_b64_tr_b16 v[200:201], v29 offset:34816
  ds_read_b64_tr_b16 v[202:203], v29 offset:35072
  ds_read_b128 v[172:175], v27 offset:36864
  ds_read_b64_tr_b16 v[204:205], v29 offset:36864
  ds_read_b64_tr_b16 v[206:207], v29 offset:37120
  ds_read_b128 v[176:179], v28 offset:36864
  ds_read_b64_tr_b16 v[208:209], v29 offset:38912
  ds_read_b64_tr_b16 v[210:211], v29 offset:39168
  ds_read_b128 v[180:183], v27 offset:40960
  ds_read_b64_tr_b16 v[212:213], v29 offset:40960
  ds_read_b64_tr_b16 v[214:215], v29 offset:41216
  ds_read_b128 v[184:187], v28 offset:40960
  ds_read_b64_tr_b16 v[216:217], v29 offset:43008
  ds_read_b64_tr_b16 v[218:219], v29 offset:43264
  ds_read_b128 v[188:191], v27 offset:45056
  ds_read_b64_tr_b16 v[220:221], v29 offset:45056
  ds_read_b64_tr_b16 v[222:223], v29 offset:45312
  ds_read_b128 v[192:195], v28 offset:45056
  ds_read_b64_tr_b16 v[224:225], v29 offset:47104
  ds_read_b64_tr_b16 v[226:227], v29 offset:47360
  s_cmp_lg_u32 s82, 0
  s_cbranch_scc1 L_kv_v1
  s_waitcnt lgkmcnt(12)
  v_mfma_f32_16x16x32_bf16 v[160:163], v[196:199], v[164:167], v[160:163]
  v_mfma_f32_16x16x32_bf16 v[160:163], v[200:203], v[168:171], v[160:163]
  v_mfma_f32_16x16x32_bf16 v[160:163], v[204:207], v[172:175], v[160:163]
  v_mfma_f32_16x16x32_bf16 v[160:163], v[208:211], v[176:179], v[160:163]
  s_waitcnt lgkmcnt(0)
  v_mfma_f32_16x16x32_bf16 v[160:163], v[212:215], v[180:183], v[160:163]
  v_mfma_f32_16x16x32_bf16 v[160:163], v[216:219], v[184:187], v[160:163]
  v_mfma_f32_16x16x32_bf16 v[160:163], v[220:223], v[188:191], v[160:163]
  v_mfma_f32_16x16x32_bf16 v[160:163], v[224:227], v[192:195], v[160:163]
  s_branch L_kv_e1
L_kv_v1:
  s_waitcnt lgkmcnt(12)
  v_mfma_f32_16x16x32_bf16 v[160:163], v[164:167], v[196:199], v[160:163]
  v_mfma_f32_16x16x32_bf16 v[160:163], v[168:171], v[200:203], v[160:163]
  v_mfma_f32_16x16x32_bf16 v[160:163], v[172:175], v[204:207], v[160:163]
  v_mfma_f32_16x16x32_bf16 v[160:163], v[176:179], v[208:211], v[160:163]
  s_waitcnt lgkmcnt(0)
  v_mfma_f32_16x16x32_bf16 v[160:163], v[180:183], v[212:215], v[160:163]
  v_mfma_f32_16x16x32_bf16 v[160:163], v[184:187], v[216:219], v[160:163]
  v_mfma_f32_16x16x32_bf16 v[160:163], v[188:191], v[220:223], v[160:163]
  v_mfma_f32_16x16x32_bf16 v[160:163], v[192:195], v[224:227], v[160:163]
L_kv_e1:
  s_waitcnt lgkmcnt(0)
  s_barrier
  v_add_u32 v27, 65536, v20
  v_add_u32 v28, 65536, v21
  v_add_u32 v29, 65536, v22
  ds_read_b128 v[164:167], v27 offset:0
  ds_read_b64_tr_b16 v[196:197], v29 offset:0
  ds_read_b64_tr_b16 v[198:199], v29 offset:256
  ds_read_b128 v[168:171], v28 offset:0
  ds_read_b64_tr_b16 v[200:201], v29 offset:2048
  ds_read_b64_tr_b16 v[202:203], v29 offset:2304
  ds_read_b128 v[172:175], v27 offset:4096
  ds_read_b64_tr_b16 v[204:205], v29 offset:4096
  ds_read_b64_tr_b16 v[206:207], v29 offset:4352
  ds_read_b128 v[176:179], v28 offset:4096
  ds_read_b64_tr_b16 v[208:209], v29 offset:6144
  ds_read_b64_tr_b16 v[210:211], v29 offset:6400
  ds_read_b128 v[180:183], v27 offset:8192
  ds_read_b64_tr_b16 v[212:213], v29 offset:8192
  ds_read_b64_tr_b16 v[214:215], v29 offset:8448
  ds_read_b128 v[184:187], v28 offset:8192
  ds_read_b64_tr_b16 v[216:217], v29 offset:10240
  ds_read_b64_tr_b16 v[218:219], v29 offset:10496
  ds_read_b128 v[188:191], v27 offset:12288
  ds_read_b64_tr_b16 v[220:221], v29 offset:12288
  ds_read_b64_tr_b16 v[222:223], v29 offset:12544
  ds_read_b128 v[192:195], v28 offset:12288
  ds_read_b64_tr_b16 v[224:225], v29 offset:14336
  ds_read_b64_tr_b16 v[226:227], v29 offset:14592
  s_cmp_lg_u32 s82, 0
  s_cbranch_scc1 L_kv_v2
  s_waitcnt lgkmcnt(12)
  v_mfma_f32_16x16x32_bf16 v[160:163], v[196:199], v[164:167], v[160:163]
  v_mfma_f32_16x16x32_bf16 v[160:163], v[200:203], v[168:171], v[160:163]
  v_mfma_f32_16x16x32_bf16 v[160:163], v[204:207], v[172:175], v[160:163]
  v_mfma_f32_16x16x32_bf16 v[160:163], v[208:211], v[176:179], v[160:163]
  s_waitcnt lgkmcnt(0)
  v_mfma_f32_16x16x32_bf16 v[160:163], v[212:215], v[180:183], v[160:163]
  v_mfma_f32_16x16x32_bf16 v[160:163], v[216:219], v[184:187], v[160:163]
  v_mfma_f32_16x16x32_bf16 v[160:163], v[220:223], v[188:191], v[160:163]
  v_mfma_f32_16x16x32_bf16 v[160:163], v[224:227], v[192:195], v[160:163]
  s_branch L_kv_e2
L_kv_v2:
  s_waitcnt lgkmcnt(12)
  v_mfma_f32_16x16x32_bf16 v[160:163], v[164:167], v[196:199], v[160:163]
  v_mfma_f32_16x16x32_bf16 v[160:163], v[168:171], v[200:203], v[160:163]
  v_mfma_f32_16x16x32_bf16 v[160:163], v[172:175], v[204:207], v[160:163]
  v_mfma_f32_16x16x32_bf16 v[160:163], v[176:179], v[208:211], v[160:163]
  s_waitcnt lgkmcnt(0)
  v_mfma_f32_16x16x32_bf16 v[160:163], v[180:183], v[212:215], v[160:163]
  v_mfma_f32_16x16x32_bf16 v[160:163], v[184:187], v[216:219], v[160:163]
  v_mfma_f32_16x16x32_bf16 v[160:163], v[188:191], v[220:223], v[160:163]
  v_mfma_f32_16x16x32_bf16 v[160:163], v[192:195], v[224:227], v[160:163]
L_kv_e2:
  s_waitcnt lgkmcnt(0)
  s_barrier
  v_add_u32 v27, 65536, v20
  v_add_u32 v28, 65536, v21
  v_add_u32 v29, 65536, v22
  ds_read_b128 v[164:167], v27 offset:32768
  ds_read_b64_tr_b16 v[196:197], v29 offset:32768
  ds_read_b64_tr_b16 v[198:199], v29 offset:33024
  ds_read_b128 v[168:171], v28 offset:32768
  ds_read_b64_tr_b16 v[200:201], v29 offset:34816
  ds_read_b64_tr_b16 v[202:203], v29 offset:35072
  ds_read_b128 v[172:175], v27 offset:36864
  ds_read_b64_tr_b16 v[204:205], v29 offset:36864
  ds_read_b64_tr_b16 v[206:207], v29 offset:37120
  ds_read_b128 v[176:179], v28 offset:36864
  ds_read_b64_tr_b16 v[208:209], v29 offset:38912
  ds_read_b64_tr_b16 v[210:211], v29 offset:39168
  ds_read_b128 v[180:183], v27 offset:40960
  ds_read_b64_tr_b16 v[212:213], v29 offset:40960
  ds_read_b64_tr_b16 v[214:215], v29 offset:41216
  ds_read_b128 v[184:187], v28 offset:40960
  ds_read_b64_tr_b16 v[216:217], v29 offset:43008
  ds_read_b64_tr_b16 v[218:219], v29 offset:43264
  ds_read_b128 v[188:191], v27 offset:45056
  ds_read_b64_tr_b16 v[220:221], v29 offset:45056
  ds_read_b64_tr_b16 v[222:223], v29 offset:45312
  ds_read_b128 v[192:195], v28 offset:45056
  ds_read_b64_tr_b16 v[224:225], v29 offset:47104
  ds_read_b64_tr_b16 v[226:227], v29 offset:47360
  s_cmp_lg_u32 s82, 0
  s_cbranch_scc1 L_kv_v3
  s_waitcnt lgkmcnt(12)
  v_mfma_f32_16x16x32_bf16 v[160:163], v[196:199], v[164:167], v[160:163]
  v_mfma_f32_16x16x32_bf16 v[160:163], v[200:203], v[168:171], v[160:163]
  v_mfma_f32_16x16x32_bf16 v[160:163], v[204:207], v[172:175], v[160:163]
  v_mfma_f32_16x16x32_bf16 v[160:163], v[208:211], v[176:179], v[160:163]
  s_waitcnt lgkmcnt(0)
  v_mfma_f32_16x16x32_bf16 v[160:163], v[212:215], v[180:183], v[160:163]
  v_mfma_f32_16x16x32_bf16 v[160:163], v[216:219], v[184:187], v[160:163]
  v_mfma_f32_16x16x32_bf16 v[160:163], v[220:223], v[188:191], v[160:163]
  v_mfma_f32_16x16x32_bf16 v[160:163], v[224:227], v[192:195], v[160:163]
  s_branch L_kv_e3
L_kv_v3:
  s_waitcnt lgkmcnt(12)
  v_mfma_f32_16x16x32_bf16 v[160:163], v[164:167], v[196:199], v[160:163]
  v_mfma_f32_16x16x32_bf16 v[160:163], v[168:171], v[200:203], v[160:163]
  v_mfma_f32_16x16x32_bf16 v[160:163], v[172:175], v[204:207], v[160:163]
  v_mfma_f32_16x16x32_bf16 v[160:163], v[176:179], v[208:211], v[160:163]
  s_waitcnt lgkmcnt(0)
  v_mfma_f32_16x16x32_bf16 v[160:163], v[180:183], v[212:215], v[160:163]
  v_mfma_f32_16x16x32_bf16 v[160:163], v[184:187], v[216:219], v[160:163]
  v_mfma_f32_16x16x32_bf16 v[160:163], v[188:191], v[220:223], v[160:163]
  v_mfma_f32_16x16x32_bf16 v[160:163], v[192:195], v[224:227], v[160:163]
L_kv_e3:
  v_and_b32 v26, 15, v0
  v_lshrrev_b32 v27, 4, v0
  s_cmp_lg_u32 s82, 0
  s_cselect_b32 s30, s72, s73
  s_cselect_b32 s31, s73, s72
  s_cselect_b32 s32, 0, 1
  s_lshl_b32 s30, s30, 10
  s_lshl_b32 s31, s31, 8
  s_add_u32 s30, s30, s31
  s_lshl_b32 s31, s82, 11
  s_add_u32 s30, s30, s31
  s_lshl_b32 s31, s28, 2
  s_lshr_b32 s33, s29, 1
  s_add_u32 s31, s31, s33
  s_lshl_b32 s31, s31, 12
  s_add_u32 s30, s30, s31
  v_lshrrev_b32 v28, s32, v27
  v_and_b32 v28, 1, v28
  v_lshlrev_b32 v28, 9, v28
  s_xor_b32 s32, s32, 1
  v_lshrrev_b32 v29, s32, v27
  v_and_b32 v29, 1, v29
  v_lshlrev_b32 v29, 3, v29
  v_lshlrev_b32 v30, 4, v26
  v_add3_u32 v30, v30, v28, v29
  s_cmp_lg_u32 s82, 0
  s_cselect_b32 s31, 1.0, 0x3e8293ee
  s_nop 3
  v_mul_f32 v160, s31, v160
  v_mul_f32 v161, s31, v161
  v_mul_f32 v162, s31, v162
  v_mul_f32 v163, s31, v163
  v_cvt_pk_bf16_f32 v26, v160, v161
  v_cvt_pk_bf16_f32 v27, v162, v163
  buffer_store_dwordx2 v[26:27], v30, s[16:19], s30 offen sc1
  s_waitcnt lgkmcnt(0)
  s_barrier
  ds_read_b128 v[112:115], v6 offset:0
  ds_read_b64_tr_b16 v[96:97], v16 offset:0
  ds_read_b64_tr_b16 v[98:99], v16 offset:1024
  ds_read_b128 v[116:119], v6 offset:2048
  ds_read_b128 v[120:123], v6 offset:4096
  ds_read_b128 v[124:127], v6 offset:6144
  ds_read_b64_tr_b16 v[100:101], v17 offset:0
  ds_read_b64_tr_b16 v[102:103], v17 offset:1024
  ds_read_b64_tr_b16 v[104:105], v18 offset:0
  ds_read_b64_tr_b16 v[106:107], v18 offset:1024
  ds_read_b64_tr_b16 v[108:109], v19 offset:0
  ds_read_b64_tr_b16 v[110:111], v19 offset:1024
  s_waitcnt lgkmcnt(9)
  v_mfma_f32_16x16x32_bf16 v[32:35], v[96:99], v[112:115], v[32:35]
  ds_read_b128 v[144:147], v7 offset:0
  s_waitcnt lgkmcnt(9)
  v_mfma_f32_16x16x32_bf16 v[36:39], v[96:99], v[116:119], v[36:39]
  ds_read_b64_tr_b16 v[128:129], v16 offset:8192
  s_waitcnt lgkmcnt(9)
  v_mfma_f32_16x16x32_bf16 v[40:43], v[96:99], v[120:123], v[40:43]
  ds_read_b64_tr_b16 v[130:131], v16 offset:9216
  s_waitcnt lgkmcnt(9)
  v_mfma_f32_16x16x32_bf16 v[44:47], v[96:99], v[124:127], v[44:47]
  ds_read_b128 v[148:151], v7 offset:2048
  s_waitcnt lgkmcnt(8)
  v_mfma_f32_16x16x32_bf16 v[48:51], v[100:103], v[112:115], v[48:51]
  ds_read_b128 v[152:155], v7 offset:4096
  v_mfma_f32_16x16x32_bf16 v[52:55], v[100:103], v[116:119], v[52:55]
  ds_read_b128 v[156:159], v7 offset:6144
  v_mfma_f32_16x16x32_bf16 v[56:59], v[100:103], v[120:123], v[56:59]
  ds_read_b64_tr_b16 v[132:133], v17 offset:8192
  v_mfma_f32_16x16x32_bf16 v[60:63], v[100:103], v[124:127], v[60:63]
  ds_read_b64_tr_b16 v[134:135], v17 offset:9216
  s_waitcnt lgkmcnt(10)
  v_mfma_f32_16x16x32_bf16 v[64:67], v[104:107], v[112:115], v[64:67]
  ds_read_b64_tr_b16 v[136:137], v18 offset:8192
  v_mfma_f32_16x16x32_bf16 v[68:71], v[104:107], v[116:119], v[68:71]
  ds_read_b64_tr_b16 v[138:139], v18 offset:9216
  v_mfma_f32_16x16x32_bf16 v[72:75], v[104:107], v[120:123], v[72:75]
  ds_read_b64_tr_b16 v[140:141], v19 offset:8192
  v_mfma_f32_16x16x32_bf16 v[76:79], v[104:107], v[124:127], v[76:79]
  ds_read_b64_tr_b16 v[142:143], v19 offset:9216
  s_waitcnt lgkmcnt(12)
  v_mfma_f32_16x16x32_bf16 v[80:83], v[108:111], v[112:115], v[80:83]
  v_mfma_f32_16x16x32_bf16 v[84:87], v[108:111], v[116:119], v[84:87]
  v_mfma_f32_16x16x32_bf16 v[88:91], v[108:111], v[120:123], v[88:91]
  v_mfma_f32_16x16x32_bf16 v[92:95], v[108:111], v[124:127], v[92:95]
  s_waitcnt lgkmcnt(0)
  s_barrier
  v_mfma_f32_16x16x32_bf16 v[32:35], v[128:131], v[144:147], v[32:35]
  ds_read_b128 v[112:115], v2 offset:0
  v_mfma_f32_16x16x32_bf16 v[36:39], v[128:131], v[148:151], v[36:39]
  ds_read_b64_tr_b16 v[96:97], v8 offset:0
  v_mfma_f32_16x16x32_bf16 v[40:43], v[128:131], v[152:155], v[40:43]
  ds_read_b64_tr_b16 v[98:99], v8 offset:1024
  v_mfma_f32_16x16x32_bf16 v[44:47], v[128:131], v[156:159], v[44:47]
  ds_read_b128 v[116:119], v2 offset:2048
  v_mfma_f32_16x16x32_bf16 v[48:51], v[132:135], v[144:147], v[48:51]
  ds_read_b128 v[120:123], v2 offset:4096
  v_mfma_f32_16x16x32_bf16 v[52:55], v[132:135], v[148:151], v[52:55]
  ds_read_b128 v[124:127], v2 offset:6144
  v_mfma_f32_16x16x32_bf16 v[56:59], v[132:135], v[152:155], v[56:59]
  ds_read_b64_tr_b16 v[100:101], v9 offset:0
  v_mfma_f32_16x16x32_bf16 v[60:63], v[132:135], v[156:159], v[60:63]
  ds_read_b64_tr_b16 v[102:103], v9 offset:1024
  v_mfma_f32_16x16x32_bf16 v[64:67], v[136:139], v[144:147], v[64:67]
  ds_read_b64_tr_b16 v[104:105], v10 offset:0
  v_mfma_f32_16x16x32_bf16 v[68:71], v[136:139], v[148:151], v[68:71]
  ds_read_b64_tr_b16 v[106:107], v10 offset:1024
  v_mfma_f32_16x16x32_bf16 v[72:75], v[136:139], v[152:155], v[72:75]
  ds_read_b64_tr_b16 v[108:109], v11 offset:0
  v_mfma_f32_16x16x32_bf16 v[76:79], v[136:139], v[156:159], v[76:79]
  ds_read_b64_tr_b16 v[110:111], v11 offset:1024
  v_mfma_f32_16x16x32_bf16 v[80:83], v[140:143], v[144:147], v[80:83]
  v_mov_b32 v160, 0
  v_mfma_f32_16x16x32_bf16 v[84:87], v[140:143], v[148:151], v[84:87]
  v_mov_b32 v161, 0
  v_mfma_f32_16x16x32_bf16 v[88:91], v[140:143], v[152:155], v[88:91]
  v_mov_b32 v162, 0
  v_mfma_f32_16x16x32_bf16 v[92:95], v[140:143], v[156:159], v[92:95]
  v_mov_b32 v163, 0
  s_waitcnt lgkmcnt(9)
  v_mfma_f32_16x16x32_bf16 v[32:35], v[96:99], v[112:115], v[32:35]
  ds_read_b128 v[144:147], v3 offset:0
  s_waitcnt lgkmcnt(9)
  v_mfma_f32_16x16x32_bf16 v[36:39], v[96:99], v[116:119], v[36:39]
  ds_read_b64_tr_b16 v[128:129], v8 offset:8192
  s_waitcnt lgkmcnt(9)
  v_mfma_f32_16x16x32_bf16 v[40:43], v[96:99], v[120:123], v[40:43]
  ds_read_b64_tr_b16 v[130:131], v8 offset:9216
  s_waitcnt lgkmcnt(9)
  v_mfma_f32_16x16x32_bf16 v[44:47], v[96:99], v[124:127], v[44:47]
  ds_read_b128 v[148:151], v3 offset:2048
  s_waitcnt lgkmcnt(8)
  v_mfma_f32_16x16x32_bf16 v[48:51], v[100:103], v[112:115], v[48:51]
  ds_read_b128 v[152:155], v3 offset:4096
  v_mfma_f32_16x16x32_bf16 v[52:55], v[100:103], v[116:119], v[52:55]
  ds_read_b128 v[156:159], v3 offset:6144
  v_mfma_f32_16x16x32_bf16 v[56:59], v[100:103], v[120:123], v[56:59]
  ds_read_b64_tr_b16 v[132:133], v9 offset:8192
  v_mfma_f32_16x16x32_bf16 v[60:63], v[100:103], v[124:127], v[60:63]
  ds_read_b64_tr_b16 v[134:135], v9 offset:9216
  s_waitcnt lgkmcnt(10)
  v_mfma_f32_16x16x32_bf16 v[64:67], v[104:107], v[112:115], v[64:67]
  ds_read_b64_tr_b16 v[136:137], v10 offset:8192
  v_mfma_f32_16x16x32_bf16 v[68:71], v[104:107], v[116:119], v[68:71]
  ds_read_b64_tr_b16 v[138:139], v10 offset:9216
  v_mfma_f32_16x16x32_bf16 v[72:75], v[104:107], v[120:123], v[72:75]
  ds_read_b64_tr_b16 v[140:141], v11 offset:8192
  v_mfma_f32_16x16x32_bf16 v[76:79], v[104:107], v[124:127], v[76:79]
  ds_read_b64_tr_b16 v[142:143], v11 offset:9216
  s_waitcnt lgkmcnt(12)
  v_mfma_f32_16x16x32_bf16 v[80:83], v[108:111], v[112:115], v[80:83]
  v_mov_b32 v164, 0
  v_mfma_f32_16x16x32_bf16 v[84:87], v[108:111], v[116:119], v[84:87]
  v_mov_b32 v165, 0
  v_mfma_f32_16x16x32_bf16 v[88:91], v[108:111], v[120:123], v[88:91]
  v_mov_b32 v166, 0
  v_mfma_f32_16x16x32_bf16 v[92:95], v[108:111], v[124:127], v[92:95]
  v_mov_b32 v167, 0
  s_waitcnt lgkmcnt(0)
  s_barrier
  v_mfma_f32_16x16x32_bf16 v[32:35], v[128:131], v[144:147], v[32:35]
  ds_read_b128 v[112:115], v2 offset:32768
  v_mfma_f32_16x16x32_bf16 v[36:39], v[128:131], v[148:151], v[36:39]
  ds_read_b64_tr_b16 v[96:97], v8 offset:32768
  v_mfma_f32_16x16x32_bf16 v[40:43], v[128:131], v[152:155], v[40:43]
  ds_read_b64_tr_b16 v[98:99], v8 offset:33792
  v_mfma_f32_16x16x32_bf16 v[44:47], v[128:131], v[156:159], v[44:47]
  ds_read_b128 v[116:119], v2 offset:34816
  v_mfma_f32_16x16x32_bf16 v[48:51], v[132:135], v[144:147], v[48:51]
  ds_read_b128 v[120:123], v2 offset:36864
  v_mfma_f32_16x16x32_bf16 v[52:55], v[132:135], v[148:151], v[52:55]
  ds_read_b128 v[124:127], v2 offset:38912
  v_mfma_f32_16x16x32_bf16 v[56:59], v[132:135], v[152:155], v[56:59]
  ds_read_b64_tr_b16 v[100:101], v9 offset:32768
  v_mfma_f32_16x16x32_bf16 v[60:63], v[132:135], v[156:159], v[60:63]
  ds_read_b64_tr_b16 v[102:103], v9 offset:33792
  v_mfma_f32_16x16x32_bf16 v[64:67], v[136:139], v[144:147], v[64:67]
  ds_read_b64_tr_b16 v[104:105], v10 offset:32768
  v_mfma_f32_16x16x32_bf16 v[68:71], v[136:139], v[148:151], v[68:71]
  ds_read_b64_tr_b16 v[106:107], v10 offset:33792
  v_mfma_f32_16x16x32_bf16 v[72:75], v[136:139], v[152:155], v[72:75]
  ds_read_b64_tr_b16 v[108:109], v11 offset:32768
  v_mfma_f32_16x16x32_bf16 v[76:79], v[136:139], v[156:159], v[76:79]
  ds_read_b64_tr_b16 v[110:111], v11 offset:33792
  v_mfma_f32_16x16x32_bf16 v[80:83], v[140:143], v[144:147], v[80:83]
  v_mov_b32 v168, 0
  v_mfma_f32_16x16x32_bf16 v[84:87], v[140:143], v[148:151], v[84:87]
  v_mov_b32 v169, 0
  v_mfma_f32_16x16x32_bf16 v[88:91], v[140:143], v[152:155], v[88:91]
  v_mov_b32 v170, 0
  v_mfma_f32_16x16x32_bf16 v[92:95], v[140:143], v[156:159], v[92:95]
  v_mov_b32 v171, 0
  s_waitcnt lgkmcnt(9)
  v_mfma_f32_16x16x32_bf16 v[32:35], v[96:99], v[112:115], v[32:35]
  ds_read_b128 v[144:147], v3 offset:32768
  s_waitcnt lgkmcnt(9)
  v_mfma_f32_16x16x32_bf16 v[36:39], v[96:99], v[116:119], v[36:39]
  ds_read_b64_tr_b16 v[128:129], v8 offset:40960
  s_waitcnt lgkmcnt(9)
  v_mfma_f32_16x16x32_bf16 v[40:43], v[96:99], v[120:123], v[40:43]
  ds_read_b64_tr_b16 v[130:131], v8 offset:41984
  s_waitcnt lgkmcnt(9)
  v_mfma_f32_16x16x32_bf16 v[44:47], v[96:99], v[124:127], v[44:47]
  ds_read_b128 v[148:151], v3 offset:34816
  s_waitcnt lgkmcnt(8)
  v_mfma_f32_16x16x32_bf16 v[48:51], v[100:103], v[112:115], v[48:51]
  ds_read_b128 v[152:155], v3 offset:36864
  v_mfma_f32_16x16x32_bf16 v[52:55], v[100:103], v[116:119], v[52:55]
  ds_read_b128 v[156:159], v3 offset:38912
  v_mfma_f32_16x16x32_bf16 v[56:59], v[100:103], v[120:123], v[56:59]
  ds_read_b64_tr_b16 v[132:133], v9 offset:40960
  v_mfma_f32_16x16x32_bf16 v[60:63], v[100:103], v[124:127], v[60:63]
  ds_read_b64_tr_b16 v[134:135], v9 offset:41984
  s_waitcnt lgkmcnt(10)
  v_mfma_f32_16x16x32_bf16 v[64:67], v[104:107], v[112:115], v[64:67]
  ds_read_b64_tr_b16 v[136:137], v10 offset:40960
  v_mfma_f32_16x16x32_bf16 v[68:71], v[104:107], v[116:119], v[68:71]
  ds_read_b64_tr_b16 v[138:139], v10 offset:41984
  v_mfma_f32_16x16x32_bf16 v[72:75], v[104:107], v[120:123], v[72:75]
  ds_read_b64_tr_b16 v[140:141], v11 offset:40960
  v_mfma_f32_16x16x32_bf16 v[76:79], v[104:107], v[124:127], v[76:79]
  ds_read_b64_tr_b16 v[142:143], v11 offset:41984
  s_waitcnt lgkmcnt(12)
  v_mfma_f32_16x16x32_bf16 v[80:83], v[108:111], v[112:115], v[80:83]
  v_mov_b32 v172, 0
  v_mfma_f32_16x16x32_bf16 v[84:87], v[108:111], v[116:119], v[84:87]
  v_mov_b32 v173, 0
  v_mfma_f32_16x16x32_bf16 v[88:91], v[108:111], v[120:123], v[88:91]
  v_mov_b32 v174, 0
  v_mfma_f32_16x16x32_bf16 v[92:95], v[108:111], v[124:127], v[92:95]
  v_mov_b32 v175, 0
  s_waitcnt vmcnt(0) lgkmcnt(0)
  s_barrier
  s_cmp_lg_u32 s26, 0
  s_cbranch_scc1 L_nopub
  v_mov_b32 v28, 0
  v_mov_b32 v29, 1
  s_mov_b64 s[76:77], exec
  s_mov_b64 exec, 1
  global_atomic_add v28, v29, s[24:25] sc1
  s_mov_b64 exec, s[76:77]
L_nopub:
  v_mfma_f32_16x16x32_bf16 v[32:35], v[128:131], v[144:147], v[32:35]
  ds_read_b128 v[112:115], v4 offset:0
  v_mfma_f32_16x16x32_bf16 v[36:39], v[128:131], v[148:151], v[36:39]
  ds_read_b64_tr_b16 v[96:97], v12 offset:0
  v_mfma_f32_16x16x32_bf16 v[40:43], v[128:131], v[152:155], v[40:43]
  ds_read_b64_tr_b16 v[98:99], v12 offset:1024
  v_mfma_f32_16x16x32_bf16 v[44:47], v[128:131], v[156:159], v[44:47]
  ds_read_b128 v[116:119], v4 offset:2048
  v_mfma_f32_16x16x32_bf16 v[48:51], v[132:135], v[144:147], v[48:51]
  ds_read_b128 v[120:123], v4 offset:4096
  v_mfma_f32_16x16x32_bf16 v[52:55], v[132:135], v[148:151], v[52:55]
  ds_read_b128 v[124:127], v4 offset:6144
  v_mfma_f32_16x16x32_bf16 v[56:59], v[132:135], v[152:155], v[56:59]
  ds_read_b64_tr_b16 v[100:101], v13 offset:0
  v_mfma_f32_16x16x32_bf16 v[60:63], v[132:135], v[156:159], v[60:63]
  ds_read_b64_tr_b16 v[102:103], v13 offset:1024
  v_mfma_f32_16x16x32_bf16 v[64:67], v[136:139], v[144:147], v[64:67]
  ds_read_b64_tr_b16 v[104:105], v14 offset:0
  v_mfma_f32_16x16x32_bf16 v[68:71], v[136:139], v[148:151], v[68:71]
  ds_read_b64_tr_b16 v[106:107], v14 offset:1024
  v_mfma_f32_16x16x32_bf16 v[72:75], v[136:139], v[152:155], v[72:75]
  ds_read_b64_tr_b16 v[108:109], v15 offset:0
  v_mfma_f32_16x16x32_bf16 v[76:79], v[136:139], v[156:159], v[76:79]
  ds_read_b64_tr_b16 v[110:111], v15 offset:1024
  v_mfma_f32_16x16x32_bf16 v[80:83], v[140:143], v[144:147], v[80:83]
  v_mov_b32 v176, 0
  v_mfma_f32_16x16x32_bf16 v[84:87], v[140:143], v[148:151], v[84:87]
  v_mov_b32 v177, 0
  v_mfma_f32_16x16x32_bf16 v[88:91], v[140:143], v[152:155], v[88:91]
  v_mov_b32 v178, 0
  v_mfma_f32_16x16x32_bf16 v[92:95], v[140:143], v[156:159], v[92:95]
  v_mov_b32 v179, 0
  s_waitcnt lgkmcnt(9)
  v_mfma_f32_16x16x32_bf16 v[32:35], v[96:99], v[112:115], v[32:35]
  ds_read_b128 v[144:147], v5 offset:0
  s_waitcnt lgkmcnt(9)
  v_mfma_f32_16x16x32_bf16 v[36:39], v[96:99], v[116:119], v[36:39]
  ds_read_b64_tr_b16 v[128:129], v12 offset:8192
  s_waitcnt lgkmcnt(9)
  v_mfma_f32_16x16x32_bf16 v[40:43], v[96:99], v[120:123], v[40:43]
  ds_read_b64_tr_b16 v[130:131], v12 offset:9216
  s_waitcnt lgkmcnt(9)
  v_mfma_f32_16x16x32_bf16 v[44:47], v[96:99], v[124:127], v[44:47]
  ds_read_b128 v[148:151], v5 offset:2048
  s_waitcnt lgkmcnt(8)
  v_mfma_f32_16x16x32_bf16 v[48:51], v[100:103], v[112:115], v[48:51]
  ds_read_b128 v[152:155], v5 offset:4096
  v_mfma_f32_16x16x32_bf16 v[52:55], v[100:103], v[116:119], v[52:55]
  ds_read_b128 v[156:159], v5 offset:6144
  v_mfma_f32_16x16x32_bf16 v[56:59], v[100:103], v[120:123], v[56:59]
  ds_read_b64_tr_b16 v[132:133], v13 offset:8192
  v_mfma_f32_16x16x32_bf16 v[60:63], v[100:103], v[124:127], v[60:63]
  ds_read_b64_tr_b16 v[134:135], v13 offset:9216
  s_waitcnt lgkmcnt(10)
  v_mfma_f32_16x16x32_bf16 v[64:67], v[104:107], v[112:115], v[64:67]
  ds_read_b64_tr_b16 v[136:137], v14 offset:8192
  v_mfma_f32_16x16x32_bf16 v[68:71], v[104:107], v[116:119], v[68:71]
  ds_read_b64_tr_b16 v[138:139], v14 offset:9216
  v_mfma_f32_16x16x32_bf16 v[72:75], v[104:107], v[120:123], v[72:75]
  ds_read_b64_tr_b16 v[140:141], v15 offset:8192
  v_mfma_f32_16x16x32_bf16 v[76:79], v[104:107], v[124:127], v[76:79]
  ds_read_b64_tr_b16 v[142:143], v15 offset:9216
  s_waitcnt lgkmcnt(12)
  v_mfma_f32_16x16x32_bf16 v[80:83], v[108:111], v[112:115], v[80:83]
  v_mov_b32 v180, 0
  v_mfma_f32_16x16x32_bf16 v[84:87], v[108:111], v[116:119], v[84:87]
  v_mov_b32 v181, 0
  v_mfma_f32_16x16x32_bf16 v[88:91], v[108:111], v[120:123], v[88:91]
  v_mov_b32 v182, 0
  v_mfma_f32_16x16x32_bf16 v[92:95], v[108:111], v[124:127], v[92:95]
  v_mov_b32 v183, 0
  s_waitcnt lgkmcnt(0)
  s_barrier
  v_mfma_f32_16x16x32_bf16 v[32:35], v[128:131], v[144:147], v[32:35]
  ds_read_b128 v[112:115], v4 offset:32768
  v_mfma_f32_16x16x32_bf16 v[36:39], v[128:131], v[148:151], v[36:39]
  ds_read_b64_tr_b16 v[96:97], v12 offset:32768
  v_mfma_f32_16x16x32_bf16 v[40:43], v[128:131], v[152:155], v[40:43]
  ds_read_b64_tr_b16 v[98:99], v12 offset:33792
  v_mfma_f32_16x16x32_bf16 v[44:47], v[128:131], v[156:159], v[44:47]
  ds_read_b128 v[116:119], v4 offset:34816
  v_mfma_f32_16x16x32_bf16 v[48:51], v[132:135], v[144:147], v[48:51]
  ds_read_b128 v[120:123], v4 offset:36864
  v_mfma_f32_16x16x32_bf16 v[52:55], v[132:135], v[148:151], v[52:55]
  ds_read_b128 v[124:127], v4 offset:38912
  v_mfma_f32_16x16x32_bf16 v[56:59], v[132:135], v[152:155], v[56:59]
  ds_read_b64_tr_b16 v[100:101], v13 offset:32768
  v_mfma_f32_16x16x32_bf16 v[60:63], v[132:135], v[156:159], v[60:63]
  ds_read_b64_tr_b16 v[102:103], v13 offset:33792
  v_mfma_f32_16x16x32_bf16 v[64:67], v[136:139], v[144:147], v[64:67]
  ds_read_b64_tr_b16 v[104:105], v14 offset:32768
  v_mfma_f32_16x16x32_bf16 v[68:71], v[136:139], v[148:151], v[68:71]
  ds_read_b64_tr_b16 v[106:107], v14 offset:33792
  v_mfma_f32_16x16x32_bf16 v[72:75], v[136:139], v[152:155], v[72:75]
  ds_read_b64_tr_b16 v[108:109], v15 offset:32768
  v_mfma_f32_16x16x32_bf16 v[76:79], v[136:139], v[156:159], v[76:79]
  ds_read_b64_tr_b16 v[110:111], v15 offset:33792
  v_mfma_f32_16x16x32_bf16 v[80:83], v[140:143], v[144:147], v[80:83]
  v_mov_b32 v184, 0
  v_mfma_f32_16x16x32_bf16 v[84:87], v[140:143], v[148:151], v[84:87]
  v_mov_b32 v185, 0
  v_mfma_f32_16x16x32_bf16 v[88:91], v[140:143], v[152:155], v[88:91]
  v_mov_b32 v186, 0
  v_mfma_f32_16x16x32_bf16 v[92:95], v[140:143], v[156:159], v[92:95]
  v_mov_b32 v187, 0
  s_waitcnt lgkmcnt(9)
  v_mfma_f32_16x16x32_bf16 v[32:35], v[96:99], v[112:115], v[32:35]
  ds_read_b128 v[144:147], v5 offset:32768
  s_waitcnt lgkmcnt(9)
  v_mfma_f32_16x16x32_bf16 v[36:39], v[96:99], v[116:119], v[36:39]
  ds_read_b64_tr_b16 v[128:129], v12 offset:40960
  s_waitcnt lgkmcnt(9)
  v_mfma_f32_16x16x32_bf16 v[40:43], v[96:99], v[120:123], v[40:43]
  ds_read_b64_tr_b16 v[130:131], v12 offset:41984
  s_waitcnt lgkmcnt(9)
  v_mfma_f32_16x16x32_bf16 v[44:47], v[96:99], v[124:127], v[44:47]
  ds_read_b128 v[148:151], v5 offset:34816
  s_waitcnt lgkmcnt(8)
  v_mfma_f32_16x16x32_bf16 v[48:51], v[100:103], v[112:115], v[48:51]
  ds_read_b128 v[152:155], v5 offset:36864
  v_mfma_f32_16x16x32_bf16 v[52:55], v[100:103], v[116:119], v[52:55]
  ds_read_b128 v[156:159], v5 offset:38912
  v_mfma_f32_16x16x32_bf16 v[56:59], v[100:103], v[120:123], v[56:59]
  ds_read_b64_tr_b16 v[132:133], v13 offset:40960
  v_mfma_f32_16x16x32_bf16 v[60:63], v[100:103], v[124:127], v[60:63]
  ds_read_b64_tr_b16 v[134:135], v13 offset:41984
  s_waitcnt lgkmcnt(10)
  v_mfma_f32_16x16x32_bf16 v[64:67], v[104:107], v[112:115], v[64:67]
  ds_read_b64_tr_b16 v[136:137], v14 offset:40960
  v_mfma_f32_16x16x32_bf16 v[68:71], v[104:107], v[116:119], v[68:71]
  ds_read_b64_tr_b16 v[138:139], v14 offset:41984
  v_mfma_f32_16x16x32_bf16 v[72:75], v[104:107], v[120:123], v[72:75]
  ds_read_b64_tr_b16 v[140:141], v15 offset:40960
  v_mfma_f32_16x16x32_bf16 v[76:79], v[104:107], v[124:127], v[76:79]
  ds_read_b64_tr_b16 v[142:143], v15 offset:41984
  s_waitcnt lgkmcnt(12)
  v_mfma_f32_16x16x32_bf16 v[80:83], v[108:111], v[112:115], v[80:83]
  v_mov_b32 v188, 0
  v_mfma_f32_16x16x32_bf16 v[84:87], v[108:111], v[116:119], v[84:87]
  v_mov_b32 v189, 0
  v_mfma_f32_16x16x32_bf16 v[88:91], v[108:111], v[120:123], v[88:91]
  v_mov_b32 v190, 0
  v_mfma_f32_16x16x32_bf16 v[92:95], v[108:111], v[124:127], v[92:95]
  v_mov_b32 v191, 0
  s_waitcnt lgkmcnt(0)
  s_barrier
  v_mfma_f32_16x16x32_bf16 v[32:35], v[128:131], v[144:147], v[32:35]
  ds_read_b128 v[112:115], v6 offset:0
  v_mfma_f32_16x16x32_bf16 v[36:39], v[128:131], v[148:151], v[36:39]
  ds_read_b64_tr_b16 v[96:97], v16 offset:0
  v_mfma_f32_16x16x32_bf16 v[40:43], v[128:131], v[152:155], v[40:43]
  ds_read_b64_tr_b16 v[98:99], v16 offset:1024
  v_mfma_f32_16x16x32_bf16 v[44:47], v[128:131], v[156:159], v[44:47]
  ds_read_b128 v[116:119], v6 offset:2048
  v_mfma_f32_16x16x32_bf16 v[48:51], v[132:135], v[144:147], v[48:51]
  ds_read_b128 v[120:123], v6 offset:4096
  v_mfma_f32_16x16x32_bf16 v[52:55], v[132:135], v[148:151], v[52:55]
  ds_read_b128 v[124:127], v6 offset:6144
  v_mfma_f32_16x16x32_bf16 v[56:59], v[132:135], v[152:155], v[56:59]
  ds_read_b64_tr_b16 v[100:101], v17 offset:0
  v_mfma_f32_16x16x32_bf16 v[60:63], v[132:135], v[156:159], v[60:63]
  ds_read_b64_tr_b16 v[102:103], v17 offset:1024
  v_mfma_f32_16x16x32_bf16 v[64:67], v[136:139], v[144:147], v[64:67]
  ds_read_b64_tr_b16 v[104:105], v18 offset:0
  v_mfma_f32_16x16x32_bf16 v[68:71], v[136:139], v[148:151], v[68:71]
  ds_read_b64_tr_b16 v[106:107], v18 offset:1024
  v_mfma_f32_16x16x32_bf16 v[72:75], v[136:139], v[152:155], v[72:75]
  ds_read_b64_tr_b16 v[108:109], v19 offset:0
  v_mfma_f32_16x16x32_bf16 v[76:79], v[136:139], v[156:159], v[76:79]
  ds_read_b64_tr_b16 v[110:111], v19 offset:1024
  v_mfma_f32_16x16x32_bf16 v[80:83], v[140:143], v[144:147], v[80:83]
  v_mov_b32 v192, 0
  v_mfma_f32_16x16x32_bf16 v[84:87], v[140:143], v[148:151], v[84:87]
  v_mov_b32 v193, 0
  v_mfma_f32_16x16x32_bf16 v[88:91], v[140:143], v[152:155], v[88:91]
  v_mov_b32 v194, 0
  v_mfma_f32_16x16x32_bf16 v[92:95], v[140:143], v[156:159], v[92:95]
  v_mov_b32 v195, 0
  s_waitcnt lgkmcnt(9)
  v_mfma_f32_16x16x32_bf16 v[32:35], v[96:99], v[112:115], v[32:35]
  ds_read_b128 v[144:147], v7 offset:0
  s_waitcnt lgkmcnt(9)
  v_mfma_f32_16x16x32_bf16 v[36:39], v[96:99], v[116:119], v[36:39]
  ds_read_b64_tr_b16 v[128:129], v16 offset:8192
  s_waitcnt lgkmcnt(9)
  v_mfma_f32_16x16x32_bf16 v[40:43], v[96:99], v[120:123], v[40:43]
  ds_read_b64_tr_b16 v[130:131], v16 offset:9216
  s_waitcnt lgkmcnt(9)
  v_mfma_f32_16x16x32_bf16 v[44:47], v[96:99], v[124:127], v[44:47]
  ds_read_b128 v[148:151], v7 offset:2048
  s_waitcnt lgkmcnt(8)
  v_mfma_f32_16x16x32_bf16 v[48:51], v[100:103], v[112:115], v[48:51]
  ds_read_b128 v[152:155], v7 offset:4096
  v_mfma_f32_16x16x32_bf16 v[52:55], v[100:103], v[116:119], v[52:55]
  ds_read_b128 v[156:159], v7 offset:6144
  v_mfma_f32_16x16x32_bf16 v[56:59], v[100:103], v[120:123], v[56:59]
  ds_read_b64_tr_b16 v[132:133], v17 offset:8192
  v_mfma_f32_16x16x32_bf16 v[60:63], v[100:103], v[124:127], v[60:63]
  ds_read_b64_tr_b16 v[134:135], v17 offset:9216
  s_waitcnt lgkmcnt(10)
  v_mfma_f32_16x16x32_bf16 v[64:67], v[104:107], v[112:115], v[64:67]
  ds_read_b64_tr_b16 v[136:137], v18 offset:8192
  v_mfma_f32_16x16x32_bf16 v[68:71], v[104:107], v[116:119], v[68:71]
  ds_read_b64_tr_b16 v[138:139], v18 offset:9216
  v_mfma_f32_16x16x32_bf16 v[72:75], v[104:107], v[120:123], v[72:75]
  ds_read_b64_tr_b16 v[140:141], v19 offset:8192
  v_mfma_f32_16x16x32_bf16 v[76:79], v[104:107], v[124:127], v[76:79]
  ds_read_b64_tr_b16 v[142:143], v19 offset:9216
  s_waitcnt lgkmcnt(12)
  v_mfma_f32_16x16x32_bf16 v[80:83], v[108:111], v[112:115], v[80:83]
  v_mov_b32 v196, 0
  v_mfma_f32_16x16x32_bf16 v[84:87], v[108:111], v[116:119], v[84:87]
  v_mov_b32 v197, 0
  v_mfma_f32_16x16x32_bf16 v[88:91], v[108:111], v[120:123], v[88:91]
  v_mov_b32 v198, 0
  v_mfma_f32_16x16x32_bf16 v[92:95], v[108:111], v[124:127], v[92:95]
  v_mov_b32 v199, 0
  s_waitcnt lgkmcnt(0)
  s_barrier
  v_mfma_f32_16x16x32_bf16 v[32:35], v[128:131], v[144:147], v[32:35]
  ds_read_b128 v[112:115], v2 offset:0
  v_mfma_f32_16x16x32_bf16 v[36:39], v[128:131], v[148:151], v[36:39]
  ds_read_b64_tr_b16 v[96:97], v8 offset:0
  v_mfma_f32_16x16x32_bf16 v[40:43], v[128:131], v[152:155], v[40:43]
  ds_read_b64_tr_b16 v[98:99], v8 offset:1024
  v_mfma_f32_16x16x32_bf16 v[44:47], v[128:131], v[156:159], v[44:47]
  ds_read_b128 v[116:119], v2 offset:2048
  v_mfma_f32_16x16x32_bf16 v[48:51], v[132:135], v[144:147], v[48:51]
  ds_read_b128 v[120:123], v2 offset:4096
  v_mfma_f32_16x16x32_bf16 v[52:55], v[132:135], v[148:151], v[52:55]
  ds_read_b128 v[124:127], v2 offset:6144
  v_mfma_f32_16x16x32_bf16 v[56:59], v[132:135], v[152:155], v[56:59]
  ds_read_b64_tr_b16 v[100:101], v9 offset:0
  v_mfma_f32_16x16x32_bf16 v[60:63], v[132:135], v[156:159], v[60:63]
  ds_read_b64_tr_b16 v[102:103], v9 offset:1024
  v_mfma_f32_16x16x32_bf16 v[64:67], v[136:139], v[144:147], v[64:67]
  ds_read_b64_tr_b16 v[104:105], v10 offset:0
  v_mfma_f32_16x16x32_bf16 v[68:71], v[136:139], v[148:151], v[68:71]
  ds_read_b64_tr_b16 v[106:107], v10 offset:1024
  v_mfma_f32_16x16x32_bf16 v[72:75], v[136:139], v[152:155], v[72:75]
  ds_read_b64_tr_b16 v[108:109], v11 offset:0
  v_mfma_f32_16x16x32_bf16 v[76:79], v[136:139], v[156:159], v[76:79]
  ds_read_b64_tr_b16 v[110:111], v11 offset:1024
  v_mfma_f32_16x16x32_bf16 v[80:83], v[140:143], v[144:147], v[80:83]
  v_mov_b32 v200, 0
  v_mfma_f32_16x16x32_bf16 v[84:87], v[140:143], v[148:151], v[84:87]
  v_mov_b32 v201, 0
  v_mfma_f32_16x16x32_bf16 v[88:91], v[140:143], v[152:155], v[88:91]
  v_mov_b32 v202, 0
  v_mfma_f32_16x16x32_bf16 v[92:95], v[140:143], v[156:159], v[92:95]
  v_mov_b32 v203, 0
  s_waitcnt lgkmcnt(9)
  v_mfma_f32_16x16x32_bf16 v[32:35], v[96:99], v[112:115], v[32:35]
  ds_read_b128 v[144:147], v3 offset:0
  s_waitcnt lgkmcnt(9)
  v_mfma_f32_16x16x32_bf16 v[36:39], v[96:99], v[116:119], v[36:39]
  ds_read_b64_tr_b16 v[128:129], v8 offset:8192
  s_waitcnt lgkmcnt(9)
  v_mfma_f32_16x16x32_bf16 v[40:43], v[96:99], v[120:123], v[40:43]
  ds_read_b64_tr_b16 v[130:131], v8 offset:9216
  s_waitcnt lgkmcnt(9)
  v_mfma_f32_16x16x32_bf16 v[44:47], v[96:99], v[124:127], v[44:47]
  ds_read_b128 v[148:151], v3 offset:2048
  s_waitcnt lgkmcnt(8)
  v_mfma_f32_16x16x32_bf16 v[48:51], v[100:103], v[112:115], v[48:51]
  ds_read_b128 v[152:155], v3 offset:4096
  v_mfma_f32_16x16x32_bf16 v[52:55], v[100:103], v[116:119], v[52:55]
  ds_read_b128 v[156:159], v3 offset:6144
  v_mfma_f32_16x16x32_bf16 v[56:59], v[100:103], v[120:123], v[56:59]
  ds_read_b64_tr_b16 v[132:133], v9 offset:8192
  v_mfma_f32_16x16x32_bf16 v[60:63], v[100:103], v[124:127], v[60:63]
  ds_read_b64_tr_b16 v[134:135], v9 offset:9216
  s_waitcnt lgkmcnt(10)
  v_mfma_f32_16x16x32_bf16 v[64:67], v[104:107], v[112:115], v[64:67]
  ds_read_b64_tr_b16 v[136:137], v10 offset:8192
  v_mfma_f32_16x16x32_bf16 v[68:71], v[104:107], v[116:119], v[68:71]
  ds_read_b64_tr_b16 v[138:139], v10 offset:9216
  v_mfma_f32_16x16x32_bf16 v[72:75], v[104:107], v[120:123], v[72:75]
  ds_read_b64_tr_b16 v[140:141], v11 offset:8192
  v_mfma_f32_16x16x32_bf16 v[76:79], v[104:107], v[124:127], v[76:79]
  ds_read_b64_tr_b16 v[142:143], v11 offset:9216
  s_waitcnt lgkmcnt(12)
  v_mfma_f32_16x16x32_bf16 v[80:83], v[108:111], v[112:115], v[80:83]
  v_mov_b32 v204, 0
  v_mfma_f32_16x16x32_bf16 v[84:87], v[108:111], v[116:119], v[84:87]
  v_mov_b32 v205, 0
  v_mfma_f32_16x16x32_bf16 v[88:91], v[108:111], v[120:123], v[88:91]
  v_mov_b32 v206, 0
  v_mfma_f32_16x16x32_bf16 v[92:95], v[108:111], v[124:127], v[92:95]
  v_mov_b32 v207, 0
  s_waitcnt lgkmcnt(0)
  s_barrier
  v_mfma_f32_16x16x32_bf16 v[32:35], v[128:131], v[144:147], v[32:35]
  ds_read_b128 v[112:115], v2 offset:32768
  v_mfma_f32_16x16x32_bf16 v[36:39], v[128:131], v[148:151], v[36:39]
  ds_read_b64_tr_b16 v[96:97], v8 offset:32768
  v_mfma_f32_16x16x32_bf16 v[40:43], v[128:131], v[152:155], v[40:43]
  ds_read_b64_tr_b16 v[98:99], v8 offset:33792
  v_mfma_f32_16x16x32_bf16 v[44:47], v[128:131], v[156:159], v[44:47]
  ds_read_b128 v[116:119], v2 offset:34816
  v_mfma_f32_16x16x32_bf16 v[48:51], v[132:135], v[144:147], v[48:51]
  ds_read_b128 v[120:123], v2 offset:36864
  v_mfma_f32_16x16x32_bf16 v[52:55], v[132:135], v[148:151], v[52:55]
  ds_read_b128 v[124:127], v2 offset:38912
  v_mfma_f32_16x16x32_bf16 v[56:59], v[132:135], v[152:155], v[56:59]
  ds_read_b64_tr_b16 v[100:101], v9 offset:32768
  v_mfma_f32_16x16x32_bf16 v[60:63], v[132:135], v[156:159], v[60:63]
  ds_read_b64_tr_b16 v[102:103], v9 offset:33792
  v_mfma_f32_16x16x32_bf16 v[64:67], v[136:139], v[144:147], v[64:67]
  ds_read_b64_tr_b16 v[104:105], v10 offset:32768
  v_mfma_f32_16x16x32_bf16 v[68:71], v[136:139], v[148:151], v[68:71]
  ds_read_b64_tr_b16 v[106:107], v10 offset:33792
  v_mfma_f32_16x16x32_bf16 v[72:75], v[136:139], v[152:155], v[72:75]
  ds_read_b64_tr_b16 v[108:109], v11 offset:32768
  v_mfma_f32_16x16x32_bf16 v[76:79], v[136:139], v[156:159], v[76:79]
  ds_read_b64_tr_b16 v[110:111], v11 offset:33792
  v_mfma_f32_16x16x32_bf16 v[80:83], v[140:143], v[144:147], v[80:83]
  v_mov_b32 v208, 0
  v_mfma_f32_16x16x32_bf16 v[84:87], v[140:143], v[148:151], v[84:87]
  v_mov_b32 v209, 0
  v_mfma_f32_16x16x32_bf16 v[88:91], v[140:143], v[152:155], v[88:91]
  v_mov_b32 v210, 0
  v_mfma_f32_16x16x32_bf16 v[92:95], v[140:143], v[156:159], v[92:95]
  v_mov_b32 v211, 0
  s_waitcnt lgkmcnt(9)
  v_mfma_f32_16x16x32_bf16 v[32:35], v[96:99], v[112:115], v[32:35]
  ds_read_b128 v[144:147], v3 offset:32768
  s_waitcnt lgkmcnt(9)
  v_mfma_f32_16x16x32_bf16 v[36:39], v[96:99], v[116:119], v[36:39]
  ds_read_b64_tr_b16 v[128:129], v8 offset:40960
  s_waitcnt lgkmcnt(9)
  v_mfma_f32_16x16x32_bf16 v[40:43], v[96:99], v[120:123], v[40:43]
  ds_read_b64_tr_b16 v[130:131], v8 offset:41984
  s_waitcnt lgkmcnt(9)
  v_mfma_f32_16x16x32_bf16 v[44:47], v[96:99], v[124:127], v[44:47]
  ds_read_b128 v[148:151], v3 offset:34816
  s_waitcnt lgkmcnt(8)
  v_mfma_f32_16x16x32_bf16 v[48:51], v[100:103], v[112:115], v[48:51]
  ds_read_b128 v[152:155], v3 offset:36864
  v_mfma_f32_16x16x32_bf16 v[52:55], v[100:103], v[116:119], v[52:55]
  ds_read_b128 v[156:159], v3 offset:38912
  v_mfma_f32_16x16x32_bf16 v[56:59], v[100:103], v[120:123], v[56:59]
  ds_read_b64_tr_b16 v[132:133], v9 offset:40960
  v_mfma_f32_16x16x32_bf16 v[60:63], v[100:103], v[124:127], v[60:63]
  ds_read_b64_tr_b16 v[134:135], v9 offset:41984
  s_waitcnt lgkmcnt(10)
  v_mfma_f32_16x16x32_bf16 v[64:67], v[104:107], v[112:115], v[64:67]
  ds_read_b64_tr_b16 v[136:137], v10 offset:40960
  v_mfma_f32_16x16x32_bf16 v[68:71], v[104:107], v[116:119], v[68:71]
  ds_read_b64_tr_b16 v[138:139], v10 offset:41984
  v_mfma_f32_16x16x32_bf16 v[72:75], v[104:107], v[120:123], v[72:75]
  ds_read_b64_tr_b16 v[140:141], v11 offset:40960
  v_mfma_f32_16x16x32_bf16 v[76:79], v[104:107], v[124:127], v[76:79]
  ds_read_b64_tr_b16 v[142:143], v11 offset:41984
  s_waitcnt lgkmcnt(12)
  v_mfma_f32_16x16x32_bf16 v[80:83], v[108:111], v[112:115], v[80:83]
  v_mov_b32 v212, 0
  v_mfma_f32_16x16x32_bf16 v[84:87], v[108:111], v[116:119], v[84:87]
  v_mov_b32 v213, 0
  v_mfma_f32_16x16x32_bf16 v[88:91], v[108:111], v[120:123], v[88:91]
  v_mov_b32 v214, 0
  v_mfma_f32_16x16x32_bf16 v[92:95], v[108:111], v[124:127], v[92:95]
  v_mov_b32 v215, 0
  s_waitcnt lgkmcnt(0)
  s_barrier
  v_mfma_f32_16x16x32_bf16 v[32:35], v[128:131], v[144:147], v[32:35]
  ds_read_b128 v[112:115], v4 offset:0
  v_mfma_f32_16x16x32_bf16 v[36:39], v[128:131], v[148:151], v[36:39]
  ds_read_b64_tr_b16 v[96:97], v12 offset:0
  v_mfma_f32_16x16x32_bf16 v[40:43], v[128:131], v[152:155], v[40:43]
  ds_read_b64_tr_b16 v[98:99], v12 offset:1024
  v_mfma_f32_16x16x32_bf16 v[44:47], v[128:131], v[156:159], v[44:47]
  ds_read_b128 v[116:119], v4 offset:2048
  v_mfma_f32_16x16x32_bf16 v[48:51], v[132:135], v[144:147], v[48:51]
  ds_read_b128 v[120:123], v4 offset:4096
  v_mfma_f32_16x16x32_bf16 v[52:55], v[132:135], v[148:151], v[52:55]
  ds_read_b128 v[124:127], v4 offset:6144
  v_mfma_f32_16x16x32_bf16 v[56:59], v[132:135], v[152:155], v[56:59]
  ds_read_b64_tr_b16 v[100:101], v13 offset:0
  v_mfma_f32_16x16x32_bf16 v[60:63], v[132:135], v[156:159], v[60:63]
  ds_read_b64_tr_b16 v[102:103], v13 offset:1024
  v_mfma_f32_16x16x32_bf16 v[64:67], v[136:139], v[144:147], v[64:67]
  ds_read_b64_tr_b16 v[104:105], v14 offset:0
  v_mfma_f32_16x16x32_bf16 v[68:71], v[136:139], v[148:151], v[68:71]
  ds_read_b64_tr_b16 v[106:107], v14 offset:1024
  v_mfma_f32_16x16x32_bf16 v[72:75], v[136:139], v[152:155], v[72:75]
  ds_read_b64_tr_b16 v[108:109], v15 offset:0
  v_mfma_f32_16x16x32_bf16 v[76:79], v[136:139], v[156:159], v[76:79]
  ds_read_b64_tr_b16 v[110:111], v15 offset:1024
  v_mfma_f32_16x16x32_bf16 v[80:83], v[140:143], v[144:147], v[80:83]
  v_mov_b32 v216, 0
  v_mfma_f32_16x16x32_bf16 v[84:87], v[140:143], v[148:151], v[84:87]
  v_mov_b32 v217, 0
  v_mfma_f32_16x16x32_bf16 v[88:91], v[140:143], v[152:155], v[88:91]
  v_mov_b32 v218, 0
  v_mfma_f32_16x16x32_bf16 v[92:95], v[140:143], v[156:159], v[92:95]
  v_mov_b32 v219, 0
  s_waitcnt lgkmcnt(9)
  v_mfma_f32_16x16x32_bf16 v[32:35], v[96:99], v[112:115], v[32:35]
  ds_read_b128 v[144:147], v5 offset:0
  s_waitcnt lgkmcnt(9)
  v_mfma_f32_16x16x32_bf16 v[36:39], v[96:99], v[116:119], v[36:39]
  ds_read_b64_tr_b16 v[128:129], v12 offset:8192
  s_waitcnt lgkmcnt(9)
  v_mfma_f32_16x16x32_bf16 v[40:43], v[96:99], v[120:123], v[40:43]
  ds_read_b64_tr_b16 v[130:131], v12 offset:9216
  s_waitcnt lgkmcnt(9)
  v_mfma_f32_16x16x32_bf16 v[44:47], v[96:99], v[124:127], v[44:47]
  ds_read_b128 v[148:151], v5 offset:2048
  s_waitcnt lgkmcnt(8)
  v_mfma_f32_16x16x32_bf16 v[48:51], v[100:103], v[112:115], v[48:51]
  ds_read_b128 v[152:155], v5 offset:4096
  v_mfma_f32_16x16x32_bf16 v[52:55], v[100:103], v[116:119], v[52:55]
  ds_read_b128 v[156:159], v5 offset:6144
  v_mfma_f32_16x16x32_bf16 v[56:59], v[100:103], v[120:123], v[56:59]
  ds_read_b64_tr_b16 v[132:133], v13 offset:8192
  v_mfma_f32_16x16x32_bf16 v[60:63], v[100:103], v[124:127], v[60:63]
  ds_read_b64_tr_b16 v[134:135], v13 offset:9216
  s_waitcnt lgkmcnt(10)
  v_mfma_f32_16x16x32_bf16 v[64:67], v[104:107], v[112:115], v[64:67]
  ds_read_b64_tr_b16 v[136:137], v14 offset:8192
  v_mfma_f32_16x16x32_bf16 v[68:71], v[104:107], v[116:119], v[68:71]
  ds_read_b64_tr_b16 v[138:139], v14 offset:9216
  v_mfma_f32_16x16x32_bf16 v[72:75], v[104:107], v[120:123], v[72:75]
  ds_read_b64_tr_b16 v[140:141], v15 offset:8192
  v_mfma_f32_16x16x32_bf16 v[76:79], v[104:107], v[124:127], v[76:79]
  ds_read_b64_tr_b16 v[142:143], v15 offset:9216
  s_waitcnt lgkmcnt(12)
  v_mfma_f32_16x16x32_bf16 v[80:83], v[108:111], v[112:115], v[80:83]
  v_mov_b32 v220, 0
  v_mfma_f32_16x16x32_bf16 v[84:87], v[108:111], v[116:119], v[84:87]
  v_mov_b32 v221, 0
  v_mfma_f32_16x16x32_bf16 v[88:91], v[108:111], v[120:123], v[88:91]
  v_mov_b32 v222, 0
  v_mfma_f32_16x16x32_bf16 v[92:95], v[108:111], v[124:127], v[92:95]
  v_mov_b32 v223, 0
  s_waitcnt lgkmcnt(0)
  s_barrier
  v_mfma_f32_16x16x32_bf16 v[32:35], v[128:131], v[144:147], v[32:35]
  ds_read_b128 v[112:115], v4 offset:32768
  v_mfma_f32_16x16x32_bf16 v[36:39], v[128:131], v[148:151], v[36:39]
  ds_read_b64_tr_b16 v[96:97], v12 offset:32768
  v_mfma_f32_16x16x32_bf16 v[40:43], v[128:131], v[152:155], v[40:43]
  ds_read_b64_tr_b16 v[98:99], v12 offset:33792
  v_mfma_f32_16x16x32_bf16 v[44:47], v[128:131], v[156:159], v[44:47]
  ds_read_b128 v[116:119], v4 offset:34816
  v_mfma_f32_16x16x32_bf16 v[48:51], v[132:135], v[144:147], v[48:51]
  ds_read_b128 v[120:123], v4 offset:36864
  v_mfma_f32_16x16x32_bf16 v[52:55], v[132:135], v[148:151], v[52:55]
  ds_read_b128 v[124:127], v4 offset:38912
  v_mfma_f32_16x16x32_bf16 v[56:59], v[132:135], v[152:155], v[56:59]
  ds_read_b64_tr_b16 v[100:101], v13 offset:32768
  v_mfma_f32_16x16x32_bf16 v[60:63], v[132:135], v[156:159], v[60:63]
  ds_read_b64_tr_b16 v[102:103], v13 offset:33792
  v_mfma_f32_16x16x32_bf16 v[64:67], v[136:139], v[144:147], v[64:67]
  ds_read_b64_tr_b16 v[104:105], v14 offset:32768
  v_mfma_f32_16x16x32_bf16 v[68:71], v[136:139], v[148:151], v[68:71]
  ds_read_b64_tr_b16 v[106:107], v14 offset:33792
  v_mfma_f32_16x16x32_bf16 v[72:75], v[136:139], v[152:155], v[72:75]
  ds_read_b64_tr_b16 v[108:109], v15 offset:32768
  v_mfma_f32_16x16x32_bf16 v[76:79], v[136:139], v[156:159], v[76:79]
  ds_read_b64_tr_b16 v[110:111], v15 offset:33792
  v_mfma_f32_16x16x32_bf16 v[80:83], v[140:143], v[144:147], v[80:83]
  v_mov_b32 v224, 0
  v_mfma_f32_16x16x32_bf16 v[84:87], v[140:143], v[148:151], v[84:87]
  v_mov_b32 v225, 0
  v_mfma_f32_16x16x32_bf16 v[88:91], v[140:143], v[152:155], v[88:91]
  v_mov_b32 v226, 0
  v_mfma_f32_16x16x32_bf16 v[92:95], v[140:143], v[156:159], v[92:95]
  v_mov_b32 v227, 0
  s_waitcnt lgkmcnt(9)
  v_mfma_f32_16x16x32_bf16 v[32:35], v[96:99], v[112:115], v[32:35]
  ds_read_b128 v[144:147], v5 offset:32768
  s_waitcnt lgkmcnt(9)
  v_mfma_f32_16x16x32_bf16 v[36:39], v[96:99], v[116:119], v[36:39]
  ds_read_b64_tr_b16 v[128:129], v12 offset:40960
  s_waitcnt lgkmcnt(9)
  v_mfma_f32_16x16x32_bf16 v[40:43], v[96:99], v[120:123], v[40:43]
  ds_read_b64_tr_b16 v[130:131], v12 offset:41984
  s_waitcnt lgkmcnt(9)
  v_mfma_f32_16x16x32_bf16 v[44:47], v[96:99], v[124:127], v[44:47]
  ds_read_b128 v[148:151], v5 offset:34816
  s_waitcnt lgkmcnt(8)
  v_mfma_f32_16x16x32_bf16 v[48:51], v[100:103], v[112:115], v[48:51]
  ds_read_b128 v[152:155], v5 offset:36864
  v_mfma_f32_16x16x32_bf16 v[52:55], v[100:103], v[116:119], v[52:55]
  ds_read_b128 v[156:159], v5 offset:38912
  v_mfma_f32_16x16x32_bf16 v[56:59], v[100:103], v[120:123], v[56:59]
  ds_read_b64_tr_b16 v[132:133], v13 offset:40960
  v_mfma_f32_16x16x32_bf16 v[60:63], v[100:103], v[124:127], v[60:63]
  ds_read_b64_tr_b16 v[134:135], v13 offset:41984
  s_waitcnt lgkmcnt(10)
  v_mfma_f32_16x16x32_bf16 v[64:67], v[104:107], v[112:115], v[64:67]
  ds_read_b64_tr_b16 v[136:137], v14 offset:40960
  v_mfma_f32_16x16x32_bf16 v[68:71], v[104:107], v[116:119], v[68:71]
  ds_read_b64_tr_b16 v[138:139], v14 offset:41984
  v_mfma_f32_16x16x32_bf16 v[72:75], v[104:107], v[120:123], v[72:75]
  ds_read_b64_tr_b16 v[140:141], v15 offset:40960
  v_mfma_f32_16x16x32_bf16 v[76:79], v[104:107], v[124:127], v[76:79]
  ds_read_b64_tr_b16 v[142:143], v15 offset:41984
  s_waitcnt lgkmcnt(12)
  v_mfma_f32_16x16x32_bf16 v[80:83], v[108:111], v[112:115], v[80:83]
  v_mov_b32 v228, 0
  v_mfma_f32_16x16x32_bf16 v[84:87], v[108:111], v[116:119], v[84:87]
  v_mov_b32 v229, 0
  v_mfma_f32_16x16x32_bf16 v[88:91], v[108:111], v[120:123], v[88:91]
  v_mov_b32 v230, 0
  v_mfma_f32_16x16x32_bf16 v[92:95], v[108:111], v[124:127], v[92:95]
  v_mov_b32 v231, 0
  s_waitcnt lgkmcnt(0)
  s_barrier
  v_mfma_f32_16x16x32_bf16 v[32:35], v[128:131], v[144:147], v[32:35]
  ds_read_b128 v[112:115], v6 offset:0
  v_mfma_f32_16x16x32_bf16 v[36:39], v[128:131], v[148:151], v[36:39]
  ds_read_b64_tr_b16 v[96:97], v16 offset:0
  v_mfma_f32_16x16x32_bf16 v[40:43], v[128:131], v[152:155], v[40:43]
  ds_read_b64_tr_b16 v[98:99], v16 offset:1024
  v_mfma_f32_16x16x32_bf16 v[44:47], v[128:131], v[156:159], v[44:47]
  ds_read_b128 v[116:119], v6 offset:2048
  v_mfma_f32_16x16x32_bf16 v[48:51], v[132:135], v[144:147], v[48:51]
  ds_read_b128 v[120:123], v6 offset:4096
  v_mfma_f32_16x16x32_bf16 v[52:55], v[132:135], v[148:151], v[52:55]
  ds_read_b128 v[124:127], v6 offset:6144
  v_mfma_f32_16x16x32_bf16 v[56:59], v[132:135], v[152:155], v[56:59]
  ds_read_b64_tr_b16 v[100:101], v17 offset:0
  v_mfma_f32_16x16x32_bf16 v[60:63], v[132:135], v[156:159], v[60:63]
  ds_read_b64_tr_b16 v[102:103], v17 offset:1024
  v_mfma_f32_16x16x32_bf16 v[64:67], v[136:139], v[144:147], v[64:67]
  ds_read_b64_tr_b16 v[104:105], v18 offset:0
  v_mfma_f32_16x16x32_bf16 v[68:71], v[136:139], v[148:151], v[68:71]
  ds_read_b64_tr_b16 v[106:107], v18 offset:1024
  v_mfma_f32_16x16x32_bf16 v[72:75], v[136:139], v[152:155], v[72:75]
  ds_read_b64_tr_b16 v[108:109], v19 offset:0
  v_mfma_f32_16x16x32_bf16 v[76:79], v[136:139], v[156:159], v[76:79]
  ds_read_b64_tr_b16 v[110:111], v19 offset:1024
  v_mfma_f32_16x16x32_bf16 v[80:83], v[140:143], v[144:147], v[80:83]
  v_mov_b32 v232, 0
  v_mfma_f32_16x16x32_bf16 v[84:87], v[140:143], v[148:151], v[84:87]
  v_mov_b32 v233, 0
  v_mfma_f32_16x16x32_bf16 v[88:91], v[140:143], v[152:155], v[88:91]
  v_mov_b32 v234, 0
  v_mfma_f32_16x16x32_bf16 v[92:95], v[140:143], v[156:159], v[92:95]
  v_mov_b32 v235, 0
  s_waitcnt lgkmcnt(9)
  v_mfma_f32_16x16x32_bf16 v[32:35], v[96:99], v[112:115], v[32:35]
  ds_read_b128 v[144:147], v7 offset:0
  s_waitcnt lgkmcnt(9)
  v_mfma_f32_16x16x32_bf16 v[36:39], v[96:99], v[116:119], v[36:39]
  ds_read_b64_tr_b16 v[128:129], v16 offset:8192
  s_waitcnt lgkmcnt(9)
  v_mfma_f32_16x16x32_bf16 v[40:43], v[96:99], v[120:123], v[40:43]
  ds_read_b64_tr_b16 v[130:131], v16 offset:9216
  s_waitcnt lgkmcnt(9)
  v_mfma_f32_16x16x32_bf16 v[44:47], v[96:99], v[124:127], v[44:47]
  ds_read_b128 v[148:151], v7 offset:2048
  s_waitcnt lgkmcnt(8)
  v_mfma_f32_16x16x32_bf16 v[48:51], v[100:103], v[112:115], v[48:51]
  ds_read_b128 v[152:155], v7 offset:4096
  v_mfma_f32_16x16x32_bf16 v[52:55], v[100:103], v[116:119], v[52:55]
  ds_read_b128 v[156:159], v7 offset:6144
  v_mfma_f32_16x16x32_bf16 v[56:59], v[100:103], v[120:123], v[56:59]
  ds_read_b64_tr_b16 v[132:133], v17 offset:8192
  v_mfma_f32_16x16x32_bf16 v[60:63], v[100:103], v[124:127], v[60:63]
  ds_read_b64_tr_b16 v[134:135], v17 offset:9216
  s_waitcnt lgkmcnt(10)
  v_mfma_f32_16x16x32_bf16 v[64:67], v[104:107], v[112:115], v[64:67]
  ds_read_b64_tr_b16 v[136:137], v18 offset:8192
  v_mfma_f32_16x16x32_bf16 v[68:71], v[104:107], v[116:119], v[68:71]
  ds_read_b64_tr_b16 v[138:139], v18 offset:9216
  v_mfma_f32_16x16x32_bf16 v[72:75], v[104:107], v[120:123], v[72:75]
  ds_read_b64_tr_b16 v[140:141], v19 offset:8192
  v_mfma_f32_16x16x32_bf16 v[76:79], v[104:107], v[124:127], v[76:79]
  ds_read_b64_tr_b16 v[142:143], v19 offset:9216
  s_waitcnt lgkmcnt(12)
  v_mfma_f32_16x16x32_bf16 v[80:83], v[108:111], v[112:115], v[80:83]
  v_mov_b32 v236, 0
  v_mfma_f32_16x16x32_bf16 v[84:87], v[108:111], v[116:119], v[84:87]
  v_mov_b32 v237, 0
  v_mfma_f32_16x16x32_bf16 v[88:91], v[108:111], v[120:123], v[88:91]
  v_mov_b32 v238, 0
  v_mfma_f32_16x16x32_bf16 v[92:95], v[108:111], v[124:127], v[92:95]
  v_mov_b32 v239, 0
  s_waitcnt lgkmcnt(0)
  s_barrier
  v_mfma_f32_16x16x32_bf16 v[32:35], v[128:131], v[144:147], v[32:35]
  ds_read_b128 v[112:115], v2 offset:0
  v_mfma_f32_16x16x32_bf16 v[36:39], v[128:131], v[148:151], v[36:39]
  ds_read_b64_tr_b16 v[96:97], v8 offset:0
  v_mfma_f32_16x16x32_bf16 v[40:43], v[128:131], v[152:155], v[40:43]
  ds_read_b64_tr_b16 v[98:99], v8 offset:1024
  v_mfma_f32_16x16x32_bf16 v[44:47], v[128:131], v[156:159], v[44:47]
  ds_read_b128 v[116:119], v2 offset:2048
  v_mfma_f32_16x16x32_bf16 v[48:51], v[132:135], v[144:147], v[48:51]
  ds_read_b128 v[120:123], v2 offset:4096
  v_mfma_f32_16x16x32_bf16 v[52:55], v[132:135], v[148:151], v[52:55]
  ds_read_b128 v[124:127], v2 offset:6144
  v_mfma_f32_16x16x32_bf16 v[56:59], v[132:135], v[152:155], v[56:59]
  ds_read_b64_tr_b16 v[100:101], v9 offset:0
  v_mfma_f32_16x16x32_bf16 v[60:63], v[132:135], v[156:159], v[60:63]
  ds_read_b64_tr_b16 v[102:103], v9 offset:1024
  v_mfma_f32_16x16x32_bf16 v[64:67], v[136:139], v[144:147], v[64:67]
  ds_read_b64_tr_b16 v[104:105], v10 offset:0
  v_mfma_f32_16x16x32_bf16 v[68:71], v[136:139], v[148:151], v[68:71]
  ds_read_b64_tr_b16 v[106:107], v10 offset:1024
  v_mfma_f32_16x16x32_bf16 v[72:75], v[136:139], v[152:155], v[72:75]
  ds_read_b64_tr_b16 v[108:109], v11 offset:0
  v_mfma_f32_16x16x32_bf16 v[76:79], v[136:139], v[156:159], v[76:79]
  ds_read_b64_tr_b16 v[110:111], v11 offset:1024
  v_mfma_f32_16x16x32_bf16 v[80:83], v[140:143], v[144:147], v[80:83]
  v_mfma_f32_16x16x32_bf16 v[84:87], v[140:143], v[148:151], v[84:87]
  v_mfma_f32_16x16x32_bf16 v[88:91], v[140:143], v[152:155], v[88:91]
  v_mfma_f32_16x16x32_bf16 v[92:95], v[140:143], v[156:159], v[92:95]
  s_waitcnt lgkmcnt(9)
  v_mfma_f32_16x16x32_bf16 v[32:35], v[96:99], v[112:115], v[32:35]
  ds_read_b128 v[144:147], v3 offset:0
  s_waitcnt lgkmcnt(9)
  v_mfma_f32_16x16x32_bf16 v[36:39], v[96:99], v[116:119], v[36:39]
  ds_read_b64_tr_b16 v[128:129], v8 offset:8192
  s_waitcnt lgkmcnt(9)
  v_mfma_f32_16x16x32_bf16 v[40:43], v[96:99], v[120:123], v[40:43]
  ds_read_b64_tr_b16 v[130:131], v8 offset:9216
  s_waitcnt lgkmcnt(9)
  v_mfma_f32_16x16x32_bf16 v[44:47], v[96:99], v[124:127], v[44:47]
  ds_read_b128 v[148:151], v3 offset:2048
  s_waitcnt lgkmcnt(8)
  v_mfma_f32_16x16x32_bf16 v[48:51], v[100:103], v[112:115], v[48:51]
  ds_read_b128 v[152:155], v3 offset:4096
  v_mfma_f32_16x16x32_bf16 v[52:55], v[100:103], v[116:119], v[52:55]
  ds_read_b128 v[156:159], v3 offset:6144
  v_mfma_f32_16x16x32_bf16 v[56:59], v[100:103], v[120:123], v[56:59]
  ds_read_b64_tr_b16 v[132:133], v9 offset:8192
  v_mfma_f32_16x16x32_bf16 v[60:63], v[100:103], v[124:127], v[60:63]
  ds_read_b64_tr_b16 v[134:135], v9 offset:9216
  s_waitcnt lgkmcnt(10)
  v_mfma_f32_16x16x32_bf16 v[64:67], v[104:107], v[112:115], v[64:67]
  ds_read_b64_tr_b16 v[136:137], v10 offset:8192
  v_mfma_f32_16x16x32_bf16 v[68:71], v[104:107], v[116:119], v[68:71]
  ds_read_b64_tr_b16 v[138:139], v10 offset:9216
  v_mfma_f32_16x16x32_bf16 v[72:75], v[104:107], v[120:123], v[72:75]
  ds_read_b64_tr_b16 v[140:141], v11 offset:8192
  v_mfma_f32_16x16x32_bf16 v[76:79], v[104:107], v[124:127], v[76:79]
  ds_read_b64_tr_b16 v[142:143], v11 offset:9216
  s_waitcnt lgkmcnt(12)
  v_mfma_f32_16x16x32_bf16 v[80:83], v[108:111], v[112:115], v[80:83]
  v_mfma_f32_16x16x32_bf16 v[84:87], v[108:111], v[116:119], v[84:87]
  v_mfma_f32_16x16x32_bf16 v[88:91], v[108:111], v[120:123], v[88:91]
  v_mfma_f32_16x16x32_bf16 v[92:95], v[108:111], v[124:127], v[92:95]
  s_waitcnt lgkmcnt(0)
  s_barrier
  v_mfma_f32_16x16x32_bf16 v[32:35], v[128:131], v[144:147], v[32:35]
  ds_read_b128 v[112:115], v2 offset:32768
  v_mfma_f32_16x16x32_bf16 v[36:39], v[128:131], v[148:151], v[36:39]
  ds_read_b64_tr_b16 v[96:97], v8 offset:32768
  v_mfma_f32_16x16x32_bf16 v[40:43], v[128:131], v[152:155], v[40:43]
  ds_read_b64_tr_b16 v[98:99], v8 offset:33792
  v_mfma_f32_16x16x32_bf16 v[44:47], v[128:131], v[156:159], v[44:47]
  ds_read_b128 v[116:119], v2 offset:34816
  v_mfma_f32_16x16x32_bf16 v[48:51], v[132:135], v[144:147], v[48:51]
  ds_read_b128 v[120:123], v2 offset:36864
  v_mfma_f32_16x16x32_bf16 v[52:55], v[132:135], v[148:151], v[52:55]
  ds_read_b128 v[124:127], v2 offset:38912
  v_mfma_f32_16x16x32_bf16 v[56:59], v[132:135], v[152:155], v[56:59]
  ds_read_b64_tr_b16 v[100:101], v9 offset:32768
  v_mfma_f32_16x16x32_bf16 v[60:63], v[132:135], v[156:159], v[60:63]
  ds_read_b64_tr_b16 v[102:103], v9 offset:33792
  v_mfma_f32_16x16x32_bf16 v[64:67], v[136:139], v[144:147], v[64:67]
  ds_read_b64_tr_b16 v[104:105], v10 offset:32768
  v_mfma_f32_16x16x32_bf16 v[68:71], v[136:139], v[148:151], v[68:71]
  ds_read_b64_tr_b16 v[106:107], v10 offset:33792
  v_mfma_f32_16x16x32_bf16 v[72:75], v[136:139], v[152:155], v[72:75]
  ds_read_b64_tr_b16 v[108:109], v11 offset:32768
  v_mfma_f32_16x16x32_bf16 v[76:79], v[136:139], v[156:159], v[76:79]
  ds_read_b64_tr_b16 v[110:111], v11 offset:33792
  v_mfma_f32_16x16x32_bf16 v[80:83], v[140:143], v[144:147], v[80:83]
  v_mfma_f32_16x16x32_bf16 v[84:87], v[140:143], v[148:151], v[84:87]
  v_mfma_f32_16x16x32_bf16 v[88:91], v[140:143], v[152:155], v[88:91]
  v_mfma_f32_16x16x32_bf16 v[92:95], v[140:143], v[156:159], v[92:95]
  s_waitcnt lgkmcnt(9)
  v_mfma_f32_16x16x32_bf16 v[32:35], v[96:99], v[112:115], v[32:35]
  ds_read_b128 v[144:147], v3 offset:32768
  s_waitcnt lgkmcnt(9)
  v_mfma_f32_16x16x32_bf16 v[36:39], v[96:99], v[116:119], v[36:39]
  ds_read_b64_tr_b16 v[128:129], v8 offset:40960
  s_waitcnt lgkmcnt(9)
  v_mfma_f32_16x16x32_bf16 v[40:43], v[96:99], v[120:123], v[40:43]
  ds_read_b64_tr_b16 v[130:131], v8 offset:41984
  s_waitcnt lgkmcnt(9)
  v_mfma_f32_16x16x32_bf16 v[44:47], v[96:99], v[124:127], v[44:47]
  ds_read_b128 v[148:151], v3 offset:34816
  s_waitcnt lgkmcnt(8)
  v_mfma_f32_16x16x32_bf16 v[48:51], v[100:103], v[112:115], v[48:51]
  ds_read_b128 v[152:155], v3 offset:36864
  v_mfma_f32_16x16x32_bf16 v[52:55], v[100:103], v[116:119], v[52:55]
  ds_read_b128 v[156:159], v3 offset:38912
  v_mfma_f32_16x16x32_bf16 v[56:59], v[100:103], v[120:123], v[56:59]
  ds_read_b64_tr_b16 v[132:133], v9 offset:40960
  v_mfma_f32_16x16x32_bf16 v[60:63], v[100:103], v[124:127], v[60:63]
  ds_read_b64_tr_b16 v[134:135], v9 offset:41984
  s_waitcnt lgkmcnt(10)
  v_mfma_f32_16x16x32_bf16 v[64:67], v[104:107], v[112:115], v[64:67]
  ds_read_b64_tr_b16 v[136:137], v10 offset:40960
  v_mfma_f32_16x16x32_bf16 v[68:71], v[104:107], v[116:119], v[68:71]
  ds_read_b64_tr_b16 v[138:139], v10 offset:41984
  v_mfma_f32_16x16x32_bf16 v[72:75], v[104:107], v[120:123], v[72:75]
  ds_read_b64_tr_b16 v[140:141], v11 offset:40960
  v_mfma_f32_16x16x32_bf16 v[76:79], v[104:107], v[124:127], v[76:79]
  ds_read_b64_tr_b16 v[142:143], v11 offset:41984
  s_waitcnt lgkmcnt(12)
  v_mfma_f32_16x16x32_bf16 v[80:83], v[108:111], v[112:115], v[80:83]
  v_mfma_f32_16x16x32_bf16 v[84:87], v[108:111], v[116:119], v[84:87]
  v_mfma_f32_16x16x32_bf16 v[88:91], v[108:111], v[120:123], v[88:91]
  v_mfma_f32_16x16x32_bf16 v[92:95], v[108:111], v[124:127], v[92:95]
  s_waitcnt lgkmcnt(0)
  s_barrier
  v_mfma_f32_16x16x32_bf16 v[32:35], v[128:131], v[144:147], v[32:35]
  ds_read_b128 v[112:115], v4 offset:0
  v_mfma_f32_16x16x32_bf16 v[36:39], v[128:131], v[148:151], v[36:39]
  ds_read_b64_tr_b16 v[96:97], v12 offset:0
  v_mfma_f32_16x16x32_bf16 v[40:43], v[128:131], v[152:155], v[40:43]
  ds_read_b64_tr_b16 v[98:99], v12 offset:1024
  v_mfma_f32_16x16x32_bf16 v[44:47], v[128:131], v[156:159], v[44:47]
  ds_read_b128 v[116:119], v4 offset:2048
  v_mfma_f32_16x16x32_bf16 v[48:51], v[132:135], v[144:147], v[48:51]
  ds_read_b128 v[120:123], v4 offset:4096
  v_mfma_f32_16x16x32_bf16 v[52:55], v[132:135], v[148:151], v[52:55]
  ds_read_b128 v[124:127], v4 offset:6144
  v_mfma_f32_16x16x32_bf16 v[56:59], v[132:135], v[152:155], v[56:59]
  ds_read_b64_tr_b16 v[100:101], v13 offset:0
  v_mfma_f32_16x16x32_bf16 v[60:63], v[132:135], v[156:159], v[60:63]
  ds_read_b64_tr_b16 v[102:103], v13 offset:1024
  v_mfma_f32_16x16x32_bf16 v[64:67], v[136:139], v[144:147], v[64:67]
  ds_read_b64_tr_b16 v[104:105], v14 offset:0
  v_mfma_f32_16x16x32_bf16 v[68:71], v[136:139], v[148:151], v[68:71]
  ds_read_b64_tr_b16 v[106:107], v14 offset:1024
  v_mfma_f32_16x16x32_bf16 v[72:75], v[136:139], v[152:155], v[72:75]
  ds_read_b64_tr_b16 v[108:109], v15 offset:0
  v_mfma_f32_16x16x32_bf16 v[76:79], v[136:139], v[156:159], v[76:79]
  ds_read_b64_tr_b16 v[110:111], v15 offset:1024
  v_mfma_f32_16x16x32_bf16 v[80:83], v[140:143], v[144:147], v[80:83]
  v_mfma_f32_16x16x32_bf16 v[84:87], v[140:143], v[148:151], v[84:87]
  v_mfma_f32_16x16x32_bf16 v[88:91], v[140:143], v[152:155], v[88:91]
  v_mfma_f32_16x16x32_bf16 v[92:95], v[140:143], v[156:159], v[92:95]
  s_waitcnt lgkmcnt(9)
  v_mfma_f32_16x16x32_bf16 v[32:35], v[96:99], v[112:115], v[32:35]
  ds_read_b128 v[144:147], v5 offset:0
  s_waitcnt lgkmcnt(9)
  v_mfma_f32_16x16x32_bf16 v[36:39], v[96:99], v[116:119], v[36:39]
  ds_read_b64_tr_b16 v[128:129], v12 offset:8192
  s_waitcnt lgkmcnt(9)
  v_mfma_f32_16x16x32_bf16 v[40:43], v[96:99], v[120:123], v[40:43]
  ds_read_b64_tr_b16 v[130:131], v12 offset:9216
  s_waitcnt lgkmcnt(9)
  v_mfma_f32_16x16x32_bf16 v[44:47], v[96:99], v[124:127], v[44:47]
  ds_read_b128 v[148:151], v5 offset:2048
  s_waitcnt lgkmcnt(8)
  v_mfma_f32_16x16x32_bf16 v[48:51], v[100:103], v[112:115], v[48:51]
  ds_read_b128 v[152:155], v5 offset:4096
  v_mfma_f32_16x16x32_bf16 v[52:55], v[100:103], v[116:119], v[52:55]
  ds_read_b128 v[156:159], v5 offset:6144
  v_mfma_f32_16x16x32_bf16 v[56:59], v[100:103], v[120:123], v[56:59]
  ds_read_b64_tr_b16 v[132:133], v13 offset:8192
  v_mfma_f32_16x16x32_bf16 v[60:63], v[100:103], v[124:127], v[60:63]
  ds_read_b64_tr_b16 v[134:135], v13 offset:9216
  s_waitcnt lgkmcnt(10)
  v_mfma_f32_16x16x32_bf16 v[64:67], v[104:107], v[112:115], v[64:67]
  ds_read_b64_tr_b16 v[136:137], v14 offset:8192
  v_mfma_f32_16x16x32_bf16 v[68:71], v[104:107], v[116:119], v[68:71]
  ds_read_b64_tr_b16 v[138:139], v14 offset:9216
  v_mfma_f32_16x16x32_bf16 v[72:75], v[104:107], v[120:123], v[72:75]
  ds_read_b64_tr_b16 v[140:141], v15 offset:8192
  v_mfma_f32_16x16x32_bf16 v[76:79], v[104:107], v[124:127], v[76:79]
  ds_read_b64_tr_b16 v[142:143], v15 offset:9216
  s_waitcnt lgkmcnt(12)
  v_mfma_f32_16x16x32_bf16 v[80:83], v[108:111], v[112:115], v[80:83]
  v_mfma_f32_16x16x32_bf16 v[84:87], v[108:111], v[116:119], v[84:87]
  v_mfma_f32_16x16x32_bf16 v[88:91], v[108:111], v[120:123], v[88:91]
  v_mfma_f32_16x16x32_bf16 v[92:95], v[108:111], v[124:127], v[92:95]
  s_waitcnt lgkmcnt(0)
  s_barrier
  v_mfma_f32_16x16x32_bf16 v[32:35], v[128:131], v[144:147], v[32:35]
  ds_read_b128 v[112:115], v4 offset:32768
  v_mfma_f32_16x16x32_bf16 v[36:39], v[128:131], v[148:151], v[36:39]
  ds_read_b64_tr_b16 v[96:97], v12 offset:32768
  v_mfma_f32_16x16x32_bf16 v[40:43], v[128:131], v[152:155], v[40:43]
  ds_read_b64_tr_b16 v[98:99], v12 offset:33792
  v_mfma_f32_16x16x32_bf16 v[44:47], v[128:131], v[156:159], v[44:47]
  ds_read_b128 v[116:119], v4 offset:34816
  v_mfma_f32_16x16x32_bf16 v[48:51], v[132:135], v[144:147], v[48:51]
  ds_read_b128 v[120:123], v4 offset:36864
  v_mfma_f32_16x16x32_bf16 v[52:55], v[132:135], v[148:151], v[52:55]
  ds_read_b128 v[124:127], v4 offset:38912
  v_mfma_f32_16x16x32_bf16 v[56:59], v[132:135], v[152:155], v[56:59]
  ds_read_b64_tr_b16 v[100:101], v13 offset:32768
  v_mfma_f32_16x16x32_bf16 v[60:63], v[132:135], v[156:159], v[60:63]
  ds_read_b64_tr_b16 v[102:103], v13 offset:33792
  v_mfma_f32_16x16x32_bf16 v[64:67], v[136:139], v[144:147], v[64:67]
  ds_read_b64_tr_b16 v[104:105], v14 offset:32768
  v_mfma_f32_16x16x32_bf16 v[68:71], v[136:139], v[148:151], v[68:71]
  ds_read_b64_tr_b16 v[106:107], v14 offset:33792
  v_mfma_f32_16x16x32_bf16 v[72:75], v[136:139], v[152:155], v[72:75]
  ds_read_b64_tr_b16 v[108:109], v15 offset:32768
  v_mfma_f32_16x16x32_bf16 v[76:79], v[136:139], v[156:159], v[76:79]
  ds_read_b64_tr_b16 v[110:111], v15 offset:33792
  v_mfma_f32_16x16x32_bf16 v[80:83], v[140:143], v[144:147], v[80:83]
  v_mfma_f32_16x16x32_bf16 v[84:87], v[140:143], v[148:151], v[84:87]
  v_mfma_f32_16x16x32_bf16 v[88:91], v[140:143], v[152:155], v[88:91]
  v_mfma_f32_16x16x32_bf16 v[92:95], v[140:143], v[156:159], v[92:95]
  s_waitcnt lgkmcnt(9)
  v_mfma_f32_16x16x32_bf16 v[32:35], v[96:99], v[112:115], v[32:35]
  ds_read_b128 v[144:147], v5 offset:32768
  s_waitcnt lgkmcnt(9)
  v_mfma_f32_16x16x32_bf16 v[36:39], v[96:99], v[116:119], v[36:39]
  ds_read_b64_tr_b16 v[128:129], v12 offset:40960
  s_waitcnt lgkmcnt(9)
  v_mfma_f32_16x16x32_bf16 v[40:43], v[96:99], v[120:123], v[40:43]
  ds_read_b64_tr_b16 v[130:131], v12 offset:41984
  s_waitcnt lgkmcnt(9)
  v_mfma_f32_16x16x32_bf16 v[44:47], v[96:99], v[124:127], v[44:47]
  ds_read_b128 v[148:151], v5 offset:34816
  s_waitcnt lgkmcnt(8)
  v_mfma_f32_16x16x32_bf16 v[48:51], v[100:103], v[112:115], v[48:51]
  ds_read_b128 v[152:155], v5 offset:36864
  v_mfma_f32_16x16x32_bf16 v[52:55], v[100:103], v[116:119], v[52:55]
  ds_read_b128 v[156:159], v5 offset:38912
  v_mfma_f32_16x16x32_bf16 v[56:59], v[100:103], v[120:123], v[56:59]
  ds_read_b64_tr_b16 v[132:133], v13 offset:40960
  v_mfma_f32_16x16x32_bf16 v[60:63], v[100:103], v[124:127], v[60:63]
  ds_read_b64_tr_b16 v[134:135], v13 offset:41984
  s_waitcnt lgkmcnt(10)
  v_mfma_f32_16x16x32_bf16 v[64:67], v[104:107], v[112:115], v[64:67]
  ds_read_b64_tr_b16 v[136:137], v14 offset:40960
  v_mfma_f32_16x16x32_bf16 v[68:71], v[104:107], v[116:119], v[68:71]
  ds_read_b64_tr_b16 v[138:139], v14 offset:41984
  v_mfma_f32_16x16x32_bf16 v[72:75], v[104:107], v[120:123], v[72:75]
  ds_read_b64_tr_b16 v[140:141], v15 offset:40960
  v_mfma_f32_16x16x32_bf16 v[76:79], v[104:107], v[124:127], v[76:79]
  ds_read_b64_tr_b16 v[142:143], v15 offset:41984
  s_waitcnt lgkmcnt(12)
  v_mfma_f32_16x16x32_bf16 v[80:83], v[108:111], v[112:115], v[80:83]
  v_mfma_f32_16x16x32_bf16 v[84:87], v[108:111], v[116:119], v[84:87]
  v_mfma_f32_16x16x32_bf16 v[88:91], v[108:111], v[120:123], v[88:91]
  v_mfma_f32_16x16x32_bf16 v[92:95], v[108:111], v[124:127], v[92:95]
  s_waitcnt lgkmcnt(0)
  s_barrier
  v_mfma_f32_16x16x32_bf16 v[32:35], v[128:131], v[144:147], v[32:35]
  ds_read_b128 v[112:115], v6 offset:0
  v_mfma_f32_16x16x32_bf16 v[36:39], v[128:131], v[148:151], v[36:39]
  ds_read_b64_tr_b16 v[96:97], v16 offset:0
  v_mfma_f32_16x16x32_bf16 v[40:43], v[128:131], v[152:155], v[40:43]
  ds_read_b64_tr_b16 v[98:99], v16 offset:1024
  v_mfma_f32_16x16x32_bf16 v[44:47], v[128:131], v[156:159], v[44:47]
  ds_read_b128 v[116:119], v6 offset:2048
  v_mfma_f32_16x16x32_bf16 v[48:51], v[132:135], v[144:147], v[48:51]
  ds_read_b128 v[120:123], v6 offset:4096
  v_mfma_f32_16x16x32_bf16 v[52:55], v[132:135], v[148:151], v[52:55]
  ds_read_b128 v[124:127], v6 offset:6144
  v_mfma_f32_16x16x32_bf16 v[56:59], v[132:135], v[152:155], v[56:59]
  ds_read_b64_tr_b16 v[100:101], v17 offset:0
  v_mfma_f32_16x16x32_bf16 v[60:63], v[132:135], v[156:159], v[60:63]
  ds_read_b64_tr_b16 v[102:103], v17 offset:1024
  v_mfma_f32_16x16x32_bf16 v[64:67], v[136:139], v[144:147], v[64:67]
  ds_read_b64_tr_b16 v[104:105], v18 offset:0
  v_mfma_f32_16x16x32_bf16 v[68:71], v[136:139], v[148:151], v[68:71]
  ds_read_b64_tr_b16 v[106:107], v18 offset:1024
  v_mfma_f32_16x16x32_bf16 v[72:75], v[136:139], v[152:155], v[72:75]
  ds_read_b64_tr_b16 v[108:109], v19 offset:0
  v_mfma_f32_16x16x32_bf16 v[76:79], v[136:139], v[156:159], v[76:79]
  ds_read_b64_tr_b16 v[110:111], v19 offset:1024
  v_mfma_f32_16x16x32_bf16 v[80:83], v[140:143], v[144:147], v[80:83]
  v_mfma_f32_16x16x32_bf16 v[84:87], v[140:143], v[148:151], v[84:87]
  v_mfma_f32_16x16x32_bf16 v[88:91], v[140:143], v[152:155], v[88:91]
  v_mfma_f32_16x16x32_bf16 v[92:95], v[140:143], v[156:159], v[92:95]
  s_waitcnt lgkmcnt(9)
  v_mfma_f32_16x16x32_bf16 v[32:35], v[96:99], v[112:115], v[32:35]
  ds_read_b128 v[144:147], v7 offset:0
  s_waitcnt lgkmcnt(9)
  v_mfma_f32_16x16x32_bf16 v[36:39], v[96:99], v[116:119], v[36:39]
  ds_read_b64_tr_b16 v[128:129], v16 offset:8192
  s_waitcnt lgkmcnt(9)
  v_mfma_f32_16x16x32_bf16 v[40:43], v[96:99], v[120:123], v[40:43]
  ds_read_b64_tr_b16 v[130:131], v16 offset:9216
  s_waitcnt lgkmcnt(9)
  v_mfma_f32_16x16x32_bf16 v[44:47], v[96:99], v[124:127], v[44:47]
  ds_read_b128 v[148:151], v7 offset:2048
  s_waitcnt lgkmcnt(8)
  v_mfma_f32_16x16x32_bf16 v[48:51], v[100:103], v[112:115], v[48:51]
  ds_read_b128 v[152:155], v7 offset:4096
  v_mfma_f32_16x16x32_bf16 v[52:55], v[100:103], v[116:119], v[52:55]
  ds_read_b128 v[156:159], v7 offset:6144
  v_mfma_f32_16x16x32_bf16 v[56:59], v[100:103], v[120:123], v[56:59]
  ds_read_b64_tr_b16 v[132:133], v17 offset:8192
  v_mfma_f32_16x16x32_bf16 v[60:63], v[100:103], v[124:127], v[60:63]
  ds_read_b64_tr_b16 v[134:135], v17 offset:9216
  s_waitcnt lgkmcnt(10)
  v_mfma_f32_16x16x32_bf16 v[64:67], v[104:107], v[112:115], v[64:67]
  ds_read_b64_tr_b16 v[136:137], v18 offset:8192
  v_mfma_f32_16x16x32_bf16 v[68:71], v[104:107], v[116:119], v[68:71]
  ds_read_b64_tr_b16 v[138:139], v18 offset:9216
  v_mfma_f32_16x16x32_bf16 v[72:75], v[104:107], v[120:123], v[72:75]
  ds_read_b64_tr_b16 v[140:141], v19 offset:8192
  v_mfma_f32_16x16x32_bf16 v[76:79], v[104:107], v[124:127], v[76:79]
  ds_read_b64_tr_b16 v[142:143], v19 offset:9216
  s_waitcnt lgkmcnt(12)
  v_mfma_f32_16x16x32_bf16 v[80:83], v[108:111], v[112:115], v[80:83]
  v_mfma_f32_16x16x32_bf16 v[84:87], v[108:111], v[116:119], v[84:87]
  v_mfma_f32_16x16x32_bf16 v[88:91], v[108:111], v[120:123], v[88:91]
  v_mfma_f32_16x16x32_bf16 v[92:95], v[108:111], v[124:127], v[92:95]
  s_waitcnt lgkmcnt(0)
  v_mfma_f32_16x16x32_bf16 v[32:35], v[128:131], v[144:147], v[32:35]
  v_mfma_f32_16x16x32_bf16 v[36:39], v[128:131], v[148:151], v[36:39]
  v_mfma_f32_16x16x32_bf16 v[40:43], v[128:131], v[152:155], v[40:43]
  v_mfma_f32_16x16x32_bf16 v[44:47], v[128:131], v[156:159], v[44:47]
  v_mfma_f32_16x16x32_bf16 v[48:51], v[132:135], v[144:147], v[48:51]
  v_mfma_f32_16x16x32_bf16 v[52:55], v[132:135], v[148:151], v[52:55]
  v_mfma_f32_16x16x32_bf16 v[56:59], v[132:135], v[152:155], v[56:59]
  v_mfma_f32_16x16x32_bf16 v[60:63], v[132:135], v[156:159], v[60:63]
  v_mfma_f32_16x16x32_bf16 v[64:67], v[136:139], v[144:147], v[64:67]
  v_mfma_f32_16x16x32_bf16 v[68:71], v[136:139], v[148:151], v[68:71]
  v_mfma_f32_16x16x32_bf16 v[72:75], v[136:139], v[152:155], v[72:75]
  v_mfma_f32_16x16x32_bf16 v[76:79], v[136:139], v[156:159], v[76:79]
  v_mfma_f32_16x16x32_bf16 v[80:83], v[140:143], v[144:147], v[80:83]
  v_mfma_f32_16x16x32_bf16 v[84:87], v[140:143], v[148:151], v[84:87]
  v_mfma_f32_16x16x32_bf16 v[88:91], v[140:143], v[152:155], v[88:91]
  v_mfma_f32_16x16x32_bf16 v[92:95], v[140:143], v[156:159], v[92:95]
  s_barrier
  v_mov_b32 v2, v254
  v_add_u32 v3, 0x8000, v254
  ds_read_b128 v[144:147], v254 offset:0
  ds_read_b128 v[148:151], v254 offset:1024
  ds_read_b128 v[128:131], v254 offset:2048
  ds_read_b128 v[132:135], v254 offset:3072
  ds_read_b128 v[152:155], v254 offset:4096
  ds_read_b128 v[156:159], v254 offset:5120
  v_mov_b32 v136, 0
  v_mov_b32 v137, 0
  v_mov_b32 v138, 0
  v_mov_b32 v139, 0
  v_mov_b32 v140, 0
  v_mov_b32 v141, 0
  v_mov_b32 v142, 0
  v_mov_b32 v143, 0
  v_cvt_pk_bf16_f32 v96, v32, v33
  v_cvt_pk_bf16_f32 v97, v34, v35
  v_cvt_pk_bf16_f32 v98, v36, v37
  v_cvt_pk_bf16_f32 v99, v38, v39
  v_cvt_pk_bf16_f32 v100, v48, v49
  v_cvt_pk_bf16_f32 v101, v50, v51
  v_cvt_pk_bf16_f32 v102, v52, v53
  v_cvt_pk_bf16_f32 v103, v54, v55
  v_cvt_pk_bf16_f32 v104, v40, v41
  v_cvt_pk_bf16_f32 v105, v42, v43
  v_cvt_pk_bf16_f32 v106, v44, v45
  v_cvt_pk_bf16_f32 v107, v46, v47
  v_cvt_pk_bf16_f32 v108, v56, v57
  v_cvt_pk_bf16_f32 v109, v58, v59
  v_cvt_pk_bf16_f32 v110, v60, v61
  v_cvt_pk_bf16_f32 v111, v62, v63
  v_cvt_pk_bf16_f32 v112, v64, v65
  v_cvt_pk_bf16_f32 v113, v66, v67
  v_cvt_pk_bf16_f32 v114, v68, v69
  v_cvt_pk_bf16_f32 v115, v70, v71
  v_cvt_pk_bf16_f32 v116, v80, v81
  v_cvt_pk_bf16_f32 v117, v82, v83
  v_cvt_pk_bf16_f32 v118, v84, v85
  v_cvt_pk_bf16_f32 v119, v86, v87
  v_cvt_pk_bf16_f32 v120, v72, v73
  v_cvt_pk_bf16_f32 v121, v74, v75
  v_cvt_pk_bf16_f32 v122, v76, v77
  v_cvt_pk_bf16_f32 v123, v78, v79
  v_cvt_pk_bf16_f32 v124, v88, v89
  v_cvt_pk_bf16_f32 v125, v90, v91
  v_cvt_pk_bf16_f32 v126, v92, v93
  v_cvt_pk_bf16_f32 v127, v94, v95
  v_mov_b32 v72, 0
  v_mov_b32 v73, 0
  v_mov_b32 v74, 0
  v_mov_b32 v75, 0
  v_mov_b32 v76, 0
  v_mov_b32 v77, 0
  v_mov_b32 v78, 0
  v_mov_b32 v79, 0
  v_permlane16_swap_b32 v96, v98
  v_permlane16_swap_b32 v97, v99
  v_permlane16_swap_b32 v100, v102
  v_permlane16_swap_b32 v101, v103
  v_permlane16_swap_b32 v104, v106
  v_permlane16_swap_b32 v105, v107
  v_permlane16_swap_b32 v108, v110
  v_permlane16_swap_b32 v109, v111
  v_permlane16_swap_b32 v112, v114
  v_permlane16_swap_b32 v113, v115
  v_permlane16_swap_b32 v116, v118
  v_permlane16_swap_b32 v117, v119
  v_permlane16_swap_b32 v120, v122
  v_permlane16_swap_b32 v121, v123
  v_permlane16_swap_b32 v124, v126
  v_permlane16_swap_b32 v125, v127
  s_mov_b32 s71, 0x8000
  s_mov_b32 s69, 6
  s_mov_b32 s67, 0
  s_waitcnt lgkmcnt(0)
  v_mfma_f32_32x32x16_bf16 v[32:47], v[144:147], v[96:99], 0
  v_mfma_f32_32x32x16_bf16 v[32:47], v[148:151], v[100:103], v[32:47]
  s_nop 7
  s_nop 3
  .p2align 6
L_attnY:
  v_mfma_f32_32x32x16_bf16 v[48:63], v[144:147], v[104:107], 0
  v_exp_f32 v32, v32
  v_exp_f32 v33, v33
  v_exp_f32 v34, v34
  v_cvt_pk_bf16_f32 v64, v32, v33
  v_mfma_f32_32x32x16_bf16 v[48:63], v[148:151], v[108:111], v[48:63]
  v_exp_f32 v35, v35
  v_exp_f32 v36, v36
  v_cvt_pk_bf16_f32 v65, v34, v35
  v_exp_f32 v37, v37
  v_mfma_f32_32x32x16_bf16 v[208:223], v[136:139], v[72:75], v[208:223]
  v_exp_f32 v38, v38
  v_cvt_pk_bf16_f32 v66, v36, v37
  v_exp_f32 v39, v39
  v_exp_f32 v40, v40
  v_mfma_f32_32x32x16_bf16 v[208:223], v[140:143], v[76:79], v[208:223]
  v_cvt_pk_bf16_f32 v67, v38, v39
  v_exp_f32 v41, v41
  v_exp_f32 v42, v42
  v_cvt_pk_bf16_f32 v68, v40, v41
  v_exp_f32 v43, v43
  v_exp_f32 v44, v44
  v_cvt_pk_bf16_f32 v69, v42, v43
  v_exp_f32 v45, v45
  v_exp_f32 v46, v46
  v_cvt_pk_bf16_f32 v70, v44, v45
  v_exp_f32 v47, v47
  v_smfmac_f32_16x16x64_bf16 v[236:239], v[240:243], v[72:79], v244
  v_cvt_pk_bf16_f32 v71, v46, v47
  v_mfma_f32_32x32x16_bf16 v[32:47], v[144:147], v[112:115], 0
  v_exp_f32 v48, v48
  v_exp_f32 v49, v49
  v_exp_f32 v50, v50
  v_cvt_pk_bf16_f32 v72, v48, v49
  v_mfma_f32_32x32x16_bf16 v[32:47], v[148:151], v[116:119], v[32:47]
  v_exp_f32 v51, v51
  v_exp_f32 v52, v52
  v_cvt_pk_bf16_f32 v73, v50, v51
  v_exp_f32 v53, v53
  s_waitcnt lgkmcnt(2)
  v_mfma_f32_32x32x16_bf16 v[160:175], v[128:131], v[64:67], v[160:175]
  v_exp_f32 v54, v54
  v_cvt_pk_bf16_f32 v74, v52, v53
  v_exp_f32 v55, v55
  v_exp_f32 v56, v56
  v_mfma_f32_32x32x16_bf16 v[160:175], v[132:135], v[68:71], v[160:175]
  v_cvt_pk_bf16_f32 v75, v54, v55
  v_exp_f32 v57, v57
  v_exp_f32 v58, v58
  v_cvt_pk_bf16_f32 v76, v56, v57
  v_exp_f32 v59, v59
  v_exp_f32 v60, v60
  v_cvt_pk_bf16_f32 v77, v58, v59
  v_exp_f32 v61, v61
  v_exp_f32 v62, v62
  v_cvt_pk_bf16_f32 v78, v60, v61
  v_exp_f32 v63, v63
  v_smfmac_f32_16x16x64_bf16 v[224:227], v[240:243], v[64:71], v244
  v_cvt_pk_bf16_f32 v79, v62, v63
  v_mfma_f32_32x32x16_bf16 v[48:63], v[144:147], v[120:123], 0
  v_exp_f32 v32, v32
  v_exp_f32 v33, v33
  v_exp_f32 v34, v34
  v_cvt_pk_bf16_f32 v64, v32, v33
  v_mfma_f32_32x32x16_bf16 v[48:63], v[148:151], v[124:127], v[48:63]
  v_exp_f32 v35, v35
  v_exp_f32 v36, v36
  v_cvt_pk_bf16_f32 v65, v34, v35
  v_exp_f32 v37, v37
  v_mfma_f32_32x32x16_bf16 v[176:191], v[128:131], v[72:75], v[176:191]
  v_exp_f32 v38, v38
  v_cvt_pk_bf16_f32 v66, v36, v37
  v_exp_f32 v39, v39
  v_exp_f32 v40, v40
  v_mfma_f32_32x32x16_bf16 v[176:191], v[132:135], v[76:79], v[176:191]
  v_cvt_pk_bf16_f32 v67, v38, v39
  v_exp_f32 v41, v41
  v_exp_f32 v42, v42
  v_cvt_pk_bf16_f32 v68, v40, v41
  v_exp_f32 v43, v43
  v_exp_f32 v44, v44
  v_cvt_pk_bf16_f32 v69, v42, v43
  v_exp_f32 v45, v45
  v_exp_f32 v46, v46
  v_cvt_pk_bf16_f32 v70, v44, v45
  v_exp_f32 v47, v47
  v_smfmac_f32_16x16x64_bf16 v[228:231], v[240:243], v[72:79], v244
  v_cvt_pk_bf16_f32 v71, v46, v47
  s_waitcnt lgkmcnt(0)
  v_mfma_f32_32x32x16_bf16 v[32:47], v[152:155], v[96:99], 0
  v_exp_f32 v48, v48
  v_exp_f32 v49, v49
  v_exp_f32 v50, v50
  v_cvt_pk_bf16_f32 v72, v48, v49
  v_mfma_f32_32x32x16_bf16 v[32:47], v[156:159], v[100:103], v[32:47]
  ds_read_b128 v[136:139], v2 offset:6144
  v_exp_f32 v51, v51
  v_exp_f32 v52, v52
  v_cvt_pk_bf16_f32 v73, v50, v51
  v_exp_f32 v53, v53
  v_mfma_f32_32x32x16_bf16 v[192:207], v[128:131], v[64:67], v[192:207]
  ds_read_b128 v[140:143], v2 offset:7168
  v_exp_f32 v54, v54
  v_cvt_pk_bf16_f32 v74, v52, v53
  v_exp_f32 v55, v55
  v_exp_f32 v56, v56
  v_mfma_f32_32x32x16_bf16 v[192:207], v[132:135], v[68:71], v[192:207]
  ds_read_b128 v[144:147], v2 offset:8192
  v_cvt_pk_bf16_f32 v75, v54, v55
  v_exp_f32 v57, v57
  v_exp_f32 v58, v58
  v_cvt_pk_bf16_f32 v76, v56, v57
  v_exp_f32 v59, v59
  v_exp_f32 v60, v60
  v_cvt_pk_bf16_f32 v77, v58, v59
  v_exp_f32 v61, v61
  v_exp_f32 v62, v62
  v_cvt_pk_bf16_f32 v78, v60, v61
  v_exp_f32 v63, v63
  v_smfmac_f32_16x16x64_bf16 v[232:235], v[240:243], v[64:71], v244
  ds_read_b128 v[148:151], v2 offset:9216
  v_cvt_pk_bf16_f32 v79, v62, v63
  v_mfma_f32_32x32x16_bf16 v[48:63], v[152:155], v[104:107], 0
  v_exp_f32 v32, v32
  v_exp_f32 v33, v33
  v_exp_f32 v34, v34
  v_cvt_pk_bf16_f32 v64, v32, v33
  v_mfma_f32_32x32x16_bf16 v[48:63], v[156:159], v[108:111], v[48:63]
  v_exp_f32 v35, v35
  v_exp_f32 v36, v36
  v_cvt_pk_bf16_f32 v65, v34, v35
  v_exp_f32 v37, v37
  v_mfma_f32_32x32x16_bf16 v[208:223], v[128:131], v[72:75], v[208:223]
  v_exp_f32 v38, v38
  v_cvt_pk_bf16_f32 v66, v36, v37
  v_exp_f32 v39, v39
  v_exp_f32 v40, v40
  v_mfma_f32_32x32x16_bf16 v[208:223], v[132:135], v[76:79], v[208:223]
  v_cvt_pk_bf16_f32 v67, v38, v39
  v_exp_f32 v41, v41
  v_exp_f32 v42, v42
  v_cvt_pk_bf16_f32 v68, v40, v41
  v_exp_f32 v43, v43
  v_exp_f32 v44, v44
  v_cvt_pk_bf16_f32 v69, v42, v43
  v_exp_f32 v45, v45
  v_exp_f32 v46, v46
  v_cvt_pk_bf16_f32 v70, v44, v45
  v_exp_f32 v47, v47
  v_smfmac_f32_16x16x64_bf16 v[236:239], v[240:243], v[72:79], v244
  v_cvt_pk_bf16_f32 v71, v46, v47
  v_mfma_f32_32x32x16_bf16 v[32:47], v[152:155], v[112:115], 0
  v_exp_f32 v48, v48
  v_exp_f32 v49, v49
  v_exp_f32 v50, v50
  v_cvt_pk_bf16_f32 v72, v48, v49
  v_mfma_f32_32x32x16_bf16 v[32:47], v[156:159], v[116:119], v[32:47]
  v_exp_f32 v51, v51
  v_exp_f32 v52, v52
  v_cvt_pk_bf16_f32 v73, v50, v51
  v_exp_f32 v53, v53
  s_waitcnt lgkmcnt(2)
  v_mfma_f32_32x32x16_bf16 v[160:175], v[136:139], v[64:67], v[160:175]
  v_exp_f32 v54, v54
  v_cvt_pk_bf16_f32 v74, v52, v53
  v_exp_f32 v55, v55
  v_exp_f32 v56, v56
  v_mfma_f32_32x32x16_bf16 v[160:175], v[140:143], v[68:71], v[160:175]
  v_cvt_pk_bf16_f32 v75, v54, v55
  v_exp_f32 v57, v57
  v_exp_f32 v58, v58
  v_cvt_pk_bf16_f32 v76, v56, v57
  v_exp_f32 v59, v59
  v_exp_f32 v60, v60
  v_cvt_pk_bf16_f32 v77, v58, v59
  v_exp_f32 v61, v61
  v_exp_f32 v62, v62
  v_cvt_pk_bf16_f32 v78, v60, v61
  v_exp_f32 v63, v63
  v_smfmac_f32_16x16x64_bf16 v[224:227], v[240:243], v[64:71], v244
  v_cvt_pk_bf16_f32 v79, v62, v63
  v_mfma_f32_32x32x16_bf16 v[48:63], v[152:155], v[120:123], 0
  v_exp_f32 v32, v32
  v_exp_f32 v33, v33
  v_exp_f32 v34, v34
  v_cvt_pk_bf16_f32 v64, v32, v33
  v_mfma_f32_32x32x16_bf16 v[48:63], v[156:159], v[124:127], v[48:63]
  v_exp_f32 v35, v35
  v_exp_f32 v36, v36
  v_cvt_pk_bf16_f32 v65, v34, v35
  v_exp_f32 v37, v37
  v_mfma_f32_32x32x16_bf16 v[176:191], v[136:139], v[72:75], v[176:191]
  v_exp_f32 v38, v38
  v_cvt_pk_bf16_f32 v66, v36, v37
  v_exp_f32 v39, v39
  v_exp_f32 v40, v40
  v_mfma_f32_32x32x16_bf16 v[176:191], v[140:143], v[76:79], v[176:191]
  v_cvt_pk_bf16_f32 v67, v38, v39
  v_exp_f32 v41, v41
  v_exp_f32 v42, v42
  v_cvt_pk_bf16_f32 v68, v40, v41
  v_exp_f32 v43, v43
  v_exp_f32 v44, v44
  v_cvt_pk_bf16_f32 v69, v42, v43
  v_exp_f32 v45, v45
  v_exp_f32 v46, v46
  v_cvt_pk_bf16_f32 v70, v44, v45
  v_exp_f32 v47, v47
  v_smfmac_f32_16x16x64_bf16 v[228:231], v[240:243], v[72:79], v244
  v_cvt_pk_bf16_f32 v71, v46, v47
  s_waitcnt lgkmcnt(0)
  v_mfma_f32_32x32x16_bf16 v[32:47], v[144:147], v[96:99], 0
  v_exp_f32 v48, v48
  v_exp_f32 v49, v49
  v_exp_f32 v50, v50
  v_cvt_pk_bf16_f32 v72, v48, v49
  v_mfma_f32_32x32x16_bf16 v[32:47], v[148:151], v[100:103], v[32:47]
  ds_read_b128 v[128:131], v2 offset:10240
  v_exp_f32 v51, v51
  v_exp_f32 v52, v52
  v_cvt_pk_bf16_f32 v73, v50, v51
  v_exp_f32 v53, v53
  v_mfma_f32_32x32x16_bf16 v[192:207], v[136:139], v[64:67], v[192:207]
  ds_read_b128 v[132:135], v2 offset:11264
  v_exp_f32 v54, v54
  v_cvt_pk_bf16_f32 v74, v52, v53
  v_exp_f32 v55, v55
  v_exp_f32 v56, v56
  v_mfma_f32_32x32x16_bf16 v[192:207], v[140:143], v[68:71], v[192:207]
  ds_read_b128 v[152:155], v2 offset:12288
  v_cvt_pk_bf16_f32 v75, v54, v55
  v_exp_f32 v57, v57
  v_exp_f32 v58, v58
  v_cvt_pk_bf16_f32 v76, v56, v57
  v_exp_f32 v59, v59
  v_exp_f32 v60, v60
  v_cvt_pk_bf16_f32 v77, v58, v59
  v_exp_f32 v61, v61
  v_exp_f32 v62, v62
  v_cvt_pk_bf16_f32 v78, v60, v61
  v_exp_f32 v63, v63
  v_smfmac_f32_16x16x64_bf16 v[232:235], v[240:243], v[64:71], v244
  ds_read_b128 v[156:159], v2 offset:13312
  v_cvt_pk_bf16_f32 v79, v62, v63
  v_mfma_f32_32x32x16_bf16 v[48:63], v[144:147], v[104:107], 0
  v_exp_f32 v32, v32
  v_exp_f32 v33, v33
  v_exp_f32 v34, v34
  v_cvt_pk_bf16_f32 v64, v32, v33
  v_mfma_f32_32x32x16_bf16 v[48:63], v[148:151], v[108:111], v[48:63]
  v_exp_f32 v35, v35
  v_exp_f32 v36, v36
  v_cvt_pk_bf16_f32 v65, v34, v35
  v_exp_f32 v37, v37
  v_mfma_f32_32x32x16_bf16 v[208:223], v[136:139], v[72:75], v[208:223]
  v_exp_f32 v38, v38
  v_cvt_pk_bf16_f32 v66, v36, v37
  v_exp_f32 v39, v39
  v_exp_f32 v40, v40
  v_mfma_f32_32x32x16_bf16 v[208:223], v[140:143], v[76:79], v[208:223]
  v_cvt_pk_bf16_f32 v67, v38, v39
  v_exp_f32 v41, v41
  v_exp_f32 v42, v42
  v_cvt_pk_bf16_f32 v68, v40, v41
  v_exp_f32 v43, v43
  v_exp_f32 v44, v44
  v_cvt_pk_bf16_f32 v69, v42, v43
  v_exp_f32 v45, v45
  v_exp_f32 v46, v46
  v_cvt_pk_bf16_f32 v70, v44, v45
  v_exp_f32 v47, v47
  v_smfmac_f32_16x16x64_bf16 v[236:239], v[240:243], v[72:79], v244
  v_cvt_pk_bf16_f32 v71, v46, v47
  v_mfma_f32_32x32x16_bf16 v[32:47], v[144:147], v[112:115], 0
  v_exp_f32 v48, v48
  v_exp_f32 v49, v49
  v_exp_f32 v50, v50
  v_cvt_pk_bf16_f32 v72, v48, v49
  v_mfma_f32_32x32x16_bf16 v[32:47], v[148:151], v[116:119], v[32:47]
  v_exp_f32 v51, v51
  v_exp_f32 v52, v52
  v_cvt_pk_bf16_f32 v73, v50, v51
  v_exp_f32 v53, v53
  s_waitcnt lgkmcnt(2)
  v_mfma_f32_32x32x16_bf16 v[160:175], v[128:131], v[64:67], v[160:175]
  v_exp_f32 v54, v54
  v_cvt_pk_bf16_f32 v74, v52, v53
  v_exp_f32 v55, v55
  v_exp_f32 v56, v56
  v_mfma_f32_32x32x16_bf16 v[160:175], v[132:135], v[68:71], v[160:175]
  v_cvt_pk_bf16_f32 v75, v54, v55
  v_exp_f32 v57, v57
  v_exp_f32 v58, v58
  v_cvt_pk_bf16_f32 v76, v56, v57
  v_exp_f32 v59, v59
  v_exp_f32 v60, v60
  v_cvt_pk_bf16_f32 v77, v58, v59
  v_exp_f32 v61, v61
  v_exp_f32 v62, v62
  v_cvt_pk_bf16_f32 v78, v60, v61
  v_exp_f32 v63, v63
  v_smfmac_f32_16x16x64_bf16 v[224:227], v[240:243], v[64:71], v244
  v_cvt_pk_bf16_f32 v79, v62, v63
  v_mfma_f32_32x32x16_bf16 v[48:63], v[144:147], v[120:123], 0
  v_exp_f32 v32, v32
  v_exp_f32 v33, v33
  v_exp_f32 v34, v34
  v_cvt_pk_bf16_f32 v64, v32, v33
  v_mfma_f32_32x32x16_bf16 v[48:63], v[148:151], v[124:127], v[48:63]
  v_exp_f32 v35, v35
  v_exp_f32 v36, v36
  v_cvt_pk_bf16_f32 v65, v34, v35
  v_exp_f32 v37, v37
  v_mfma_f32_32x32x16_bf16 v[176:191], v[128:131], v[72:75], v[176:191]
  v_exp_f32 v38, v38
  v_cvt_pk_bf16_f32 v66, v36, v37
  v_exp_f32 v39, v39
  v_exp_f32 v40, v40
  v_mfma_f32_32x32x16_bf16 v[176:191], v[132:135], v[76:79], v[176:191]
  v_cvt_pk_bf16_f32 v67, v38, v39
  v_exp_f32 v41, v41
  v_exp_f32 v42, v42
  v_cvt_pk_bf16_f32 v68, v40, v41
  v_exp_f32 v43, v43
  v_exp_f32 v44, v44
  v_cvt_pk_bf16_f32 v69, v42, v43
  v_exp_f32 v45, v45
  v_exp_f32 v46, v46
  v_cvt_pk_bf16_f32 v70, v44, v45
  v_exp_f32 v47, v47
  v_smfmac_f32_16x16x64_bf16 v[228:231], v[240:243], v[72:79], v244
  v_cvt_pk_bf16_f32 v71, v46, v47
  s_waitcnt lgkmcnt(0)
  v_mfma_f32_32x32x16_bf16 v[32:47], v[152:155], v[96:99], 0
  v_exp_f32 v48, v48
  v_exp_f32 v49, v49
  v_exp_f32 v50, v50
  v_cvt_pk_bf16_f32 v72, v48, v49
  v_mfma_f32_32x32x16_bf16 v[32:47], v[156:159], v[100:103], v[32:47]
  ds_read_b128 v[136:139], v2 offset:14336
  v_exp_f32 v51, v51
  v_exp_f32 v52, v52
  v_cvt_pk_bf16_f32 v73, v50, v51
  v_exp_f32 v53, v53
  v_mfma_f32_32x32x16_bf16 v[192:207], v[128:131], v[64:67], v[192:207]
  ds_read_b128 v[140:143], v2 offset:15360
  v_exp_f32 v54, v54
  v_cvt_pk_bf16_f32 v74, v52, v53
  v_exp_f32 v55, v55
  v_exp_f32 v56, v56
  v_mfma_f32_32x32x16_bf16 v[192:207], v[132:135], v[68:71], v[192:207]
  ds_read_b128 v[144:147], v2 offset:16384
  v_cvt_pk_bf16_f32 v75, v54, v55
  v_exp_f32 v57, v57
  v_exp_f32 v58, v58
  v_cvt_pk_bf16_f32 v76, v56, v57
  v_exp_f32 v59, v59
  v_exp_f32 v60, v60
  v_cvt_pk_bf16_f32 v77, v58, v59
  v_exp_f32 v61, v61
  v_exp_f32 v62, v62
  v_cvt_pk_bf16_f32 v78, v60, v61
  v_exp_f32 v63, v63
  v_smfmac_f32_16x16x64_bf16 v[232:235], v[240:243], v[64:71], v244
  ds_read_b128 v[148:151], v2 offset:17408
  v_cvt_pk_bf16_f32 v79, v62, v63
  v_mfma_f32_32x32x16_bf16 v[48:63], v[152:155], v[104:107], 0
  v_exp_f32 v32, v32
  v_exp_f32 v33, v33
  v_exp_f32 v34, v34
  v_cvt_pk_bf16_f32 v64, v32, v33
  v_mfma_f32_32x32x16_bf16 v[48:63], v[156:159], v[108:111], v[48:63]
  v_exp_f32 v35, v35
  v_exp_f32 v36, v36
  v_cvt_pk_bf16_f32 v65, v34, v35
  v_exp_f32 v37, v37
  v_mfma_f32_32x32x16_bf16 v[208:223], v[128:131], v[72:75], v[208:223]
  v_exp_f32 v38, v38
  v_cvt_pk_bf16_f32 v66, v36, v37
  v_exp_f32 v39, v39
  v_exp_f32 v40, v40
  v_mfma_f32_32x32x16_bf16 v[208:223], v[132:135], v[76:79], v[208:223]
  v_cvt_pk_bf16_f32 v67, v38, v39
  v_exp_f32 v41, v41
  v_exp_f32 v42, v42
  v_cvt_pk_bf16_f32 v68, v40, v41
  v_exp_f32 v43, v43
  v_exp_f32 v44, v44
  v_cvt_pk_bf16_f32 v69, v42, v43
  v_exp_f32 v45, v45
  v_exp_f32 v46, v46
  v_cvt_pk_bf16_f32 v70, v44, v45
  v_exp_f32 v47, v47
  v_smfmac_f32_16x16x64_bf16 v[236:239], v[240:243], v[72:79], v244
  v_cvt_pk_bf16_f32 v71, v46, v47
  v_mfma_f32_32x32x16_bf16 v[32:47], v[152:155], v[112:115], 0
  v_exp_f32 v48, v48
  v_exp_f32 v49, v49
  v_exp_f32 v50, v50
  v_cvt_pk_bf16_f32 v72, v48, v49
  v_mfma_f32_32x32x16_bf16 v[32:47], v[156:159], v[116:119], v[32:47]
  v_exp_f32 v51, v51
  v_exp_f32 v52, v52
  v_cvt_pk_bf16_f32 v73, v50, v51
  v_exp_f32 v53, v53
  s_waitcnt lgkmcnt(2)
  v_mfma_f32_32x32x16_bf16 v[160:175], v[136:139], v[64:67], v[160:175]
  v_exp_f32 v54, v54
  v_cvt_pk_bf16_f32 v74, v52, v53
  v_exp_f32 v55, v55
  v_exp_f32 v56, v56
  v_mfma_f32_32x32x16_bf16 v[160:175], v[140:143], v[68:71], v[160:175]
  v_cvt_pk_bf16_f32 v75, v54, v55
  v_exp_f32 v57, v57
  v_exp_f32 v58, v58
  v_cvt_pk_bf16_f32 v76, v56, v57
  v_exp_f32 v59, v59
  v_exp_f32 v60, v60
  v_cvt_pk_bf16_f32 v77, v58, v59
  v_exp_f32 v61, v61
  v_exp_f32 v62, v62
  v_cvt_pk_bf16_f32 v78, v60, v61
  v_exp_f32 v63, v63
  v_smfmac_f32_16x16x64_bf16 v[224:227], v[240:243], v[64:71], v244
  v_cvt_pk_bf16_f32 v79, v62, v63
  v_mfma_f32_32x32x16_bf16 v[48:63], v[152:155], v[120:123], 0
  v_exp_f32 v32, v32
  v_exp_f32 v33, v33
  v_exp_f32 v34, v34
  v_cvt_pk_bf16_f32 v64, v32, v33
  v_mfma_f32_32x32x16_bf16 v[48:63], v[156:159], v[124:127], v[48:63]
  v_exp_f32 v35, v35
  v_exp_f32 v36, v36
  v_cvt_pk_bf16_f32 v65, v34, v35
  v_exp_f32 v37, v37
  v_mfma_f32_32x32x16_bf16 v[176:191], v[136:139], v[72:75], v[176:191]
  v_exp_f32 v38, v38
  v_cvt_pk_bf16_f32 v66, v36, v37
  v_exp_f32 v39, v39
  v_exp_f32 v40, v40
  v_mfma_f32_32x32x16_bf16 v[176:191], v[140:143], v[76:79], v[176:191]
  v_cvt_pk_bf16_f32 v67, v38, v39
  v_exp_f32 v41, v41
  v_exp_f32 v42, v42
  v_cvt_pk_bf16_f32 v68, v40, v41
  v_exp_f32 v43, v43
  v_exp_f32 v44, v44
  v_cvt_pk_bf16_f32 v69, v42, v43
  v_exp_f32 v45, v45
  v_exp_f32 v46, v46
  v_cvt_pk_bf16_f32 v70, v44, v45
  v_exp_f32 v47, v47
  v_smfmac_f32_16x16x64_bf16 v[228:231], v[240:243], v[72:79], v244
  v_cvt_pk_bf16_f32 v71, v46, v47
  s_waitcnt lgkmcnt(0)
  v_mfma_f32_32x32x16_bf16 v[32:47], v[144:147], v[96:99], 0
  v_exp_f32 v48, v48
  v_exp_f32 v49, v49
  v_exp_f32 v50, v50
  v_cvt_pk_bf16_f32 v72, v48, v49
  v_mfma_f32_32x32x16_bf16 v[32:47], v[148:151], v[100:103], v[32:47]
  ds_read_b128 v[128:131], v2 offset:18432
  v_exp_f32 v51, v51
  v_exp_f32 v52, v52
  v_cvt_pk_bf16_f32 v73, v50, v51
  v_exp_f32 v53, v53
  v_mfma_f32_32x32x16_bf16 v[192:207], v[136:139], v[64:67], v[192:207]
  ds_read_b128 v[132:135], v2 offset:19456
  v_exp_f32 v54, v54
  v_cvt_pk_bf16_f32 v74, v52, v53
  v_exp_f32 v55, v55
  v_exp_f32 v56, v56
  v_mfma_f32_32x32x16_bf16 v[192:207], v[140:143], v[68:71], v[192:207]
  ds_read_b128 v[152:155], v2 offset:20480
  v_cvt_pk_bf16_f32 v75, v54, v55
  v_exp_f32 v57, v57
  v_exp_f32 v58, v58
  v_cvt_pk_bf16_f32 v76, v56, v57
  v_exp_f32 v59, v59
  v_exp_f32 v60, v60
  v_cvt_pk_bf16_f32 v77, v58, v59
  v_exp_f32 v61, v61
  v_exp_f32 v62, v62
  v_cvt_pk_bf16_f32 v78, v60, v61
  v_exp_f32 v63, v63
  v_smfmac_f32_16x16x64_bf16 v[232:235], v[240:243], v[64:71], v244
  ds_read_b128 v[156:159], v2 offset:21504
  v_cvt_pk_bf16_f32 v79, v62, v63
  v_mfma_f32_32x32x16_bf16 v[48:63], v[144:147], v[104:107], 0
  v_exp_f32 v32, v32
  v_exp_f32 v33, v33
  v_exp_f32 v34, v34
  v_cvt_pk_bf16_f32 v64, v32, v33
  v_mfma_f32_32x32x16_bf16 v[48:63], v[148:151], v[108:111], v[48:63]
  v_exp_f32 v35, v35
  v_exp_f32 v36, v36
  v_cvt_pk_bf16_f32 v65, v34, v35
  v_exp_f32 v37, v37
  v_mfma_f32_32x32x16_bf16 v[208:223], v[136:139], v[72:75], v[208:223]
  v_exp_f32 v38, v38
  v_cvt_pk_bf16_f32 v66, v36, v37
  v_exp_f32 v39, v39
  v_exp_f32 v40, v40
  v_mfma_f32_32x32x16_bf16 v[208:223], v[140:143], v[76:79], v[208:223]
  v_cvt_pk_bf16_f32 v67, v38, v39
  v_exp_f32 v41, v41
  v_exp_f32 v42, v42
  v_cvt_pk_bf16_f32 v68, v40, v41
  v_exp_f32 v43, v43
  v_exp_f32 v44, v44
  v_cvt_pk_bf16_f32 v69, v42, v43
  v_exp_f32 v45, v45
  v_exp_f32 v46, v46
  v_cvt_pk_bf16_f32 v70, v44, v45
  v_exp_f32 v47, v47
  v_smfmac_f32_16x16x64_bf16 v[236:239], v[240:243], v[72:79], v244
  v_cvt_pk_bf16_f32 v71, v46, v47
  v_mfma_f32_32x32x16_bf16 v[32:47], v[144:147], v[112:115], 0
  v_exp_f32 v48, v48
  v_exp_f32 v49, v49
  v_exp_f32 v50, v50
  v_cvt_pk_bf16_f32 v72, v48, v49
  v_mfma_f32_32x32x16_bf16 v[32:47], v[148:151], v[116:119], v[32:47]
  v_exp_f32 v51, v51
  v_exp_f32 v52, v52
  v_cvt_pk_bf16_f32 v73, v50, v51
  v_exp_f32 v53, v53
  s_waitcnt lgkmcnt(2)
  v_mfma_f32_32x32x16_bf16 v[160:175], v[128:131], v[64:67], v[160:175]
  v_exp_f32 v54, v54
  v_cvt_pk_bf16_f32 v74, v52, v53
  v_exp_f32 v55, v55
  v_exp_f32 v56, v56
  v_mfma_f32_32x32x16_bf16 v[160:175], v[132:135], v[68:71], v[160:175]
  v_cvt_pk_bf16_f32 v75, v54, v55
  v_exp_f32 v57, v57
  v_exp_f32 v58, v58
  v_cvt_pk_bf16_f32 v76, v56, v57
  v_exp_f32 v59, v59
  v_exp_f32 v60, v60
  v_cvt_pk_bf16_f32 v77, v58, v59
  v_exp_f32 v61, v61
  v_exp_f32 v62, v62
  v_cvt_pk_bf16_f32 v78, v60, v61
  v_exp_f32 v63, v63
  v_smfmac_f32_16x16x64_bf16 v[224:227], v[240:243], v[64:71], v244
  v_cvt_pk_bf16_f32 v79, v62, v63
  v_mfma_f32_32x32x16_bf16 v[48:63], v[144:147], v[120:123], 0
  v_exp_f32 v32, v32
  v_exp_f32 v33, v33
  v_exp_f32 v34, v34
  v_cvt_pk_bf16_f32 v64, v32, v33
  v_mfma_f32_32x32x16_bf16 v[48:63], v[148:151], v[124:127], v[48:63]
  v_exp_f32 v35, v35
  v_exp_f32 v36, v36
  v_cvt_pk_bf16_f32 v65, v34, v35
  v_exp_f32 v37, v37
  v_mfma_f32_32x32x16_bf16 v[176:191], v[128:131], v[72:75], v[176:191]
  v_exp_f32 v38, v38
  v_cvt_pk_bf16_f32 v66, v36, v37
  v_exp_f32 v39, v39
  v_exp_f32 v40, v40
  v_mfma_f32_32x32x16_bf16 v[176:191], v[132:135], v[76:79], v[176:191]
  v_cvt_pk_bf16_f32 v67, v38, v39
  v_exp_f32 v41, v41
  v_exp_f32 v42, v42
  v_cvt_pk_bf16_f32 v68, v40, v41
  v_exp_f32 v43, v43
  v_exp_f32 v44, v44
  v_cvt_pk_bf16_f32 v69, v42, v43
  v_exp_f32 v45, v45
  v_exp_f32 v46, v46
  v_cvt_pk_bf16_f32 v70, v44, v45
  v_exp_f32 v47, v47
  v_smfmac_f32_16x16x64_bf16 v[228:231], v[240:243], v[72:79], v244
  v_cvt_pk_bf16_f32 v71, v46, v47
  s_waitcnt lgkmcnt(0)
  v_mfma_f32_32x32x16_bf16 v[32:47], v[152:155], v[96:99], 0
  v_exp_f32 v48, v48
  v_exp_f32 v49, v49
  v_exp_f32 v50, v50
  v_cvt_pk_bf16_f32 v72, v48, v49
  v_mfma_f32_32x32x16_bf16 v[32:47], v[156:159], v[100:103], v[32:47]
  ds_read_b128 v[136:139], v2 offset:22528
  v_exp_f32 v51, v51
  v_exp_f32 v52, v52
  v_cvt_pk_bf16_f32 v73, v50, v51
  v_exp_f32 v53, v53
  v_mfma_f32_32x32x16_bf16 v[192:207], v[128:131], v[64:67], v[192:207]
  ds_read_b128 v[140:143], v2 offset:23552
  v_exp_f32 v54, v54
  v_cvt_pk_bf16_f32 v74, v52, v53
  v_exp_f32 v55, v55
  v_exp_f32 v56, v56
  v_mfma_f32_32x32x16_bf16 v[192:207], v[132:135], v[68:71], v[192:207]
  ds_read_b128 v[144:147], v2 offset:24576
  v_cvt_pk_bf16_f32 v75, v54, v55
  v_exp_f32 v57, v57
  v_exp_f32 v58, v58
  v_cvt_pk_bf16_f32 v76, v56, v57
  v_exp_f32 v59, v59
  v_exp_f32 v60, v60
  v_cvt_pk_bf16_f32 v77, v58, v59
  v_exp_f32 v61, v61
  v_exp_f32 v62, v62
  v_cvt_pk_bf16_f32 v78, v60, v61
  v_exp_f32 v63, v63
  v_smfmac_f32_16x16x64_bf16 v[232:235], v[240:243], v[64:71], v244
  ds_read_b128 v[148:151], v2 offset:25600
  v_cvt_pk_bf16_f32 v79, v62, v63
  v_mfma_f32_32x32x16_bf16 v[48:63], v[152:155], v[104:107], 0
  v_exp_f32 v32, v32
  v_exp_f32 v33, v33
  v_exp_f32 v34, v34
  v_cvt_pk_bf16_f32 v64, v32, v33
  v_mfma_f32_32x32x16_bf16 v[48:63], v[156:159], v[108:111], v[48:63]
  v_exp_f32 v35, v35
  v_exp_f32 v36, v36
  v_cvt_pk_bf16_f32 v65, v34, v35
  v_exp_f32 v37, v37
  v_mfma_f32_32x32x16_bf16 v[208:223], v[128:131], v[72:75], v[208:223]
  v_exp_f32 v38, v38
  v_cvt_pk_bf16_f32 v66, v36, v37
  v_exp_f32 v39, v39
  v_exp_f32 v40, v40
  v_mfma_f32_32x32x16_bf16 v[208:223], v[132:135], v[76:79], v[208:223]
  v_cvt_pk_bf16_f32 v67, v38, v39
  v_exp_f32 v41, v41
  v_exp_f32 v42, v42
  v_cvt_pk_bf16_f32 v68, v40, v41
  v_exp_f32 v43, v43
  v_exp_f32 v44, v44
  v_cvt_pk_bf16_f32 v69, v42, v43
  v_exp_f32 v45, v45
  v_exp_f32 v46, v46
  v_cvt_pk_bf16_f32 v70, v44, v45
  v_exp_f32 v47, v47
  v_smfmac_f32_16x16x64_bf16 v[236:239], v[240:243], v[72:79], v244
  v_cvt_pk_bf16_f32 v71, v46, v47
  v_mfma_f32_32x32x16_bf16 v[32:47], v[152:155], v[112:115], 0
  v_exp_f32 v48, v48
  v_exp_f32 v49, v49
  v_exp_f32 v50, v50
  v_cvt_pk_bf16_f32 v72, v48, v49
  v_mfma_f32_32x32x16_bf16 v[32:47], v[156:159], v[116:119], v[32:47]
  v_exp_f32 v51, v51
  v_exp_f32 v52, v52
  v_cvt_pk_bf16_f32 v73, v50, v51
  v_exp_f32 v53, v53
  s_waitcnt lgkmcnt(2)
  v_mfma_f32_32x32x16_bf16 v[160:175], v[136:139], v[64:67], v[160:175]
  v_exp_f32 v54, v54
  v_cvt_pk_bf16_f32 v74, v52, v53
  v_exp_f32 v55, v55
  v_exp_f32 v56, v56
  v_mfma_f32_32x32x16_bf16 v[160:175], v[140:143], v[68:71], v[160:175]
  v_cvt_pk_bf16_f32 v75, v54, v55
  v_exp_f32 v57, v57
  v_exp_f32 v58, v58
  v_cvt_pk_bf16_f32 v76, v56, v57
  v_exp_f32 v59, v59
  v_exp_f32 v60, v60
  v_cvt_pk_bf16_f32 v77, v58, v59
  v_exp_f32 v61, v61
  v_exp_f32 v62, v62
  v_cvt_pk_bf16_f32 v78, v60, v61
  v_exp_f32 v63, v63
  v_smfmac_f32_16x16x64_bf16 v[224:227], v[240:243], v[64:71], v244
  v_cvt_pk_bf16_f32 v79, v62, v63
  v_mfma_f32_32x32x16_bf16 v[48:63], v[152:155], v[120:123], 0
  v_exp_f32 v32, v32
  v_exp_f32 v33, v33
  v_exp_f32 v34, v34
  v_cvt_pk_bf16_f32 v64, v32, v33
  v_mfma_f32_32x32x16_bf16 v[48:63], v[156:159], v[124:127], v[48:63]
  v_exp_f32 v35, v35
  v_exp_f32 v36, v36
  v_cvt_pk_bf16_f32 v65, v34, v35
  v_exp_f32 v37, v37
  v_mfma_f32_32x32x16_bf16 v[176:191], v[136:139], v[72:75], v[176:191]
  v_exp_f32 v38, v38
  v_cvt_pk_bf16_f32 v66, v36, v37
  v_exp_f32 v39, v39
  v_exp_f32 v40, v40
  v_mfma_f32_32x32x16_bf16 v[176:191], v[140:143], v[76:79], v[176:191]
  v_cvt_pk_bf16_f32 v67, v38, v39
  v_exp_f32 v41, v41
  v_exp_f32 v42, v42
  v_cvt_pk_bf16_f32 v68, v40, v41
  v_exp_f32 v43, v43
  v_exp_f32 v44, v44
  v_cvt_pk_bf16_f32 v69, v42, v43
  v_exp_f32 v45, v45
  v_exp_f32 v46, v46
  v_cvt_pk_bf16_f32 v70, v44, v45
  v_exp_f32 v47, v47
  v_smfmac_f32_16x16x64_bf16 v[228:231], v[240:243], v[72:79], v244
  v_cvt_pk_bf16_f32 v71, v46, v47
  s_waitcnt lgkmcnt(0)
  v_mfma_f32_32x32x16_bf16 v[32:47], v[144:147], v[96:99], 0
  v_exp_f32 v48, v48
  v_exp_f32 v49, v49
  v_exp_f32 v50, v50
  v_cvt_pk_bf16_f32 v72, v48, v49
  v_mfma_f32_32x32x16_bf16 v[32:47], v[148:151], v[100:103], v[32:47]
  ds_read_b128 v[128:131], v2 offset:26624
  v_exp_f32 v51, v51
  v_exp_f32 v52, v52
  v_cvt_pk_bf16_f32 v73, v50, v51
  v_exp_f32 v53, v53
  v_mfma_f32_32x32x16_bf16 v[192:207], v[136:139], v[64:67], v[192:207]
  ds_read_b128 v[132:135], v2 offset:27648
  v_exp_f32 v54, v54
  v_cvt_pk_bf16_f32 v74, v52, v53
  v_exp_f32 v55, v55
  v_exp_f32 v56, v56
  v_mfma_f32_32x32x16_bf16 v[192:207], v[140:143], v[68:71], v[192:207]
  ds_read_b128 v[152:155], v2 offset:28672
  v_cvt_pk_bf16_f32 v75, v54, v55
  v_exp_f32 v57, v57
  v_exp_f32 v58, v58
  v_cvt_pk_bf16_f32 v76, v56, v57
  v_exp_f32 v59, v59
  v_exp_f32 v60, v60
  v_cvt_pk_bf16_f32 v77, v58, v59
  v_exp_f32 v61, v61
  v_exp_f32 v62, v62
  v_cvt_pk_bf16_f32 v78, v60, v61
  v_exp_f32 v63, v63
  v_smfmac_f32_16x16x64_bf16 v[232:235], v[240:243], v[64:71], v244
  ds_read_b128 v[156:159], v2 offset:29696
  v_cvt_pk_bf16_f32 v79, v62, v63
  v_mfma_f32_32x32x16_bf16 v[48:63], v[144:147], v[104:107], 0
  v_exp_f32 v32, v32
  v_exp_f32 v33, v33
  v_exp_f32 v34, v34
  v_cvt_pk_bf16_f32 v64, v32, v33
  v_mfma_f32_32x32x16_bf16 v[48:63], v[148:151], v[108:111], v[48:63]
  v_exp_f32 v35, v35
  v_exp_f32 v36, v36
  v_cvt_pk_bf16_f32 v65, v34, v35
  v_exp_f32 v37, v37
  v_mfma_f32_32x32x16_bf16 v[208:223], v[136:139], v[72:75], v[208:223]
  v_exp_f32 v38, v38
  v_cvt_pk_bf16_f32 v66, v36, v37
  v_exp_f32 v39, v39
  v_exp_f32 v40, v40
  v_mfma_f32_32x32x16_bf16 v[208:223], v[140:143], v[76:79], v[208:223]
  v_cvt_pk_bf16_f32 v67, v38, v39
  v_exp_f32 v41, v41
  v_exp_f32 v42, v42
  v_cvt_pk_bf16_f32 v68, v40, v41
  v_exp_f32 v43, v43
  v_exp_f32 v44, v44
  v_cvt_pk_bf16_f32 v69, v42, v43
  v_exp_f32 v45, v45
  v_exp_f32 v46, v46
  v_cvt_pk_bf16_f32 v70, v44, v45
  v_exp_f32 v47, v47
  v_smfmac_f32_16x16x64_bf16 v[236:239], v[240:243], v[72:79], v244
  v_cvt_pk_bf16_f32 v71, v46, v47
  v_mfma_f32_32x32x16_bf16 v[32:47], v[144:147], v[112:115], 0
  v_exp_f32 v48, v48
  v_exp_f32 v49, v49
  v_exp_f32 v50, v50
  v_cvt_pk_bf16_f32 v72, v48, v49
  v_mfma_f32_32x32x16_bf16 v[32:47], v[148:151], v[116:119], v[32:47]
  v_exp_f32 v51, v51
  v_exp_f32 v52, v52
  v_cvt_pk_bf16_f32 v73, v50, v51
  v_exp_f32 v53, v53
  s_waitcnt lgkmcnt(2)
  v_mfma_f32_32x32x16_bf16 v[160:175], v[128:131], v[64:67], v[160:175]
  v_exp_f32 v54, v54
  v_cvt_pk_bf16_f32 v74, v52, v53
  v_exp_f32 v55, v55
  v_exp_f32 v56, v56
  v_mfma_f32_32x32x16_bf16 v[160:175], v[132:135], v[68:71], v[160:175]
  v_cvt_pk_bf16_f32 v75, v54, v55
  v_exp_f32 v57, v57
  v_exp_f32 v58, v58
  v_cvt_pk_bf16_f32 v76, v56, v57
  v_exp_f32 v59, v59
  v_exp_f32 v60, v60
  v_cvt_pk_bf16_f32 v77, v58, v59
  v_exp_f32 v61, v61
  v_exp_f32 v62, v62
  v_cvt_pk_bf16_f32 v78, v60, v61
  v_exp_f32 v63, v63
  v_smfmac_f32_16x16x64_bf16 v[224:227], v[240:243], v[64:71], v244
  v_cvt_pk_bf16_f32 v79, v62, v63
  v_mfma_f32_32x32x16_bf16 v[48:63], v[144:147], v[120:123], 0
  v_exp_f32 v32, v32
  v_exp_f32 v33, v33
  v_exp_f32 v34, v34
  v_cvt_pk_bf16_f32 v64, v32, v33
  v_mfma_f32_32x32x16_bf16 v[48:63], v[148:151], v[124:127], v[48:63]
  v_exp_f32 v35, v35
  v_exp_f32 v36, v36
  v_cvt_pk_bf16_f32 v65, v34, v35
  v_exp_f32 v37, v37
  v_mfma_f32_32x32x16_bf16 v[176:191], v[128:131], v[72:75], v[176:191]
  v_exp_f32 v38, v38
  v_cvt_pk_bf16_f32 v66, v36, v37
  v_exp_f32 v39, v39
  v_exp_f32 v40, v40
  v_mfma_f32_32x32x16_bf16 v[176:191], v[132:135], v[76:79], v[176:191]
  v_cvt_pk_bf16_f32 v67, v38, v39
  v_exp_f32 v41, v41
  v_exp_f32 v42, v42
  v_cvt_pk_bf16_f32 v68, v40, v41
  v_exp_f32 v43, v43
  v_exp_f32 v44, v44
  v_cvt_pk_bf16_f32 v69, v42, v43
  v_exp_f32 v45, v45
  v_exp_f32 v46, v46
  v_cvt_pk_bf16_f32 v70, v44, v45
  v_exp_f32 v47, v47
  v_smfmac_f32_16x16x64_bf16 v[228:231], v[240:243], v[72:79], v244
  v_cvt_pk_bf16_f32 v71, v46, v47
  s_waitcnt lgkmcnt(0)
  v_mfma_f32_32x32x16_bf16 v[32:47], v[152:155], v[96:99], 0
  v_exp_f32 v48, v48
  v_exp_f32 v49, v49
  v_exp_f32 v50, v50
  v_cvt_pk_bf16_f32 v72, v48, v49
  v_mfma_f32_32x32x16_bf16 v[32:47], v[156:159], v[100:103], v[32:47]
  s_barrier
  ds_read_b128 v[136:139], v2 offset:30720
  v_exp_f32 v51, v51
  v_exp_f32 v52, v52
  v_cvt_pk_bf16_f32 v73, v50, v51
  v_exp_f32 v53, v53
  v_mfma_f32_32x32x16_bf16 v[192:207], v[128:131], v[64:67], v[192:207]
  ds_read_b128 v[140:143], v2 offset:31744
  v_exp_f32 v54, v54
  v_cvt_pk_bf16_f32 v74, v52, v53
  v_exp_f32 v55, v55
  v_exp_f32 v56, v56
  v_mfma_f32_32x32x16_bf16 v[192:207], v[132:135], v[68:71], v[192:207]
  ds_read_b128 v[144:147], v3 offset:0
  v_cvt_pk_bf16_f32 v75, v54, v55
  v_exp_f32 v57, v57
  v_exp_f32 v58, v58
  v_cvt_pk_bf16_f32 v76, v56, v57
  v_exp_f32 v59, v59
  v_exp_f32 v60, v60
  v_cvt_pk_bf16_f32 v77, v58, v59
  v_exp_f32 v61, v61
  v_exp_f32 v62, v62
  v_cvt_pk_bf16_f32 v78, v60, v61
  v_exp_f32 v63, v63
  v_smfmac_f32_16x16x64_bf16 v[232:235], v[240:243], v[64:71], v244
  ds_read_b128 v[148:151], v3 offset:1024
  v_cvt_pk_bf16_f32 v79, v62, v63
  v_mfma_f32_32x32x16_bf16 v[48:63], v[152:155], v[104:107], 0
  v_exp_f32 v32, v32
  v_exp_f32 v33, v33
  v_exp_f32 v34, v34
  v_cvt_pk_bf16_f32 v64, v32, v33
  v_mfma_f32_32x32x16_bf16 v[48:63], v[156:159], v[108:111], v[48:63]
  s_cmp_eq_u32 s71, 0x8000
  s_cselect_b32 s30, 0x20000, 0
  s_cmp_eq_u32 s71, 0
  s_cselect_b32 s71, 0x8000, s30
  v_exp_f32 v35, v35
  v_exp_f32 v36, v36
  v_cvt_pk_bf16_f32 v65, v34, v35
  v_exp_f32 v37, v37
  v_mfma_f32_32x32x16_bf16 v[208:223], v[128:131], v[72:75], v[208:223]
  v_exp_f32 v38, v38
  v_cvt_pk_bf16_f32 v66, v36, v37
  v_exp_f32 v39, v39
  v_exp_f32 v40, v40
  v_mfma_f32_32x32x16_bf16 v[208:223], v[132:135], v[76:79], v[208:223]
  v_cvt_pk_bf16_f32 v67, v38, v39
  v_exp_f32 v41, v41
  v_exp_f32 v42, v42
  v_cvt_pk_bf16_f32 v68, v40, v41
  v_exp_f32 v43, v43
  v_exp_f32 v44, v44
  v_cvt_pk_bf16_f32 v69, v42, v43
  v_exp_f32 v45, v45
  v_exp_f32 v46, v46
  v_cvt_pk_bf16_f32 v70, v44, v45
  v_exp_f32 v47, v47
  v_smfmac_f32_16x16x64_bf16 v[236:239], v[240:243], v[72:79], v244
  v_cvt_pk_bf16_f32 v71, v46, v47
  v_mfma_f32_32x32x16_bf16 v[32:47], v[152:155], v[112:115], 0
  v_exp_f32 v48, v48
  v_exp_f32 v49, v49
  v_exp_f32 v50, v50
  v_cvt_pk_bf16_f32 v72, v48, v49
  v_mfma_f32_32x32x16_bf16 v[32:47], v[156:159], v[116:119], v[32:47]
  v_exp_f32 v51, v51
  v_exp_f32 v52, v52
  v_cvt_pk_bf16_f32 v73, v50, v51
  v_exp_f32 v53, v53
  s_waitcnt lgkmcnt(2)
  v_mfma_f32_32x32x16_bf16 v[160:175], v[136:139], v[64:67], v[160:175]
  v_exp_f32 v54, v54
  v_cvt_pk_bf16_f32 v74, v52, v53
  v_exp_f32 v55, v55
  v_exp_f32 v56, v56
  v_mfma_f32_32x32x16_bf16 v[160:175], v[140:143], v[68:71], v[160:175]
  v_cvt_pk_bf16_f32 v75, v54, v55
  v_exp_f32 v57, v57
  v_exp_f32 v58, v58
  v_cvt_pk_bf16_f32 v76, v56, v57
  v_exp_f32 v59, v59
  v_exp_f32 v60, v60
  v_cvt_pk_bf16_f32 v77, v58, v59
  v_exp_f32 v61, v61
  v_exp_f32 v62, v62
  v_cvt_pk_bf16_f32 v78, v60, v61
  v_exp_f32 v63, v63
  v_smfmac_f32_16x16x64_bf16 v[224:227], v[240:243], v[64:71], v244
  v_cvt_pk_bf16_f32 v79, v62, v63
  v_mfma_f32_32x32x16_bf16 v[48:63], v[152:155], v[120:123], 0
  v_exp_f32 v32, v32
  v_exp_f32 v33, v33
  v_exp_f32 v34, v34
  v_cvt_pk_bf16_f32 v64, v32, v33
  v_mfma_f32_32x32x16_bf16 v[48:63], v[156:159], v[124:127], v[48:63]
  v_exp_f32 v35, v35
  v_exp_f32 v36, v36
  v_cvt_pk_bf16_f32 v65, v34, v35
  v_exp_f32 v37, v37
  v_mfma_f32_32x32x16_bf16 v[176:191], v[136:139], v[72:75], v[176:191]
  v_exp_f32 v38, v38
  v_cvt_pk_bf16_f32 v66, v36, v37
  v_exp_f32 v39, v39
  v_exp_f32 v40, v40
  v_mfma_f32_32x32x16_bf16 v[176:191], v[140:143], v[76:79], v[176:191]
  v_cvt_pk_bf16_f32 v67, v38, v39
  v_exp_f32 v41, v41
  v_exp_f32 v42, v42
  v_cvt_pk_bf16_f32 v68, v40, v41
  v_exp_f32 v43, v43
  v_exp_f32 v44, v44
  v_cvt_pk_bf16_f32 v69, v42, v43
  v_exp_f32 v45, v45
  v_exp_f32 v46, v46
  v_cvt_pk_bf16_f32 v70, v44, v45
  v_exp_f32 v47, v47
  v_smfmac_f32_16x16x64_bf16 v[228:231], v[240:243], v[72:79], v244
  v_cvt_pk_bf16_f32 v71, v46, v47
  s_waitcnt lgkmcnt(0)
  v_mfma_f32_32x32x16_bf16 v[32:47], v[144:147], v[96:99], 0
  s_sub_u32 s69, s69, 1
  s_cmp_lg_u32 s69, 0
  v_exp_f32 v48, v48
  v_exp_f32 v49, v49
  v_exp_f32 v50, v50
  v_cvt_pk_bf16_f32 v72, v48, v49
  v_mfma_f32_32x32x16_bf16 v[32:47], v[148:151], v[100:103], v[32:47]
  ds_read_b128 v[128:131], v3 offset:2048
  v_exp_f32 v51, v51
  v_exp_f32 v52, v52
  v_cvt_pk_bf16_f32 v73, v50, v51
  v_exp_f32 v53, v53
  v_mfma_f32_32x32x16_bf16 v[192:207], v[136:139], v[64:67], v[192:207]
  ds_read_b128 v[132:135], v3 offset:3072
  v_exp_f32 v54, v54
  v_cvt_pk_bf16_f32 v74, v52, v53
  v_exp_f32 v55, v55
  v_exp_f32 v56, v56
  v_mfma_f32_32x32x16_bf16 v[192:207], v[140:143], v[68:71], v[192:207]
  ds_read_b128 v[152:155], v3 offset:4096
  v_cvt_pk_bf16_f32 v75, v54, v55
  v_exp_f32 v57, v57
  v_exp_f32 v58, v58
  v_cvt_pk_bf16_f32 v76, v56, v57
  v_exp_f32 v59, v59
  v_exp_f32 v60, v60
  v_cvt_pk_bf16_f32 v77, v58, v59
  v_exp_f32 v61, v61
  v_exp_f32 v62, v62
  v_cvt_pk_bf16_f32 v78, v60, v61
  v_exp_f32 v63, v63
  v_smfmac_f32_16x16x64_bf16 v[232:235], v[240:243], v[64:71], v244
  ds_read_b128 v[156:159], v3 offset:5120
  v_cvt_pk_bf16_f32 v79, v62, v63
  v_mov_b32 v2, v3
  v_add_u32 v3, s71, v254
  s_cbranch_scc1 L_attnY
  s_nop 0
  v_mfma_f32_32x32x16_bf16 v[208:223], v[136:139], v[72:75], v[208:223]
  v_mfma_f32_32x32x16_bf16 v[208:223], v[140:143], v[76:79], v[208:223]
  v_smfmac_f32_16x16x64_bf16 v[236:239], v[240:243], v[72:79], v244
  v_mov_b32 v72, 0
  v_mov_b32 v73, 0
  v_mov_b32 v74, 0
  v_mov_b32 v75, 0
  v_mov_b32 v76, 0
  v_mov_b32 v77, 0
  v_mov_b32 v78, 0
  v_mov_b32 v79, 0
  s_mov_b32 s69, 2
  s_nop 1
  .p2align 6
L_attnX:
  v_mfma_f32_32x32x16_bf16 v[48:63], v[144:147], v[104:107], 0
  v_exp_f32 v32, v32
  v_exp_f32 v33, v33
  v_exp_f32 v34, v34
  v_cvt_pk_bf16_f32 v64, v32, v33
  v_mfma_f32_32x32x16_bf16 v[48:63], v[148:151], v[108:111], v[48:63]
  v_exp_f32 v35, v35
  v_exp_f32 v36, v36
  v_cvt_pk_bf16_f32 v65, v34, v35
  v_exp_f32 v37, v37
  v_mfma_f32_32x32x16_bf16 v[176:191], v[136:139], v[72:75], v[176:191]
  v_exp_f32 v38, v38
  v_cvt_pk_bf16_f32 v66, v36, v37
  v_exp_f32 v39, v39
  v_exp_f32 v40, v40
  v_mfma_f32_32x32x16_bf16 v[176:191], v[140:143], v[76:79], v[176:191]
  v_cvt_pk_bf16_f32 v67, v38, v39
  v_exp_f32 v41, v41
  v_exp_f32 v42, v42
  v_cvt_pk_bf16_f32 v68, v40, v41
  v_exp_f32 v43, v43
  v_exp_f32 v44, v44
  v_cvt_pk_bf16_f32 v69, v42, v43
  v_exp_f32 v45, v45
  v_exp_f32 v46, v46
  v_cvt_pk_bf16_f32 v70, v44, v45
  v_exp_f32 v47, v47
  v_smfmac_f32_16x16x64_bf16 v[228:231], v[240:243], v[72:79], v244
  v_cvt_pk_bf16_f32 v71, v46, v47
  s_waitcnt lgkmcnt(0)
  v_mfma_f32_32x32x16_bf16 v[32:47], v[152:155], v[96:99], 0
  v_exp_f32 v48, v48
  v_exp_f32 v49, v49
  v_exp_f32 v50, v50
  v_cvt_pk_bf16_f32 v72, v48, v49
  v_mfma_f32_32x32x16_bf16 v[32:47], v[156:159], v[100:103], v[32:47]
  ds_read_b128 v[136:139], v2 offset:6144
  v_exp_f32 v51, v51
  v_exp_f32 v52, v52
  v_cvt_pk_bf16_f32 v73, v50, v51
  v_exp_f32 v53, v53
  v_mfma_f32_32x32x16_bf16 v[160:175], v[128:131], v[64:67], v[160:175]
  ds_read_b128 v[140:143], v2 offset:7168
  v_exp_f32 v54, v54
  v_cvt_pk_bf16_f32 v74, v52, v53
  v_exp_f32 v55, v55
  v_exp_f32 v56, v56
  v_mfma_f32_32x32x16_bf16 v[160:175], v[132:135], v[68:71], v[160:175]
  ds_read_b128 v[144:147], v2 offset:8192
  v_cvt_pk_bf16_f32 v75, v54, v55
  v_exp_f32 v57, v57
  v_exp_f32 v58, v58
  v_cvt_pk_bf16_f32 v76, v56, v57
  v_exp_f32 v59, v59
  v_exp_f32 v60, v60
  v_cvt_pk_bf16_f32 v77, v58, v59
  v_exp_f32 v61, v61
  v_exp_f32 v62, v62
  v_cvt_pk_bf16_f32 v78, v60, v61
  v_exp_f32 v63, v63
  v_smfmac_f32_16x16x64_bf16 v[224:227], v[240:243], v[64:71], v244
  ds_read_b128 v[148:151], v2 offset:9216
  v_cvt_pk_bf16_f32 v79, v62, v63
  v_mfma_f32_32x32x16_bf16 v[48:63], v[152:155], v[104:107], 0
  v_exp_f32 v32, v32
  v_exp_f32 v33, v33
  v_exp_f32 v34, v34
  v_cvt_pk_bf16_f32 v64, v32, v33
  v_mfma_f32_32x32x16_bf16 v[48:63], v[156:159], v[108:111], v[48:63]
  v_exp_f32 v35, v35
  v_exp_f32 v36, v36
  v_cvt_pk_bf16_f32 v65, v34, v35
  v_exp_f32 v37, v37
  v_mfma_f32_32x32x16_bf16 v[176:191], v[128:131], v[72:75], v[176:191]
  v_exp_f32 v38, v38
  v_cvt_pk_bf16_f32 v66, v36, v37
  v_exp_f32 v39, v39
  v_exp_f32 v40, v40
  v_mfma_f32_32x32x16_bf16 v[176:191], v[132:135], v[76:79], v[176:191]
  v_cvt_pk_bf16_f32 v67, v38, v39
  v_exp_f32 v41, v41
  v_exp_f32 v42, v42
  v_cvt_pk_bf16_f32 v68, v40, v41
  v_exp_f32 v43, v43
  v_exp_f32 v44, v44
  v_cvt_pk_bf16_f32 v69, v42, v43
  v_exp_f32 v45, v45
  v_exp_f32 v46, v46
  v_cvt_pk_bf16_f32 v70, v44, v45
  v_exp_f32 v47, v47
  v_smfmac_f32_16x16x64_bf16 v[228:231], v[240:243], v[72:79], v244
  v_cvt_pk_bf16_f32 v71, v46, v47
  s_waitcnt lgkmcnt(0)
  v_mfma_f32_32x32x16_bf16 v[32:47], v[144:147], v[96:99], 0
  v_exp_f32 v48, v48
  v_exp_f32 v49, v49
  v_exp_f32 v50, v50
  v_cvt_pk_bf16_f32 v72, v48, v49
  v_mfma_f32_32x32x16_bf16 v[32:47], v[148:151], v[100:103], v[32:47]
  ds_read_b128 v[128:131], v2 offset:10240
  v_exp_f32 v51, v51
  v_exp_f32 v52, v52
  v_cvt_pk_bf16_f32 v73, v50, v51
  v_exp_f32 v53, v53
  v_mfma_f32_32x32x16_bf16 v[160:175], v[136:139], v[64:67], v[160:175]
  ds_read_b128 v[132:135], v2 offset:11264
  v_exp_f32 v54, v54
  v_cvt_pk_bf16_f32 v74, v52, v53
  v_exp_f32 v55, v55
  v_exp_f32 v56, v56
  v_mfma_f32_32x32x16_bf16 v[160:175], v[140:143], v[68:71], v[160:175]
  ds_read_b128 v[152:155], v2 offset:12288
  v_cvt_pk_bf16_f32 v75, v54, v55
  v_exp_f32 v57, v57
  v_exp_f32 v58, v58
  v_cvt_pk_bf16_f32 v76, v56, v57
  v_exp_f32 v59, v59
  v_exp_f32 v60, v60
  v_cvt_pk_bf16_f32 v77, v58, v59
  v_exp_f32 v61, v61
  v_exp_f32 v62, v62
  v_cvt_pk_bf16_f32 v78, v60, v61
  v_exp_f32 v63, v63
  v_smfmac_f32_16x16x64_bf16 v[224:227], v[240:243], v[64:71], v244
  ds_read_b128 v[156:159], v2 offset:13312
  v_cvt_pk_bf16_f32 v79, v62, v63
  v_mfma_f32_32x32x16_bf16 v[48:63], v[144:147], v[104:107], 0
  v_exp_f32 v32, v32
  v_exp_f32 v33, v33
  v_exp_f32 v34, v34
  v_cvt_pk_bf16_f32 v64, v32, v33
  v_mfma_f32_32x32x16_bf16 v[48:63], v[148:151], v[108:111], v[48:63]
  v_exp_f32 v35, v35
  v_exp_f32 v36, v36
  v_cvt_pk_bf16_f32 v65, v34, v35
  v_exp_f32 v37, v37
  v_mfma_f32_32x32x16_bf16 v[176:191], v[136:139], v[72:75], v[176:191]
  v_exp_f32 v38, v38
  v_cvt_pk_bf16_f32 v66, v36, v37
  v_exp_f32 v39, v39
  v_exp_f32 v40, v40
  v_mfma_f32_32x32x16_bf16 v[176:191], v[140:143], v[76:79], v[176:191]
  v_cvt_pk_bf16_f32 v67, v38, v39
  v_exp_f32 v41, v41
  v_exp_f32 v42, v42
  v_cvt_pk_bf16_f32 v68, v40, v41
  v_exp_f32 v43, v43
  v_exp_f32 v44, v44
  v_cvt_pk_bf16_f32 v69, v42, v43
  v_exp_f32 v45, v45
  v_exp_f32 v46, v46
  v_cvt_pk_bf16_f32 v70, v44, v45
  v_exp_f32 v47, v47
  v_smfmac_f32_16x16x64_bf16 v[228:231], v[240:243], v[72:79], v244
  v_cvt_pk_bf16_f32 v71, v46, v47
  s_waitcnt lgkmcnt(0)
  v_mfma_f32_32x32x16_bf16 v[32:47], v[152:155], v[96:99], 0
  v_exp_f32 v48, v48
  v_exp_f32 v49, v49
  v_exp_f32 v50, v50
  v_cvt_pk_bf16_f32 v72, v48, v49
  v_mfma_f32_32x32x16_bf16 v[32:47], v[156:159], v[100:103], v[32:47]
  ds_read_b128 v[136:139], v2 offset:14336
  v_exp_f32 v51, v51
  v_exp_f32 v52, v52
  v_cvt_pk_bf16_f32 v73, v50, v51
  v_exp_f32 v53, v53
  v_mfma_f32_32x32x16_bf16 v[160:175], v[128:131], v[64:67], v[160:175]
  ds_read_b128 v[140:143], v2 offset:15360
  v_exp_f32 v54, v54
  v_cvt_pk_bf16_f32 v74, v52, v53
  v_exp_f32 v55, v55
  v_exp_f32 v56, v56
  v_mfma_f32_32x32x16_bf16 v[160:175], v[132:135], v[68:71], v[160:175]
  ds_read_b128 v[144:147], v2 offset:16384
  v_cvt_pk_bf16_f32 v75, v54, v55
  v_exp_f32 v57, v57
  v_exp_f32 v58, v58
  v_cvt_pk_bf16_f32 v76, v56, v57
  v_exp_f32 v59, v59
  v_exp_f32 v60, v60
  v_cvt_pk_bf16_f32 v77, v58, v59
  v_exp_f32 v61, v61
  v_exp_f32 v62, v62
  v_cvt_pk_bf16_f32 v78, v60, v61
  v_exp_f32 v63, v63
  v_smfmac_f32_16x16x64_bf16 v[224:227], v[240:243], v[64:71], v244
  ds_read_b128 v[148:151], v2 offset:17408
  v_cvt_pk_bf16_f32 v79, v62, v63
  v_mfma_f32_32x32x16_bf16 v[48:63], v[152:155], v[104:107], 0
  v_exp_f32 v32, v32
  v_exp_f32 v33, v33
  v_exp_f32 v34, v34
  v_cvt_pk_bf16_f32 v64, v32, v33
  v_mfma_f32_32x32x16_bf16 v[48:63], v[156:159], v[108:111], v[48:63]
  v_exp_f32 v35, v35
  v_exp_f32 v36, v36
  v_cvt_pk_bf16_f32 v65, v34, v35
  v_exp_f32 v37, v37
  v_mfma_f32_32x32x16_bf16 v[176:191], v[128:131], v[72:75], v[176:191]
  v_exp_f32 v38, v38
  v_cvt_pk_bf16_f32 v66, v36, v37
  v_exp_f32 v39, v39
  v_exp_f32 v40, v40
  v_mfma_f32_32x32x16_bf16 v[176:191], v[132:135], v[76:79], v[176:191]
  v_cvt_pk_bf16_f32 v67, v38, v39
  v_exp_f32 v41, v41
  v_exp_f32 v42, v42
  v_cvt_pk_bf16_f32 v68, v40, v41
  v_exp_f32 v43, v43
  v_exp_f32 v44, v44
  v_cvt_pk_bf16_f32 v69, v42, v43
  v_exp_f32 v45, v45
  v_exp_f32 v46, v46
  v_cvt_pk_bf16_f32 v70, v44, v45
  v_exp_f32 v47, v47
  v_smfmac_f32_16x16x64_bf16 v[228:231], v[240:243], v[72:79], v244
  v_cvt_pk_bf16_f32 v71, v46, v47
  s_waitcnt lgkmcnt(0)
  v_mfma_f32_32x32x16_bf16 v[32:47], v[144:147], v[96:99], 0
  v_exp_f32 v48, v48
  v_exp_f32 v49, v49
  v_exp_f32 v50, v50
  v_cvt_pk_bf16_f32 v72, v48, v49
  v_mfma_f32_32x32x16_bf16 v[32:47], v[148:151], v[100:103], v[32:47]
  ds_read_b128 v[128:131], v2 offset:18432
  v_exp_f32 v51, v51
  v_exp_f32 v52, v52
  v_cvt_pk_bf16_f32 v73, v50, v51
  v_exp_f32 v53, v53
  v_mfma_f32_32x32x16_bf16 v[160:175], v[136:139], v[64:67], v[160:175]
  ds_read_b128 v[132:135], v2 offset:19456
  v_exp_f32 v54, v54
  v_cvt_pk_bf16_f32 v74, v52, v53
  v_exp_f32 v55, v55
  v_exp_f32 v56, v56
  v_mfma_f32_32x32x16_bf16 v[160:175], v[140:143], v[68:71], v[160:175]
  ds_read_b128 v[152:155], v2 offset:20480
  v_cvt_pk_bf16_f32 v75, v54, v55
  v_exp_f32 v57, v57
  v_exp_f32 v58, v58
  v_cvt_pk_bf16_f32 v76, v56, v57
  v_exp_f32 v59, v59
  v_exp_f32 v60, v60
  v_cvt_pk_bf16_f32 v77, v58, v59
  v_exp_f32 v61, v61
  v_exp_f32 v62, v62
  v_cvt_pk_bf16_f32 v78, v60, v61
  v_exp_f32 v63, v63
  v_smfmac_f32_16x16x64_bf16 v[224:227], v[240:243], v[64:71], v244
  ds_read_b128 v[156:159], v2 offset:21504
  v_cvt_pk_bf16_f32 v79, v62, v63
  v_mfma_f32_32x32x16_bf16 v[48:63], v[144:147], v[104:107], 0
  v_exp_f32 v32, v32
  v_exp_f32 v33, v33
  v_exp_f32 v34, v34
  v_cvt_pk_bf16_f32 v64, v32, v33
  v_mfma_f32_32x32x16_bf16 v[48:63], v[148:151], v[108:111], v[48:63]
  v_exp_f32 v35, v35
  v_exp_f32 v36, v36
  v_cvt_pk_bf16_f32 v65, v34, v35
  v_exp_f32 v37, v37
  v_mfma_f32_32x32x16_bf16 v[176:191], v[136:139], v[72:75], v[176:191]
  v_exp_f32 v38, v38
  v_cvt_pk_bf16_f32 v66, v36, v37
  v_exp_f32 v39, v39
  v_exp_f32 v40, v40
  v_mfma_f32_32x32x16_bf16 v[176:191], v[140:143], v[76:79], v[176:191]
  v_cvt_pk_bf16_f32 v67, v38, v39
  v_exp_f32 v41, v41
  v_exp_f32 v42, v42
  v_cvt_pk_bf16_f32 v68, v40, v41
  v_exp_f32 v43, v43
  v_exp_f32 v44, v44
  v_cvt_pk_bf16_f32 v69, v42, v43
  v_exp_f32 v45, v45
  v_exp_f32 v46, v46
  v_cvt_pk_bf16_f32 v70, v44, v45
  v_exp_f32 v47, v47
  v_smfmac_f32_16x16x64_bf16 v[228:231], v[240:243], v[72:79], v244
  v_cvt_pk_bf16_f32 v71, v46, v47
  s_waitcnt lgkmcnt(0)
  v_mfma_f32_32x32x16_bf16 v[32:47], v[152:155], v[96:99], 0
  v_exp_f32 v48, v48
  v_exp_f32 v49, v49
  v_exp_f32 v50, v50
  v_cvt_pk_bf16_f32 v72, v48, v49
  v_mfma_f32_32x32x16_bf16 v[32:47], v[156:159], v[100:103], v[32:47]
  ds_read_b128 v[136:139], v2 offset:22528
  v_exp_f32 v51, v51
  v_exp_f32 v52, v52
  v_cvt_pk_bf16_f32 v73, v50, v51
  v_exp_f32 v53, v53
  v_mfma_f32_32x32x16_bf16 v[160:175], v[128:131], v[64:67], v[160:175]
  ds_read_b128 v[140:143], v2 offset:23552
  v_exp_f32 v54, v54
  v_cvt_pk_bf16_f32 v74, v52, v53
  v_exp_f32 v55, v55
  v_exp_f32 v56, v56
  v_mfma_f32_32x32x16_bf16 v[160:175], v[132:135], v[68:71], v[160:175]
  ds_read_b128 v[144:147], v2 offset:24576
  v_cvt_pk_bf16_f32 v75, v54, v55
  v_exp_f32 v57, v57
  v_exp_f32 v58, v58
  v_cvt_pk_bf16_f32 v76, v56, v57
  v_exp_f32 v59, v59
  v_exp_f32 v60, v60
  v_cvt_pk_bf16_f32 v77, v58, v59
  v_exp_f32 v61, v61
  v_exp_f32 v62, v62
  v_cvt_pk_bf16_f32 v78, v60, v61
  v_exp_f32 v63, v63
  v_smfmac_f32_16x16x64_bf16 v[224:227], v[240:243], v[64:71], v244
  ds_read_b128 v[148:151], v2 offset:25600
  v_cvt_pk_bf16_f32 v79, v62, v63
  v_mfma_f32_32x32x16_bf16 v[48:63], v[152:155], v[104:107], 0
  v_exp_f32 v32, v32
  v_exp_f32 v33, v33
  v_exp_f32 v34, v34
  v_cvt_pk_bf16_f32 v64, v32, v33
  v_mfma_f32_32x32x16_bf16 v[48:63], v[156:159], v[108:111], v[48:63]
  v_exp_f32 v35, v35
  v_exp_f32 v36, v36
  v_cvt_pk_bf16_f32 v65, v34, v35
  v_exp_f32 v37, v37
  v_mfma_f32_32x32x16_bf16 v[176:191], v[128:131], v[72:75], v[176:191]
  v_exp_f32 v38, v38
  v_cvt_pk_bf16_f32 v66, v36, v37
  v_exp_f32 v39, v39
  v_exp_f32 v40, v40
  v_mfma_f32_32x32x16_bf16 v[176:191], v[132:135], v[76:79], v[176:191]
  v_cvt_pk_bf16_f32 v67, v38, v39
  v_exp_f32 v41, v41
  v_exp_f32 v42, v42
  v_cvt_pk_bf16_f32 v68, v40, v41
  v_exp_f32 v43, v43
  v_exp_f32 v44, v44
  v_cvt_pk_bf16_f32 v69, v42, v43
  v_exp_f32 v45, v45
  v_exp_f32 v46, v46
  v_cvt_pk_bf16_f32 v70, v44, v45
  v_exp_f32 v47, v47
  v_smfmac_f32_16x16x64_bf16 v[228:231], v[240:243], v[72:79], v244
  v_cvt_pk_bf16_f32 v71, v46, v47
  s_waitcnt lgkmcnt(0)
  v_mfma_f32_32x32x16_bf16 v[32:47], v[144:147], v[96:99], 0
  v_exp_f32 v48, v48
  v_exp_f32 v49, v49
  v_exp_f32 v50, v50
  v_cvt_pk_bf16_f32 v72, v48, v49
  v_mfma_f32_32x32x16_bf16 v[32:47], v[148:151], v[100:103], v[32:47]
  ds_read_b128 v[128:131], v2 offset:26624
  v_exp_f32 v51, v51
  v_exp_f32 v52, v52
  v_cvt_pk_bf16_f32 v73, v50, v51
  v_exp_f32 v53, v53
  v_mfma_f32_32x32x16_bf16 v[160:175], v[136:139], v[64:67], v[160:175]
  ds_read_b128 v[132:135], v2 offset:27648
  v_exp_f32 v54, v54
  v_cvt_pk_bf16_f32 v74, v52, v53
  v_exp_f32 v55, v55
  v_exp_f32 v56, v56
  v_mfma_f32_32x32x16_bf16 v[160:175], v[140:143], v[68:71], v[160:175]
  ds_read_b128 v[152:155], v2 offset:28672
  v_cvt_pk_bf16_f32 v75, v54, v55
  v_exp_f32 v57, v57
  v_exp_f32 v58, v58
  v_cvt_pk_bf16_f32 v76, v56, v57
  v_exp_f32 v59, v59
  v_exp_f32 v60, v60
  v_cvt_pk_bf16_f32 v77, v58, v59
  v_exp_f32 v61, v61
  v_exp_f32 v62, v62
  v_cvt_pk_bf16_f32 v78, v60, v61
  v_exp_f32 v63, v63
  v_smfmac_f32_16x16x64_bf16 v[224:227], v[240:243], v[64:71], v244
  ds_read_b128 v[156:159], v2 offset:29696
  v_cvt_pk_bf16_f32 v79, v62, v63
  v_mfma_f32_32x32x16_bf16 v[48:63], v[144:147], v[104:107], 0
  v_exp_f32 v32, v32
  v_exp_f32 v33, v33
  v_exp_f32 v34, v34
  v_cvt_pk_bf16_f32 v64, v32, v33
  v_mfma_f32_32x32x16_bf16 v[48:63], v[148:151], v[108:111], v[48:63]
  v_exp_f32 v35, v35
  v_exp_f32 v36, v36
  v_cvt_pk_bf16_f32 v65, v34, v35
  v_exp_f32 v37, v37
  v_mfma_f32_32x32x16_bf16 v[176:191], v[136:139], v[72:75], v[176:191]
  v_exp_f32 v38, v38
  v_cvt_pk_bf16_f32 v66, v36, v37
  v_exp_f32 v39, v39
  v_exp_f32 v40, v40
  v_mfma_f32_32x32x16_bf16 v[176:191], v[140:143], v[76:79], v[176:191]
  v_cvt_pk_bf16_f32 v67, v38, v39
  v_exp_f32 v41, v41
  v_exp_f32 v42, v42
  v_cvt_pk_bf16_f32 v68, v40, v41
  v_exp_f32 v43, v43
  v_exp_f32 v44, v44
  v_cvt_pk_bf16_f32 v69, v42, v43
  v_exp_f32 v45, v45
  v_exp_f32 v46, v46
  v_cvt_pk_bf16_f32 v70, v44, v45
  v_exp_f32 v47, v47
  v_smfmac_f32_16x16x64_bf16 v[228:231], v[240:243], v[72:79], v244
  v_cvt_pk_bf16_f32 v71, v46, v47
  s_waitcnt lgkmcnt(0)
  v_mfma_f32_32x32x16_bf16 v[32:47], v[152:155], v[96:99], 0
  v_exp_f32 v48, v48
  v_exp_f32 v49, v49
  v_exp_f32 v50, v50
  v_cvt_pk_bf16_f32 v72, v48, v49
  v_mfma_f32_32x32x16_bf16 v[32:47], v[156:159], v[100:103], v[32:47]
  s_waitcnt vmcnt(0)
  s_barrier
  ds_read_b128 v[136:139], v2 offset:30720
  v_exp_f32 v51, v51
  v_exp_f32 v52, v52
  v_cvt_pk_bf16_f32 v73, v50, v51
  v_exp_f32 v53, v53
  v_mfma_f32_32x32x16_bf16 v[160:175], v[128:131], v[64:67], v[160:175]
  ds_read_b128 v[140:143], v2 offset:31744
  v_exp_f32 v54, v54
  v_cvt_pk_bf16_f32 v74, v52, v53
  v_exp_f32 v55, v55
  v_exp_f32 v56, v56
  v_mfma_f32_32x32x16_bf16 v[160:175], v[132:135], v[68:71], v[160:175]
  ds_read_b128 v[144:147], v3 offset:0
  v_cvt_pk_bf16_f32 v75, v54, v55
  v_exp_f32 v57, v57
  v_exp_f32 v58, v58
  v_cvt_pk_bf16_f32 v76, v56, v57
  v_exp_f32 v59, v59
  v_exp_f32 v60, v60
  v_cvt_pk_bf16_f32 v77, v58, v59
  v_exp_f32 v61, v61
  v_exp_f32 v62, v62
  v_cvt_pk_bf16_f32 v78, v60, v61
  v_exp_f32 v63, v63
  v_smfmac_f32_16x16x64_bf16 v[224:227], v[240:243], v[64:71], v244
  ds_read_b128 v[148:151], v3 offset:1024
  v_cvt_pk_bf16_f32 v79, v62, v63
  v_mfma_f32_32x32x16_bf16 v[48:63], v[152:155], v[104:107], 0
  v_exp_f32 v32, v32
  v_exp_f32 v33, v33
  v_exp_f32 v34, v34
  v_cvt_pk_bf16_f32 v64, v32, v33
  v_mfma_f32_32x32x16_bf16 v[48:63], v[156:159], v[108:111], v[48:63]
  s_cmp_eq_u32 s71, 0x8000
  s_cselect_b32 s30, 0x20000, 0
  s_cmp_eq_u32 s71, 0
  s_cselect_b32 s71, 0x8000, s30
  v_exp_f32 v35, v35
  v_exp_f32 v36, v36
  v_cvt_pk_bf16_f32 v65, v34, v35
  v_exp_f32 v37, v37
  v_mfma_f32_32x32x16_bf16 v[176:191], v[128:131], v[72:75], v[176:191]
  v_exp_f32 v38, v38
  v_cvt_pk_bf16_f32 v66, v36, v37
  v_exp_f32 v39, v39
  v_exp_f32 v40, v40
  v_mfma_f32_32x32x16_bf16 v[176:191], v[132:135], v[76:79], v[176:191]
  v_cvt_pk_bf16_f32 v67, v38, v39
  v_exp_f32 v41, v41
  v_exp_f32 v42, v42
  v_cvt_pk_bf16_f32 v68, v40, v41
  v_exp_f32 v43, v43
  v_exp_f32 v44, v44
  v_cvt_pk_bf16_f32 v69, v42, v43
  v_exp_f32 v45, v45
  v_exp_f32 v46, v46
  v_cvt_pk_bf16_f32 v70, v44, v45
  v_exp_f32 v47, v47
  v_smfmac_f32_16x16x64_bf16 v[228:231], v[240:243], v[72:79], v244
  v_cvt_pk_bf16_f32 v71, v46, v47
  s_waitcnt lgkmcnt(0)
  v_mfma_f32_32x32x16_bf16 v[32:47], v[144:147], v[96:99], 0
  s_sub_u32 s69, s69, 1
  s_cmp_lg_u32 s69, 0
  v_exp_f32 v48, v48
  v_exp_f32 v49, v49
  v_exp_f32 v50, v50
  v_cvt_pk_bf16_f32 v72, v48, v49
  v_mfma_f32_32x32x16_bf16 v[32:47], v[148:151], v[100:103], v[32:47]
  ds_read_b128 v[128:131], v3 offset:2048
  v_exp_f32 v51, v51
  v_exp_f32 v52, v52
  v_cvt_pk_bf16_f32 v73, v50, v51
  v_exp_f32 v53, v53
  v_mfma_f32_32x32x16_bf16 v[160:175], v[136:139], v[64:67], v[160:175]
  ds_read_b128 v[132:135], v3 offset:3072
  v_exp_f32 v54, v54
  v_cvt_pk_bf16_f32 v74, v52, v53
  v_exp_f32 v55, v55
  v_exp_f32 v56, v56
  v_mfma_f32_32x32x16_bf16 v[160:175], v[140:143], v[68:71], v[160:175]
  ds_read_b128 v[152:155], v3 offset:4096
  v_cvt_pk_bf16_f32 v75, v54, v55
  v_exp_f32 v57, v57
  v_exp_f32 v58, v58
  v_cvt_pk_bf16_f32 v76, v56, v57
  v_exp_f32 v59, v59
  v_exp_f32 v60, v60
  v_cvt_pk_bf16_f32 v77, v58, v59
  v_exp_f32 v61, v61
  v_exp_f32 v62, v62
  v_cvt_pk_bf16_f32 v78, v60, v61
  v_exp_f32 v63, v63
  v_smfmac_f32_16x16x64_bf16 v[224:227], v[240:243], v[64:71], v244
  ds_read_b128 v[156:159], v3 offset:5120
  v_cvt_pk_bf16_f32 v79, v62, v63
  v_mov_b32 v2, v3
  v_add_u32 v3, s71, v254
  s_cbranch_scc1 L_attnX
  s_nop 0
  v_mfma_f32_32x32x16_bf16 v[176:191], v[136:139], v[72:75], v[176:191]
  v_mfma_f32_32x32x16_bf16 v[176:191], v[140:143], v[76:79], v[176:191]
  v_smfmac_f32_16x16x64_bf16 v[228:231], v[240:243], v[72:79], v244
  v_pk_add_f32 v[64:65], v[160:161], v[162:163]
  v_pk_add_f32 v[64:65], v[64:65], v[164:165]
  v_pk_add_f32 v[64:65], v[64:65], v[166:167]
  v_pk_add_f32 v[64:65], v[64:65], v[168:169]
  v_pk_add_f32 v[64:65], v[64:65], v[170:171]
  v_pk_add_f32 v[64:65], v[64:65], v[172:173]
  v_pk_add_f32 v[64:65], v[64:65], v[174:175]
  v_add_f32 v80, v224, v225
  v_add_f32 v81, v226, v227
  s_nop 7
  v_add_f32 v82, v228, v229
  v_add_f32 v83, v230, v231
  s_nop 1
  v_permlane16_swap_b32 v80, v81
  v_permlane16_swap_b32 v82, v83
  s_nop 0
  v_mov_b32 v88, v80
  v_mov_b32 v89, v82
  s_nop 1
  v_permlane32_swap_b32 v88, v80
  v_permlane32_swap_b32 v89, v82
  s_add_u32 s32, s62, 65536
  v_rcp_f32 v90, v88
  v_rcp_f32 v91, v89
  v_pk_add_f32 v[66:67], v[176:177], v[178:179]
  v_pk_add_f32 v[66:67], v[66:67], v[180:181]
  v_pk_add_f32 v[66:67], v[66:67], v[182:183]
  v_pk_add_f32 v[66:67], v[66:67], v[184:185]
  v_pk_add_f32 v[66:67], v[66:67], v[186:187]
  v_pk_add_f32 v[66:67], v[66:67], v[188:189]
  v_pk_add_f32 v[66:67], v[66:67], v[190:191]
  v_pk_mul_f32 v[160:161], v[160:161], v[90:91] op_sel:[0,0] op_sel_hi:[1,0]
  v_pk_mul_f32 v[162:163], v[162:163], v[90:91] op_sel:[0,0] op_sel_hi:[1,0]
  v_pk_mul_f32 v[164:165], v[164:165], v[90:91] op_sel:[0,0] op_sel_hi:[1,0]
  v_pk_mul_f32 v[166:167], v[166:167], v[90:91] op_sel:[0,0] op_sel_hi:[1,0]
  v_pk_mul_f32 v[168:169], v[168:169], v[90:91] op_sel:[0,0] op_sel_hi:[1,0]
  v_pk_mul_f32 v[170:171], v[170:171], v[90:91] op_sel:[0,0] op_sel_hi:[1,0]
  v_pk_mul_f32 v[172:173], v[172:173], v[90:91] op_sel:[0,0] op_sel_hi:[1,0]
  v_pk_mul_f32 v[174:175], v[174:175], v[90:91] op_sel:[0,0] op_sel_hi:[1,0]
  v_cvt_pk_bf16_f32 v160, v160, v161
  v_cvt_pk_bf16_f32 v161, v162, v163
  v_cvt_pk_bf16_f32 v162, v164, v165
  v_cvt_pk_bf16_f32 v163, v166, v167
  v_cvt_pk_bf16_f32 v164, v168, v169
  v_cvt_pk_bf16_f32 v165, v170, v171
  v_cvt_pk_bf16_f32 v166, v172, v173
  v_cvt_pk_bf16_f32 v167, v174, v175
  buffer_store_dwordx4 v[160:163], v251, s[20:23], s62 offen sc1
  buffer_store_dwordx4 v[164:167], v251, s[20:23], s62 offen offset:512 sc1
  v_pk_mul_f32 v[176:177], v[176:177], v[90:91] op_sel:[0,1] op_sel_hi:[1,1]
  v_pk_mul_f32 v[178:179], v[178:179], v[90:91] op_sel:[0,1] op_sel_hi:[1,1]
  v_pk_mul_f32 v[180:181], v[180:181], v[90:91] op_sel:[0,1] op_sel_hi:[1,1]
  v_pk_mul_f32 v[182:183], v[182:183], v[90:91] op_sel:[0,1] op_sel_hi:[1,1]
  v_pk_mul_f32 v[184:185], v[184:185], v[90:91] op_sel:[0,1] op_sel_hi:[1,1]
  v_pk_mul_f32 v[186:187], v[186:187], v[90:91] op_sel:[0,1] op_sel_hi:[1,1]
  v_pk_mul_f32 v[188:189], v[188:189], v[90:91] op_sel:[0,1] op_sel_hi:[1,1]
  v_pk_mul_f32 v[190:191], v[190:191], v[90:91] op_sel:[0,1] op_sel_hi:[1,1]
  v_cvt_pk_bf16_f32 v176, v176, v177
  v_cvt_pk_bf16_f32 v177, v178, v179
  v_cvt_pk_bf16_f32 v178, v180, v181
  v_cvt_pk_bf16_f32 v179, v182, v183
  v_cvt_pk_bf16_f32 v180, v184, v185
  v_cvt_pk_bf16_f32 v181, v186, v187
  v_cvt_pk_bf16_f32 v182, v188, v189
  v_cvt_pk_bf16_f32 v183, v190, v191
  buffer_store_dwordx4 v[176:179], v251, s[20:23], s32 offen sc1
  buffer_store_dwordx4 v[180:183], v251, s[20:23], s32 offen offset:512 sc1
  v_pk_add_f32 v[64:65], v[64:65], v[66:67]
  v_min_f32 v68, v88, v89
  v_add_f32 v64, v64, v65
  v_max_f32 v69, v88, v89
  v_add_f32 v70, v88, v89
  s_mov_b32 s30, 0x71800000
  s_movk_i32 s31, 0x1f8
  v_cmp_le_f32 vcc, 1.0, v68
  v_cmp_ge_f32 s[78:79], s30, v69
  v_cmp_class_f32 s[80:81], v64, s31
  v_cmp_class_f32 s[76:77], v70, s31
  s_nop 3
  s_and_b64 s[78:79], s[78:79], vcc
  s_and_b64 s[78:79], s[78:79], s[80:81]
  s_and_b64 s[78:79], s[78:79], s[76:77]
  s_cmp_eq_u64 s[78:79], exec
  s_cbranch_scc1 L_norm
  s_waitcnt vmcnt(0) lgkmcnt(0)
  v_mov_b32 v80, 0xff800000
  s_mov_b32 s33, 0
L_fb1_0:
  buffer_load_dwordx4 v[4:7], v254, s[16:19], s33 offen sc1
  buffer_load_dwordx4 v[8:11], v254, s[16:19], s33 offen offset:1024 sc1
  s_waitcnt vmcnt(0)
  v_mfma_f32_32x32x16_bf16 v[48:63], v[4:7], v[96:99], 0
  v_mfma_f32_32x32x16_bf16 v[48:63], v[8:11], v[100:103], v[48:63]
  s_nop 15
  v_max3_f32 v80, v48, v49, v80
  v_max3_f32 v80, v50, v51, v80
  v_max3_f32 v80, v52, v53, v80
  v_max3_f32 v80, v54, v55, v80
  v_max3_f32 v80, v56, v57, v80
  v_max3_f32 v80, v58, v59, v80
  v_max3_f32 v80, v60, v61, v80
  v_max3_f32 v80, v62, v63, v80
  s_add_u32 s33, s33, 4096
  s_cmp_lt_u32 s33, 262144
  s_cbranch_scc1 L_fb1_0
  v_mov_b32 v81, v80
  s_nop 1
  v_permlane32_swap_b32 v80, v81
  s_nop 1
  v_max_f32 v80, v80, v81
  v_sub_f32 v32, 0, v80
  v_sub_f32 v33, 0, v80
  v_sub_f32 v34, 0, v80
  v_sub_f32 v35, 0, v80
  v_sub_f32 v36, 0, v80
  v_sub_f32 v37, 0, v80
  v_sub_f32 v38, 0, v80
  v_sub_f32 v39, 0, v80
  v_sub_f32 v40, 0, v80
  v_sub_f32 v41, 0, v80
  v_sub_f32 v42, 0, v80
  v_sub_f32 v43, 0, v80
  v_sub_f32 v44, 0, v80
  v_sub_f32 v45, 0, v80
  v_sub_f32 v46, 0, v80
  v_sub_f32 v47, 0, v80
  v_mov_b32 v160, 0
  v_mov_b32 v161, 0
  v_mov_b32 v162, 0
  v_mov_b32 v163, 0
  v_mov_b32 v164, 0
  v_mov_b32 v165, 0
  v_mov_b32 v166, 0
  v_mov_b32 v167, 0
  v_mov_b32 v168, 0
  v_mov_b32 v169, 0
  v_mov_b32 v170, 0
  v_mov_b32 v171, 0
  v_mov_b32 v172, 0
  v_mov_b32 v173, 0
  v_mov_b32 v174, 0
  v_mov_b32 v175, 0
  v_mov_b32 v224, 0
  v_mov_b32 v225, 0
  v_mov_b32 v226, 0
  v_mov_b32 v227, 0
  s_mov_b32 s33, 0
L_fb2_0:
  buffer_load_dwordx4 v[4:7], v254, s[16:19], s33 offen sc1
  buffer_load_dwordx4 v[8:11], v254, s[16:19], s33 offen offset:1024 sc1
  buffer_load_dwordx4 v[12:15], v254, s[16:19], s33 offen offset:2048 sc1
  buffer_load_dwordx4 v[16:19], v254, s[16:19], s33 offen offset:3072 sc1
  s_waitcnt vmcnt(0)
  v_mfma_f32_32x32x16_bf16 v[48:63], v[4:7], v[96:99], v[32:47]
  v_mfma_f32_32x32x16_bf16 v[48:63], v[8:11], v[100:103], v[48:63]
  s_nop 15
  v_exp_f32 v48, v48
  v_exp_f32 v49, v49
  v_exp_f32 v50, v50
  v_exp_f32 v51, v51
  v_exp_f32 v52, v52
  v_exp_f32 v53, v53
  v_exp_f32 v54, v54
  v_exp_f32 v55, v55
  v_exp_f32 v56, v56
  v_exp_f32 v57, v57
  v_exp_f32 v58, v58
  v_exp_f32 v59, v59
  v_exp_f32 v60, v60
  v_exp_f32 v61, v61
  v_exp_f32 v62, v62
  v_exp_f32 v63, v63
  s_nop 1
  v_cvt_pk_bf16_f32 v64, v48, v49
  v_cvt_pk_bf16_f32 v65, v50, v51
  v_cvt_pk_bf16_f32 v66, v52, v53
  v_cvt_pk_bf16_f32 v67, v54, v55
  v_cvt_pk_bf16_f32 v68, v56, v57
  v_cvt_pk_bf16_f32 v69, v58, v59
  v_cvt_pk_bf16_f32 v70, v60, v61
  v_cvt_pk_bf16_f32 v71, v62, v63
  s_nop 2
  v_mfma_f32_32x32x16_bf16 v[160:175], v[12:15], v[64:67], v[160:175]
  v_mfma_f32_32x32x16_bf16 v[160:175], v[16:19], v[68:71], v[160:175]
  v_smfmac_f32_16x16x64_bf16 v[224:227], v[240:243], v[64:71], v244
  s_nop 15
  s_add_u32 s33, s33, 4096
  s_cmp_lt_u32 s33, 262144
  s_cbranch_scc1 L_fb2_0
  v_mov_b32 v80, 0xff800000
  s_mov_b32 s33, 0
L_fb1_1:
  buffer_load_dwordx4 v[4:7], v254, s[16:19], s33 offen sc1
  buffer_load_dwordx4 v[8:11], v254, s[16:19], s33 offen offset:1024 sc1
  s_waitcnt vmcnt(0)
  v_mfma_f32_32x32x16_bf16 v[48:63], v[4:7], v[104:107], 0
  v_mfma_f32_32x32x16_bf16 v[48:63], v[8:11], v[108:111], v[48:63]
  s_nop 15
  v_max3_f32 v80, v48, v49, v80
  v_max3_f32 v80, v50, v51, v80
  v_max3_f32 v80, v52, v53, v80
  v_max3_f32 v80, v54, v55, v80
  v_max3_f32 v80, v56, v57, v80
  v_max3_f32 v80, v58, v59, v80
  v_max3_f32 v80, v60, v61, v80
  v_max3_f32 v80, v62, v63, v80
  s_add_u32 s33, s33, 4096
  s_cmp_lt_u32 s33, 262144
  s_cbranch_scc1 L_fb1_1
  v_mov_b32 v81, v80
  s_nop 1
  v_permlane32_swap_b32 v80, v81
  s_nop 1
  v_max_f32 v80, v80, v81
  v_sub_f32 v32, 0, v80
  v_sub_f32 v33, 0, v80
  v_sub_f32 v34, 0, v80
  v_sub_f32 v35, 0, v80
  v_sub_f32 v36, 0, v80
  v_sub_f32 v37, 0, v80
  v_sub_f32 v38, 0, v80
  v_sub_f32 v39, 0, v80
  v_sub_f32 v40, 0, v80
  v_sub_f32 v41, 0, v80
  v_sub_f32 v42, 0, v80
  v_sub_f32 v43, 0, v80
  v_sub_f32 v44, 0, v80
  v_sub_f32 v45, 0, v80
  v_sub_f32 v46, 0, v80
  v_sub_f32 v47, 0, v80
  v_mov_b32 v176, 0
  v_mov_b32 v177, 0
  v_mov_b32 v178, 0
  v_mov_b32 v179, 0
  v_mov_b32 v180, 0
  v_mov_b32 v181, 0
  v_mov_b32 v182, 0
  v_mov_b32 v183, 0
  v_mov_b32 v184, 0
  v_mov_b32 v185, 0
  v_mov_b32 v186, 0
  v_mov_b32 v187, 0
  v_mov_b32 v188, 0
  v_mov_b32 v189, 0
  v_mov_b32 v190, 0
  v_mov_b32 v191, 0
  v_mov_b32 v228, 0
  v_mov_b32 v229, 0
  v_mov_b32 v230, 0
  v_mov_b32 v231, 0
  s_mov_b32 s33, 0
L_fb2_1:
  buffer_load_dwordx4 v[4:7], v254, s[16:19], s33 offen sc1
  buffer_load_dwordx4 v[8:11], v254, s[16:19], s33 offen offset:1024 sc1
  buffer_load_dwordx4 v[12:15], v254, s[16:19], s33 offen offset:2048 sc1
  buffer_load_dwordx4 v[16:19], v254, s[16:19], s33 offen offset:3072 sc1
  s_waitcnt vmcnt(0)
  v_mfma_f32_32x32x16_bf16 v[48:63], v[4:7], v[104:107], v[32:47]
  v_mfma_f32_32x32x16_bf16 v[48:63], v[8:11], v[108:111], v[48:63]
  s_nop 15
  v_exp_f32 v48, v48
  v_exp_f32 v49, v49
  v_exp_f32 v50, v50
  v_exp_f32 v51, v51
  v_exp_f32 v52, v52
  v_exp_f32 v53, v53
  v_exp_f32 v54, v54
  v_exp_f32 v55, v55
  v_exp_f32 v56, v56
  v_exp_f32 v57, v57
  v_exp_f32 v58, v58
  v_exp_f32 v59, v59
  v_exp_f32 v60, v60
  v_exp_f32 v61, v61
  v_exp_f32 v62, v62
  v_exp_f32 v63, v63
  s_nop 1
  v_cvt_pk_bf16_f32 v64, v48, v49
  v_cvt_pk_bf16_f32 v65, v50, v51
  v_cvt_pk_bf16_f32 v66, v52, v53
  v_cvt_pk_bf16_f32 v67, v54, v55
  v_cvt_pk_bf16_f32 v68, v56, v57
  v_cvt_pk_bf16_f32 v69, v58, v59
  v_cvt_pk_bf16_f32 v70, v60, v61
  v_cvt_pk_bf16_f32 v71, v62, v63
  s_nop 2
  v_mfma_f32_32x32x16_bf16 v[176:191], v[12:15], v[64:67], v[176:191]
  v_mfma_f32_32x32x16_bf16 v[176:191], v[16:19], v[68:71], v[176:191]
  v_smfmac_f32_16x16x64_bf16 v[228:231], v[240:243], v[64:71], v244
  s_nop 15
  s_add_u32 s33, s33, 4096
  s_cmp_lt_u32 s33, 262144
  s_cbranch_scc1 L_fb2_1
  s_nop 7
  v_add_f32 v80, v224, v225
  v_add_f32 v81, v226, v227
  v_add_f32 v82, v228, v229
  v_add_f32 v83, v230, v231
  s_nop 1
  v_permlane16_swap_b32 v80, v81
  v_permlane16_swap_b32 v82, v83
  s_nop 0
  v_mov_b32 v88, v80
  v_mov_b32 v89, v82
  s_nop 1
  v_permlane32_swap_b32 v88, v80
  v_permlane32_swap_b32 v89, v82
  s_nop 1
  v_rcp_f32 v90, v88
  v_rcp_f32 v91, v89
  s_nop 0
  v_pk_mul_f32 v[160:161], v[160:161], v[90:91] op_sel:[0,0] op_sel_hi:[1,0]
  v_pk_mul_f32 v[162:163], v[162:163], v[90:91] op_sel:[0,0] op_sel_hi:[1,0]
  v_pk_mul_f32 v[164:165], v[164:165], v[90:91] op_sel:[0,0] op_sel_hi:[1,0]
  v_pk_mul_f32 v[166:167], v[166:167], v[90:91] op_sel:[0,0] op_sel_hi:[1,0]
  v_pk_mul_f32 v[168:169], v[168:169], v[90:91] op_sel:[0,0] op_sel_hi:[1,0]
  v_pk_mul_f32 v[170:171], v[170:171], v[90:91] op_sel:[0,0] op_sel_hi:[1,0]
  v_pk_mul_f32 v[172:173], v[172:173], v[90:91] op_sel:[0,0] op_sel_hi:[1,0]
  v_pk_mul_f32 v[174:175], v[174:175], v[90:91] op_sel:[0,0] op_sel_hi:[1,0]
  v_cvt_pk_bf16_f32 v160, v160, v161
  v_cvt_pk_bf16_f32 v161, v162, v163
  v_cvt_pk_bf16_f32 v162, v164, v165
  v_cvt_pk_bf16_f32 v163, v166, v167
  v_cvt_pk_bf16_f32 v164, v168, v169
  v_cvt_pk_bf16_f32 v165, v170, v171
  v_cvt_pk_bf16_f32 v166, v172, v173
  v_cvt_pk_bf16_f32 v167, v174, v175
  buffer_store_dwordx4 v[160:163], v251, s[20:23], s62 offen sc1
  buffer_store_dwordx4 v[164:167], v251, s[20:23], s62 offen offset:512 sc1
  v_pk_mul_f32 v[176:177], v[176:177], v[90:91] op_sel:[0,1] op_sel_hi:[1,1]
  v_pk_mul_f32 v[178:179], v[178:179], v[90:91] op_sel:[0,1] op_sel_hi:[1,1]
  v_pk_mul_f32 v[180:181], v[180:181], v[90:91] op_sel:[0,1] op_sel_hi:[1,1]
  v_pk_mul_f32 v[182:183], v[182:183], v[90:91] op_sel:[0,1] op_sel_hi:[1,1]
  v_pk_mul_f32 v[184:185], v[184:185], v[90:91] op_sel:[0,1] op_sel_hi:[1,1]
  v_pk_mul_f32 v[186:187], v[186:187], v[90:91] op_sel:[0,1] op_sel_hi:[1,1]
  v_pk_mul_f32 v[188:189], v[188:189], v[90:91] op_sel:[0,1] op_sel_hi:[1,1]
  v_pk_mul_f32 v[190:191], v[190:191], v[90:91] op_sel:[0,1] op_sel_hi:[1,1]
  v_cvt_pk_bf16_f32 v176, v176, v177
  v_cvt_pk_bf16_f32 v177, v178, v179
  v_cvt_pk_bf16_f32 v178, v180, v181
  v_cvt_pk_bf16_f32 v179, v182, v183
  v_cvt_pk_bf16_f32 v180, v184, v185
  v_cvt_pk_bf16_f32 v181, v186, v187
  v_cvt_pk_bf16_f32 v182, v188, v189
  v_cvt_pk_bf16_f32 v183, v190, v191
  buffer_store_dwordx4 v[176:179], v251, s[20:23], s32 offen sc1
  buffer_store_dwordx4 v[180:183], v251, s[20:23], s32 offen offset:512 sc1
L_norm:
  s_cmp_lg_u32 s67, 0
  s_cbranch_scc1 L_attn_done
  s_mov_b32 s67, 1
  s_add_u32 s62, s62, 1024
  s_mov_b32 s69, 2
  v_pk_mov_b32 v[96:97], v[112:113], v[112:113] op_sel:[0,1]
  v_pk_mov_b32 v[98:99], v[114:115], v[114:115] op_sel:[0,1]
  v_pk_mov_b32 v[100:101], v[116:117], v[116:117] op_sel:[0,1]
  v_pk_mov_b32 v[102:103], v[118:119], v[118:119] op_sel:[0,1]
  v_pk_mov_b32 v[104:105], v[120:121], v[120:121] op_sel:[0,1]
  v_pk_mov_b32 v[106:107], v[122:123], v[122:123] op_sel:[0,1]
  v_pk_mov_b32 v[108:109], v[124:125], v[124:125] op_sel:[0,1]
  v_pk_mov_b32 v[110:111], v[126:127], v[126:127] op_sel:[0,1]
  s_waitcnt lgkmcnt(0)
  v_mfma_f32_32x32x16_bf16 v[32:47], v[144:147], v[96:99], 0
  v_mfma_f32_32x32x16_bf16 v[32:47], v[148:151], v[100:103], v[32:47]
  v_pk_mov_b32 v[160:161], v[192:193], v[192:193] op_sel:[0,1]
  v_pk_mov_b32 v[162:163], v[194:195], v[194:195] op_sel:[0,1]
  v_pk_mov_b32 v[164:165], v[196:197], v[196:197] op_sel:[0,1]
  v_pk_mov_b32 v[166:167], v[198:199], v[198:199] op_sel:[0,1]
  v_pk_mov_b32 v[168:169], v[200:201], v[200:201] op_sel:[0,1]
  v_pk_mov_b32 v[170:171], v[202:203], v[202:203] op_sel:[0,1]
  v_pk_mov_b32 v[172:173], v[204:205], v[204:205] op_sel:[0,1]
  v_pk_mov_b32 v[174:175], v[206:207], v[206:207] op_sel:[0,1]
  v_pk_mov_b32 v[176:177], v[208:209], v[208:209] op_sel:[0,1]
  v_pk_mov_b32 v[178:179], v[210:211], v[210:211] op_sel:[0,1]
  v_pk_mov_b32 v[180:181], v[212:213], v[212:213] op_sel:[0,1]
  v_pk_mov_b32 v[182:183], v[214:215], v[214:215] op_sel:[0,1]
  v_pk_mov_b32 v[184:185], v[216:217], v[216:217] op_sel:[0,1]
  v_pk_mov_b32 v[186:187], v[218:219], v[218:219] op_sel:[0,1]
  v_pk_mov_b32 v[188:189], v[220:221], v[220:221] op_sel:[0,1]
  v_pk_mov_b32 v[190:191], v[222:223], v[222:223] op_sel:[0,1]
  v_pk_mov_b32 v[224:225], v[232:233], v[232:233] op_sel:[0,1]
  v_pk_mov_b32 v[226:227], v[234:235], v[234:235] op_sel:[0,1]
  v_pk_mov_b32 v[228:229], v[236:237], v[236:237] op_sel:[0,1]
  v_pk_mov_b32 v[230:231], v[238:239], v[238:239] op_sel:[0,1]
  v_mov_b32 v72, 0
  v_mov_b32 v73, 0
  v_mov_b32 v74, 0
  v_mov_b32 v75, 0
  v_mov_b32 v76, 0
  v_mov_b32 v77, 0
  v_mov_b32 v78, 0
  v_mov_b32 v79, 0
  s_branch L_attnX
L_attn_done:
  s_waitcnt lgkmcnt(0)
  s_barrier
  ds_read_b128 v[112:115], v245 offset:32768
  ds_read_b64_tr_b16 v[96:97], v247 offset:0
  ds_read_b64_tr_b16 v[98:99], v247 offset:2048
  ds_read_b128 v[116:119], v245 offset:34816
  ds_read_b128 v[120:123], v245 offset:36864
  ds_read_b128 v[124:127], v245 offset:38912
  ds_read_b64_tr_b16 v[100:101], v248 offset:0
  ds_read_b64_tr_b16 v[102:103], v248 offset:2048
  ds_read_b64_tr_b16 v[104:105], v249 offset:0
  ds_read_b64_tr_b16 v[106:107], v249 offset:2048
  ds_read_b64_tr_b16 v[108:109], v250 offset:0
  ds_read_b64_tr_b16 v[110:111], v250 offset:2048
  s_waitcnt lgkmcnt(9)
  v_mfma_f32_16x16x32_bf16 v[32:35], v[96:99], v[112:115], 0
  ds_read_b128 v[144:147], v245 offset:33792
  s_waitcnt lgkmcnt(9)
  v_mfma_f32_16x16x32_bf16 v[36:39], v[96:99], v[116:119], 0
  ds_read_b64_tr_b16 v[128:129], v247 offset:8192
  s_waitcnt lgkmcnt(9)
  v_mfma_f32_16x16x32_bf16 v[40:43], v[96:99], v[120:123], 0
  ds_read_b64_tr_b16 v[130:131], v247 offset:10240
  s_waitcnt lgkmcnt(9)
  v_mfma_f32_16x16x32_bf16 v[44:47], v[96:99], v[124:127], 0
  ds_read_b128 v[148:151], v245 offset:35840
  s_waitcnt lgkmcnt(8)
  v_mfma_f32_16x16x32_bf16 v[48:51], v[100:103], v[112:115], 0
  ds_read_b128 v[152:155], v245 offset:37888
  v_mfma_f32_16x16x32_bf16 v[52:55], v[100:103], v[116:119], 0
  ds_read_b128 v[156:159], v245 offset:39936
  v_mfma_f32_16x16x32_bf16 v[56:59], v[100:103], v[120:123], 0
  ds_read_b64_tr_b16 v[132:133], v248 offset:8192
  v_mfma_f32_16x16x32_bf16 v[60:63], v[100:103], v[124:127], 0
  ds_read_b64_tr_b16 v[134:135], v248 offset:10240
  s_waitcnt lgkmcnt(10)
  v_mfma_f32_16x16x32_bf16 v[64:67], v[104:107], v[112:115], 0
  ds_read_b64_tr_b16 v[136:137], v249 offset:8192
  v_mfma_f32_16x16x32_bf16 v[68:71], v[104:107], v[116:119], 0
  ds_read_b64_tr_b16 v[138:139], v249 offset:10240
  v_mfma_f32_16x16x32_bf16 v[72:75], v[104:107], v[120:123], 0
  ds_read_b64_tr_b16 v[140:141], v250 offset:8192
  v_mfma_f32_16x16x32_bf16 v[76:79], v[104:107], v[124:127], 0
  ds_read_b64_tr_b16 v[142:143], v250 offset:10240
  s_waitcnt lgkmcnt(12)
  v_mfma_f32_16x16x32_bf16 v[80:83], v[108:111], v[112:115], 0
  v_mfma_f32_16x16x32_bf16 v[84:87], v[108:111], v[116:119], 0
  v_mfma_f32_16x16x32_bf16 v[88:91], v[108:111], v[120:123], 0
  v_mfma_f32_16x16x32_bf16 v[92:95], v[108:111], v[124:127], 0
  s_waitcnt lgkmcnt(0)
  s_barrier
  v_mfma_f32_16x16x32_bf16 v[32:35], v[128:131], v[144:147], v[32:35]
  ds_read_b128 v[112:115], v245 offset:49152
  v_mfma_f32_16x16x32_bf16 v[36:39], v[128:131], v[148:151], v[36:39]
  ds_read_b64_tr_b16 v[96:97], v247 offset:16384
  v_mfma_f32_16x16x32_bf16 v[40:43], v[128:131], v[152:155], v[40:43]
  ds_read_b64_tr_b16 v[98:99], v247 offset:18432
  v_mfma_f32_16x16x32_bf16 v[44:47], v[128:131], v[156:159], v[44:47]
  ds_read_b128 v[116:119], v245 offset:51200
  v_mfma_f32_16x16x32_bf16 v[48:51], v[132:135], v[144:147], v[48:51]
  ds_read_b128 v[120:123], v245 offset:53248
  v_mfma_f32_16x16x32_bf16 v[52:55], v[132:135], v[148:151], v[52:55]
  ds_read_b128 v[124:127], v245 offset:55296
  v_mfma_f32_16x16x32_bf16 v[56:59], v[132:135], v[152:155], v[56:59]
  ds_read_b64_tr_b16 v[100:101], v248 offset:16384
  v_mfma_f32_16x16x32_bf16 v[60:63], v[132:135], v[156:159], v[60:63]
  ds_read_b64_tr_b16 v[102:103], v248 offset:18432
  v_mfma_f32_16x16x32_bf16 v[64:67], v[136:139], v[144:147], v[64:67]
  ds_read_b64_tr_b16 v[104:105], v249 offset:16384
  v_mfma_f32_16x16x32_bf16 v[68:71], v[136:139], v[148:151], v[68:71]
  ds_read_b64_tr_b16 v[106:107], v249 offset:18432
  v_mfma_f32_16x16x32_bf16 v[72:75], v[136:139], v[152:155], v[72:75]
  ds_read_b64_tr_b16 v[108:109], v250 offset:16384
  v_mfma_f32_16x16x32_bf16 v[76:79], v[136:139], v[156:159], v[76:79]
  ds_read_b64_tr_b16 v[110:111], v250 offset:18432
  v_mfma_f32_16x16x32_bf16 v[80:83], v[140:143], v[144:147], v[80:83]
  v_mfma_f32_16x16x32_bf16 v[84:87], v[140:143], v[148:151], v[84:87]
  v_mfma_f32_16x16x32_bf16 v[88:91], v[140:143], v[152:155], v[88:91]
  v_mfma_f32_16x16x32_bf16 v[92:95], v[140:143], v[156:159], v[92:95]
  s_waitcnt lgkmcnt(9)
  v_mfma_f32_16x16x32_bf16 v[32:35], v[96:99], v[112:115], v[32:35]
  ds_read_b128 v[144:147], v245 offset:50176
  s_waitcnt lgkmcnt(9)
  v_mfma_f32_16x16x32_bf16 v[36:39], v[96:99], v[116:119], v[36:39]
  ds_read_b64_tr_b16 v[128:129], v247 offset:24576
  s_waitcnt lgkmcnt(9)
  v_mfma_f32_16x16x32_bf16 v[40:43], v[96:99], v[120:123], v[40:43]
  ds_read_b64_tr_b16 v[130:131], v247 offset:26624
  s_waitcnt lgkmcnt(9)
  v_mfma_f32_16x16x32_bf16 v[44:47], v[96:99], v[124:127], v[44:47]
  ds_read_b128 v[148:151], v245 offset:52224
  s_waitcnt lgkmcnt(8)
  v_mfma_f32_16x16x32_bf16 v[48:51], v[100:103], v[112:115], v[48:51]
  ds_read_b128 v[152:155], v245 offset:54272
  v_mfma_f32_16x16x32_bf16 v[52:55], v[100:103], v[116:119], v[52:55]
  ds_read_b128 v[156:159], v245 offset:56320
  v_mfma_f32_16x16x32_bf16 v[56:59], v[100:103], v[120:123], v[56:59]
  ds_read_b64_tr_b16 v[132:133], v248 offset:24576
  v_mfma_f32_16x16x32_bf16 v[60:63], v[100:103], v[124:127], v[60:63]
  ds_read_b64_tr_b16 v[134:135], v248 offset:26624
  s_waitcnt lgkmcnt(10)
  v_mfma_f32_16x16x32_bf16 v[64:67], v[104:107], v[112:115], v[64:67]
  ds_read_b64_tr_b16 v[136:137], v249 offset:24576
  v_mfma_f32_16x16x32_bf16 v[68:71], v[104:107], v[116:119], v[68:71]
  ds_read_b64_tr_b16 v[138:139], v249 offset:26624
  v_mfma_f32_16x16x32_bf16 v[72:75], v[104:107], v[120:123], v[72:75]
  ds_read_b64_tr_b16 v[140:141], v250 offset:24576
  v_mfma_f32_16x16x32_bf16 v[76:79], v[104:107], v[124:127], v[76:79]
  ds_read_b64_tr_b16 v[142:143], v250 offset:26624
  s_waitcnt lgkmcnt(12)
  v_mfma_f32_16x16x32_bf16 v[80:83], v[108:111], v[112:115], v[80:83]
  v_mfma_f32_16x16x32_bf16 v[84:87], v[108:111], v[116:119], v[84:87]
  v_mfma_f32_16x16x32_bf16 v[88:91], v[108:111], v[120:123], v[88:91]
  v_mfma_f32_16x16x32_bf16 v[92:95], v[108:111], v[124:127], v[92:95]
  s_waitcnt vmcnt(0) lgkmcnt(0)
  s_barrier
  v_mfma_f32_16x16x32_bf16 v[32:35], v[128:131], v[144:147], v[32:35]
  ds_read_b128 v[112:115], v246 offset:0
  v_mfma_f32_16x16x32_bf16 v[36:39], v[128:131], v[148:151], v[36:39]
  ds_read_b64_tr_b16 v[96:97], v247 offset:32768
  v_mfma_f32_16x16x32_bf16 v[40:43], v[128:131], v[152:155], v[40:43]
  ds_read_b64_tr_b16 v[98:99], v247 offset:34816
  v_mfma_f32_16x16x32_bf16 v[44:47], v[128:131], v[156:159], v[44:47]
  ds_read_b128 v[116:119], v246 offset:2048
  v_mfma_f32_16x16x32_bf16 v[48:51], v[132:135], v[144:147], v[48:51]
  ds_read_b128 v[120:123], v246 offset:4096
  v_mfma_f32_16x16x32_bf16 v[52:55], v[132:135], v[148:151], v[52:55]
  ds_read_b128 v[124:127], v246 offset:6144
  v_mfma_f32_16x16x32_bf16 v[56:59], v[132:135], v[152:155], v[56:59]
  ds_read_b64_tr_b16 v[100:101], v248 offset:32768
  v_mfma_f32_16x16x32_bf16 v[60:63], v[132:135], v[156:159], v[60:63]
  ds_read_b64_tr_b16 v[102:103], v248 offset:34816
  v_mfma_f32_16x16x32_bf16 v[64:67], v[136:139], v[144:147], v[64:67]
  ds_read_b64_tr_b16 v[104:105], v249 offset:32768
  v_mfma_f32_16x16x32_bf16 v[68:71], v[136:139], v[148:151], v[68:71]
  ds_read_b64_tr_b16 v[106:107], v249 offset:34816
  v_mfma_f32_16x16x32_bf16 v[72:75], v[136:139], v[152:155], v[72:75]
  ds_read_b64_tr_b16 v[108:109], v250 offset:32768
  v_mfma_f32_16x16x32_bf16 v[76:79], v[136:139], v[156:159], v[76:79]
  ds_read_b64_tr_b16 v[110:111], v250 offset:34816
  v_mfma_f32_16x16x32_bf16 v[80:83], v[140:143], v[144:147], v[80:83]
  v_mfma_f32_16x16x32_bf16 v[84:87], v[140:143], v[148:151], v[84:87]
  v_mfma_f32_16x16x32_bf16 v[88:91], v[140:143], v[152:155], v[88:91]
  v_mfma_f32_16x16x32_bf16 v[92:95], v[140:143], v[156:159], v[92:95]
  s_waitcnt lgkmcnt(9)
  v_mfma_f32_16x16x32_bf16 v[32:35], v[96:99], v[112:115], v[32:35]
  ds_read_b128 v[144:147], v246 offset:1024
  s_waitcnt lgkmcnt(9)
  v_mfma_f32_16x16x32_bf16 v[36:39], v[96:99], v[116:119], v[36:39]
  ds_read_b64_tr_b16 v[128:129], v247 offset:40960
  s_waitcnt lgkmcnt(9)
  v_mfma_f32_16x16x32_bf16 v[40:43], v[96:99], v[120:123], v[40:43]
  ds_read_b64_tr_b16 v[130:131], v247 offset:43008
  s_waitcnt lgkmcnt(9)
  v_mfma_f32_16x16x32_bf16 v[44:47], v[96:99], v[124:127], v[44:47]
  ds_read_b128 v[148:151], v246 offset:3072
  s_waitcnt lgkmcnt(8)
  v_mfma_f32_16x16x32_bf16 v[48:51], v[100:103], v[112:115], v[48:51]
  ds_read_b128 v[152:155], v246 offset:5120
  v_mfma_f32_16x16x32_bf16 v[52:55], v[100:103], v[116:119], v[52:55]
  ds_read_b128 v[156:159], v246 offset:7168
  v_mfma_f32_16x16x32_bf16 v[56:59], v[100:103], v[120:123], v[56:59]
  ds_read_b64_tr_b16 v[132:133], v248 offset:40960
  v_mfma_f32_16x16x32_bf16 v[60:63], v[100:103], v[124:127], v[60:63]
  ds_read_b64_tr_b16 v[134:135], v248 offset:43008
  s_waitcnt lgkmcnt(10)
  v_mfma_f32_16x16x32_bf16 v[64:67], v[104:107], v[112:115], v[64:67]
  ds_read_b64_tr_b16 v[136:137], v249 offset:40960
  v_mfma_f32_16x16x32_bf16 v[68:71], v[104:107], v[116:119], v[68:71]
  ds_read_b64_tr_b16 v[138:139], v249 offset:43008
  v_mfma_f32_16x16x32_bf16 v[72:75], v[104:107], v[120:123], v[72:75]
  ds_read_b64_tr_b16 v[140:141], v250 offset:40960
  v_mfma_f32_16x16x32_bf16 v[76:79], v[104:107], v[124:127], v[76:79]
  ds_read_b64_tr_b16 v[142:143], v250 offset:43008
  s_waitcnt lgkmcnt(12)
  v_mfma_f32_16x16x32_bf16 v[80:83], v[108:111], v[112:115], v[80:83]
  v_mfma_f32_16x16x32_bf16 v[84:87], v[108:111], v[116:119], v[84:87]
  v_mfma_f32_16x16x32_bf16 v[88:91], v[108:111], v[120:123], v[88:91]
  v_mfma_f32_16x16x32_bf16 v[92:95], v[108:111], v[124:127], v[92:95]
  s_waitcnt lgkmcnt(0)
  s_barrier
  v_mfma_f32_16x16x32_bf16 v[32:35], v[128:131], v[144:147], v[32:35]
  ds_read_b128 v[112:115], v246 offset:16384
  v_mfma_f32_16x16x32_bf16 v[36:39], v[128:131], v[148:151], v[36:39]
  ds_read_b64_tr_b16 v[96:97], v247 offset:49152
  v_mfma_f32_16x16x32_bf16 v[40:43], v[128:131], v[152:155], v[40:43]
  ds_read_b64_tr_b16 v[98:99], v247 offset:51200
  v_mfma_f32_16x16x32_bf16 v[44:47], v[128:131], v[156:159], v[44:47]
  ds_read_b128 v[116:119], v246 offset:18432
  v_mfma_f32_16x16x32_bf16 v[48:51], v[132:135], v[144:147], v[48:51]
  ds_read_b128 v[120:123], v246 offset:20480
  v_mfma_f32_16x16x32_bf16 v[52:55], v[132:135], v[148:151], v[52:55]
  ds_read_b128 v[124:127], v246 offset:22528
  v_mfma_f32_16x16x32_bf16 v[56:59], v[132:135], v[152:155], v[56:59]
  ds_read_b64_tr_b16 v[100:101], v248 offset:49152
  v_mfma_f32_16x16x32_bf16 v[60:63], v[132:135], v[156:159], v[60:63]
  ds_read_b64_tr_b16 v[102:103], v248 offset:51200
  v_mfma_f32_16x16x32_bf16 v[64:67], v[136:139], v[144:147], v[64:67]
  ds_read_b64_tr_b16 v[104:105], v249 offset:49152
  v_mfma_f32_16x16x32_bf16 v[68:71], v[136:139], v[148:151], v[68:71]
  ds_read_b64_tr_b16 v[106:107], v249 offset:51200
  v_mfma_f32_16x16x32_bf16 v[72:75], v[136:139], v[152:155], v[72:75]
  ds_read_b64_tr_b16 v[108:109], v250 offset:49152
  v_mfma_f32_16x16x32_bf16 v[76:79], v[136:139], v[156:159], v[76:79]
  ds_read_b64_tr_b16 v[110:111], v250 offset:51200
  v_mfma_f32_16x16x32_bf16 v[80:83], v[140:143], v[144:147], v[80:83]
  v_mfma_f32_16x16x32_bf16 v[84:87], v[140:143], v[148:151], v[84:87]
  v_mfma_f32_16x16x32_bf16 v[88:91], v[140:143], v[152:155], v[88:91]
  v_mfma_f32_16x16x32_bf16 v[92:95], v[140:143], v[156:159], v[92:95]
  s_waitcnt lgkmcnt(9)
  v_mfma_f32_16x16x32_bf16 v[32:35], v[96:99], v[112:115], v[32:35]
  ds_read_b128 v[144:147], v246 offset:17408
  s_waitcnt lgkmcnt(9)
  v_mfma_f32_16x16x32_bf16 v[36:39], v[96:99], v[116:119], v[36:39]
  ds_read_b64_tr_b16 v[128:129], v247 offset:57344
  s_waitcnt lgkmcnt(9)
  v_mfma_f32_16x16x32_bf16 v[40:43], v[96:99], v[120:123], v[40:43]
  ds_read_b64_tr_b16 v[130:131], v247 offset:59392
  s_waitcnt lgkmcnt(9)
  v_mfma_f32_16x16x32_bf16 v[44:47], v[96:99], v[124:127], v[44:47]
  ds_read_b128 v[148:151], v246 offset:19456
  s_waitcnt lgkmcnt(8)
  v_mfma_f32_16x16x32_bf16 v[48:51], v[100:103], v[112:115], v[48:51]
  ds_read_b128 v[152:155], v246 offset:21504
  v_mfma_f32_16x16x32_bf16 v[52:55], v[100:103], v[116:119], v[52:55]
  ds_read_b128 v[156:159], v246 offset:23552
  v_mfma_f32_16x16x32_bf16 v[56:59], v[100:103], v[120:123], v[56:59]
  ds_read_b64_tr_b16 v[132:133], v248 offset:57344
  v_mfma_f32_16x16x32_bf16 v[60:63], v[100:103], v[124:127], v[60:63]
  ds_read_b64_tr_b16 v[134:135], v248 offset:59392
  s_waitcnt lgkmcnt(10)
  v_mfma_f32_16x16x32_bf16 v[64:67], v[104:107], v[112:115], v[64:67]
  ds_read_b64_tr_b16 v[136:137], v249 offset:57344
  v_mfma_f32_16x16x32_bf16 v[68:71], v[104:107], v[116:119], v[68:71]
  ds_read_b64_tr_b16 v[138:139], v249 offset:59392
  v_mfma_f32_16x16x32_bf16 v[72:75], v[104:107], v[120:123], v[72:75]
  ds_read_b64_tr_b16 v[140:141], v250 offset:57344
  v_mfma_f32_16x16x32_bf16 v[76:79], v[104:107], v[124:127], v[76:79]
  ds_read_b64_tr_b16 v[142:143], v250 offset:59392
  s_waitcnt lgkmcnt(12)
  v_mfma_f32_16x16x32_bf16 v[80:83], v[108:111], v[112:115], v[80:83]
  v_mfma_f32_16x16x32_bf16 v[84:87], v[108:111], v[116:119], v[84:87]
  v_mfma_f32_16x16x32_bf16 v[88:91], v[108:111], v[120:123], v[88:91]
  v_mfma_f32_16x16x32_bf16 v[92:95], v[108:111], v[124:127], v[92:95]
  s_waitcnt lgkmcnt(0)
  s_barrier
  v_mfma_f32_16x16x32_bf16 v[32:35], v[128:131], v[144:147], v[32:35]
  ds_read_b128 v[112:115], v245 offset:0
  v_mfma_f32_16x16x32_bf16 v[36:39], v[128:131], v[148:151], v[36:39]
  ds_read_b64_tr_b16 v[96:97], v247 offset:0
  v_mfma_f32_16x16x32_bf16 v[40:43], v[128:131], v[152:155], v[40:43]
  ds_read_b64_tr_b16 v[98:99], v247 offset:2048
  v_mfma_f32_16x16x32_bf16 v[44:47], v[128:131], v[156:159], v[44:47]
  ds_read_b128 v[116:119], v245 offset:2048
  v_mfma_f32_16x16x32_bf16 v[48:51], v[132:135], v[144:147], v[48:51]
  ds_read_b128 v[120:123], v245 offset:4096
  v_mfma_f32_16x16x32_bf16 v[52:55], v[132:135], v[148:151], v[52:55]
  ds_read_b128 v[124:127], v245 offset:6144
  v_mfma_f32_16x16x32_bf16 v[56:59], v[132:135], v[152:155], v[56:59]
  ds_read_b64_tr_b16 v[100:101], v248 offset:0
  v_mfma_f32_16x16x32_bf16 v[60:63], v[132:135], v[156:159], v[60:63]
  ds_read_b64_tr_b16 v[102:103], v248 offset:2048
  v_mfma_f32_16x16x32_bf16 v[64:67], v[136:139], v[144:147], v[64:67]
  ds_read_b64_tr_b16 v[104:105], v249 offset:0
  v_mfma_f32_16x16x32_bf16 v[68:71], v[136:139], v[148:151], v[68:71]
  ds_read_b64_tr_b16 v[106:107], v249 offset:2048
  v_mfma_f32_16x16x32_bf16 v[72:75], v[136:139], v[152:155], v[72:75]
  ds_read_b64_tr_b16 v[108:109], v250 offset:0
  v_mfma_f32_16x16x32_bf16 v[76:79], v[136:139], v[156:159], v[76:79]
  ds_read_b64_tr_b16 v[110:111], v250 offset:2048
  v_mfma_f32_16x16x32_bf16 v[80:83], v[140:143], v[144:147], v[80:83]
  v_mfma_f32_16x16x32_bf16 v[84:87], v[140:143], v[148:151], v[84:87]
  v_mfma_f32_16x16x32_bf16 v[88:91], v[140:143], v[152:155], v[88:91]
  v_mfma_f32_16x16x32_bf16 v[92:95], v[140:143], v[156:159], v[92:95]
  s_waitcnt lgkmcnt(9)
  v_mfma_f32_16x16x32_bf16 v[32:35], v[96:99], v[112:115], v[32:35]
  ds_read_b128 v[144:147], v245 offset:1024
  s_waitcnt lgkmcnt(9)
  v_mfma_f32_16x16x32_bf16 v[36:39], v[96:99], v[116:119], v[36:39]
  ds_read_b64_tr_b16 v[128:129], v247 offset:8192
  s_waitcnt lgkmcnt(9)
  v_mfma_f32_16x16x32_bf16 v[40:43], v[96:99], v[120:123], v[40:43]
  ds_read_b64_tr_b16 v[130:131], v247 offset:10240
  s_waitcnt lgkmcnt(9)
  v_mfma_f32_16x16x32_bf16 v[44:47], v[96:99], v[124:127], v[44:47]
  ds_read_b128 v[148:151], v245 offset:3072
  s_waitcnt lgkmcnt(8)
  v_mfma_f32_16x16x32_bf16 v[48:51], v[100:103], v[112:115], v[48:51]
  ds_read_b128 v[152:155], v245 offset:5120
  v_mfma_f32_16x16x32_bf16 v[52:55], v[100:103], v[116:119], v[52:55]
  ds_read_b128 v[156:159], v245 offset:7168
  v_mfma_f32_16x16x32_bf16 v[56:59], v[100:103], v[120:123], v[56:59]
  ds_read_b64_tr_b16 v[132:133], v248 offset:8192
  v_mfma_f32_16x16x32_bf16 v[60:63], v[100:103], v[124:127], v[60:63]
  ds_read_b64_tr_b16 v[134:135], v248 offset:10240
  s_waitcnt lgkmcnt(10)
  v_mfma_f32_16x16x32_bf16 v[64:67], v[104:107], v[112:115], v[64:67]
  ds_read_b64_tr_b16 v[136:137], v249 offset:8192
  v_mfma_f32_16x16x32_bf16 v[68:71], v[104:107], v[116:119], v[68:71]
  ds_read_b64_tr_b16 v[138:139], v249 offset:10240
  v_mfma_f32_16x16x32_bf16 v[72:75], v[104:107], v[120:123], v[72:75]
  ds_read_b64_tr_b16 v[140:141], v250 offset:8192
  v_mfma_f32_16x16x32_bf16 v[76:79], v[104:107], v[124:127], v[76:79]
  ds_read_b64_tr_b16 v[142:143], v250 offset:10240
  s_waitcnt lgkmcnt(12)
  v_mfma_f32_16x16x32_bf16 v[80:83], v[108:111], v[112:115], v[80:83]
  v_mfma_f32_16x16x32_bf16 v[84:87], v[108:111], v[116:119], v[84:87]
  v_mfma_f32_16x16x32_bf16 v[88:91], v[108:111], v[120:123], v[88:91]
  v_mfma_f32_16x16x32_bf16 v[92:95], v[108:111], v[124:127], v[92:95]
  s_waitcnt lgkmcnt(0)
  s_barrier
  v_mfma_f32_16x16x32_bf16 v[32:35], v[128:131], v[144:147], v[32:35]
  ds_read_b128 v[112:115], v245 offset:16384
  v_mfma_f32_16x16x32_bf16 v[36:39], v[128:131], v[148:151], v[36:39]
  ds_read_b64_tr_b16 v[96:97], v247 offset:16384
  v_mfma_f32_16x16x32_bf16 v[40:43], v[128:131], v[152:155], v[40:43]
  ds_read_b64_tr_b16 v[98:99], v247 offset:18432
  v_mfma_f32_16x16x32_bf16 v[44:47], v[128:131], v[156:159], v[44:47]
  ds_read_b128 v[116:119], v245 offset:18432
  v_mfma_f32_16x16x32_bf16 v[48:51], v[132:135], v[144:147], v[48:51]
  ds_read_b128 v[120:123], v245 offset:20480
  v_mfma_f32_16x16x32_bf16 v[52:55], v[132:135], v[148:151], v[52:55]
  ds_read_b128 v[124:127], v245 offset:22528
  v_mfma_f32_16x16x32_bf16 v[56:59], v[132:135], v[152:155], v[56:59]
  ds_read_b64_tr_b16 v[100:101], v248 offset:16384
  v_mfma_f32_16x16x32_bf16 v[60:63], v[132:135], v[156:159], v[60:63]
  ds_read_b64_tr_b16 v[102:103], v248 offset:18432
  v_mfma_f32_16x16x32_bf16 v[64:67], v[136:139], v[144:147], v[64:67]
  ds_read_b64_tr_b16 v[104:105], v249 offset:16384
  v_mfma_f32_16x16x32_bf16 v[68:71], v[136:139], v[148:151], v[68:71]
  ds_read_b64_tr_b16 v[106:107], v249 offset:18432
  v_mfma_f32_16x16x32_bf16 v[72:75], v[136:139], v[152:155], v[72:75]
  ds_read_b64_tr_b16 v[108:109], v250 offset:16384
  v_mfma_f32_16x16x32_bf16 v[76:79], v[136:139], v[156:159], v[76:79]
  ds_read_b64_tr_b16 v[110:111], v250 offset:18432
  v_mfma_f32_16x16x32_bf16 v[80:83], v[140:143], v[144:147], v[80:83]
  v_mfma_f32_16x16x32_bf16 v[84:87], v[140:143], v[148:151], v[84:87]
  v_mfma_f32_16x16x32_bf16 v[88:91], v[140:143], v[152:155], v[88:91]
  v_mfma_f32_16x16x32_bf16 v[92:95], v[140:143], v[156:159], v[92:95]
  s_waitcnt lgkmcnt(9)
  v_mfma_f32_16x16x32_bf16 v[32:35], v[96:99], v[112:115], v[32:35]
  ds_read_b128 v[144:147], v245 offset:17408
  s_waitcnt lgkmcnt(9)
  v_mfma_f32_16x16x32_bf16 v[36:39], v[96:99], v[116:119], v[36:39]
  ds_read_b64_tr_b16 v[128:129], v247 offset:24576
  s_waitcnt lgkmcnt(9)
  v_mfma_f32_16x16x32_bf16 v[40:43], v[96:99], v[120:123], v[40:43]
  ds_read_b64_tr_b16 v[130:131], v247 offset:26624
  s_waitcnt lgkmcnt(9)
  v_mfma_f32_16x16x32_bf16 v[44:47], v[96:99], v[124:127], v[44:47]
  ds_read_b128 v[148:151], v245 offset:19456
  s_waitcnt lgkmcnt(8)
  v_mfma_f32_16x16x32_bf16 v[48:51], v[100:103], v[112:115], v[48:51]
  ds_read_b128 v[152:155], v245 offset:21504
  v_mfma_f32_16x16x32_bf16 v[52:55], v[100:103], v[116:119], v[52:55]
  ds_read_b128 v[156:159], v245 offset:23552
  v_mfma_f32_16x16x32_bf16 v[56:59], v[100:103], v[120:123], v[56:59]
  ds_read_b64_tr_b16 v[132:133], v248 offset:24576
  v_mfma_f32_16x16x32_bf16 v[60:63], v[100:103], v[124:127], v[60:63]
  ds_read_b64_tr_b16 v[134:135], v248 offset:26624
  s_waitcnt lgkmcnt(10)
  v_mfma_f32_16x16x32_bf16 v[64:67], v[104:107], v[112:115], v[64:67]
  ds_read_b64_tr_b16 v[136:137], v249 offset:24576
  v_mfma_f32_16x16x32_bf16 v[68:71], v[104:107], v[116:119], v[68:71]
  ds_read_b64_tr_b16 v[138:139], v249 offset:26624
  v_mfma_f32_16x16x32_bf16 v[72:75], v[104:107], v[120:123], v[72:75]
  ds_read_b64_tr_b16 v[140:141], v250 offset:24576
  v_mfma_f32_16x16x32_bf16 v[76:79], v[104:107], v[124:127], v[76:79]
  ds_read_b64_tr_b16 v[142:143], v250 offset:26624
  s_waitcnt lgkmcnt(12)
  v_mfma_f32_16x16x32_bf16 v[80:83], v[108:111], v[112:115], v[80:83]
  v_mfma_f32_16x16x32_bf16 v[84:87], v[108:111], v[116:119], v[84:87]
  v_mfma_f32_16x16x32_bf16 v[88:91], v[108:111], v[120:123], v[88:91]
  v_mfma_f32_16x16x32_bf16 v[92:95], v[108:111], v[124:127], v[92:95]
  s_waitcnt lgkmcnt(0)
  s_barrier
  v_mfma_f32_16x16x32_bf16 v[32:35], v[128:131], v[144:147], v[32:35]
  ds_read_b128 v[112:115], v245 offset:32768
  v_mfma_f32_16x16x32_bf16 v[36:39], v[128:131], v[148:151], v[36:39]
  ds_read_b64_tr_b16 v[96:97], v247 offset:32768
  v_mfma_f32_16x16x32_bf16 v[40:43], v[128:131], v[152:155], v[40:43]
  ds_read_b64_tr_b16 v[98:99], v247 offset:34816
  v_mfma_f32_16x16x32_bf16 v[44:47], v[128:131], v[156:159], v[44:47]
  ds_read_b128 v[116:119], v245 offset:34816
  v_mfma_f32_16x16x32_bf16 v[48:51], v[132:135], v[144:147], v[48:51]
  ds_read_b128 v[120:123], v245 offset:36864
  v_mfma_f32_16x16x32_bf16 v[52:55], v[132:135], v[148:151], v[52:55]
  ds_read_b128 v[124:127], v245 offset:38912
  v_mfma_f32_16x16x32_bf16 v[56:59], v[132:135], v[152:155], v[56:59]
  ds_read_b64_tr_b16 v[100:101], v248 offset:32768
  v_mfma_f32_16x16x32_bf16 v[60:63], v[132:135], v[156:159], v[60:63]
  ds_read_b64_tr_b16 v[102:103], v248 offset:34816
  v_mfma_f32_16x16x32_bf16 v[64:67], v[136:139], v[144:147], v[64:67]
  ds_read_b64_tr_b16 v[104:105], v249 offset:32768
  v_mfma_f32_16x16x32_bf16 v[68:71], v[136:139], v[148:151], v[68:71]
  ds_read_b64_tr_b16 v[106:107], v249 offset:34816
  v_mfma_f32_16x16x32_bf16 v[72:75], v[136:139], v[152:155], v[72:75]
  ds_read_b64_tr_b16 v[108:109], v250 offset:32768
  v_mfma_f32_16x16x32_bf16 v[76:79], v[136:139], v[156:159], v[76:79]
  ds_read_b64_tr_b16 v[110:111], v250 offset:34816
  v_mfma_f32_16x16x32_bf16 v[80:83], v[140:143], v[144:147], v[80:83]
  v_mfma_f32_16x16x32_bf16 v[84:87], v[140:143], v[148:151], v[84:87]
  v_mfma_f32_16x16x32_bf16 v[88:91], v[140:143], v[152:155], v[88:91]
  v_mfma_f32_16x16x32_bf16 v[92:95], v[140:143], v[156:159], v[92:95]
  s_waitcnt lgkmcnt(9)
  v_mfma_f32_16x16x32_bf16 v[32:35], v[96:99], v[112:115], v[32:35]
  ds_read_b128 v[144:147], v245 offset:33792
  s_waitcnt lgkmcnt(9)
  v_mfma_f32_16x16x32_bf16 v[36:39], v[96:99], v[116:119], v[36:39]
  ds_read_b64_tr_b16 v[128:129], v247 offset:40960
  s_waitcnt lgkmcnt(9)
  v_mfma_f32_16x16x32_bf16 v[40:43], v[96:99], v[120:123], v[40:43]
  ds_read_b64_tr_b16 v[130:131], v247 offset:43008
  s_waitcnt lgkmcnt(9)
  v_mfma_f32_16x16x32_bf16 v[44:47], v[96:99], v[124:127], v[44:47]
  ds_read_b128 v[148:151], v245 offset:35840
  s_waitcnt lgkmcnt(8)
  v_mfma_f32_16x16x32_bf16 v[48:51], v[100:103], v[112:115], v[48:51]
  ds_read_b128 v[152:155], v245 offset:37888
  v_mfma_f32_16x16x32_bf16 v[52:55], v[100:103], v[116:119], v[52:55]
  ds_read_b128 v[156:159], v245 offset:39936
  v_mfma_f32_16x16x32_bf16 v[56:59], v[100:103], v[120:123], v[56:59]
  ds_read_b64_tr_b16 v[132:133], v248 offset:40960
  v_mfma_f32_16x16x32_bf16 v[60:63], v[100:103], v[124:127], v[60:63]
  ds_read_b64_tr_b16 v[134:135], v248 offset:43008
  s_waitcnt lgkmcnt(10)
  v_mfma_f32_16x16x32_bf16 v[64:67], v[104:107], v[112:115], v[64:67]
  ds_read_b64_tr_b16 v[136:137], v249 offset:40960
  v_mfma_f32_16x16x32_bf16 v[68:71], v[104:107], v[116:119], v[68:71]
  ds_read_b64_tr_b16 v[138:139], v249 offset:43008
  v_mfma_f32_16x16x32_bf16 v[72:75], v[104:107], v[120:123], v[72:75]
  ds_read_b64_tr_b16 v[140:141], v250 offset:40960
  v_mfma_f32_16x16x32_bf16 v[76:79], v[104:107], v[124:127], v[76:79]
  ds_read_b64_tr_b16 v[142:143], v250 offset:43008
  s_waitcnt lgkmcnt(12)
  v_mfma_f32_16x16x32_bf16 v[80:83], v[108:111], v[112:115], v[80:83]
  v_mfma_f32_16x16x32_bf16 v[84:87], v[108:111], v[116:119], v[84:87]
  v_mfma_f32_16x16x32_bf16 v[88:91], v[108:111], v[120:123], v[88:91]
  v_mfma_f32_16x16x32_bf16 v[92:95], v[108:111], v[124:127], v[92:95]
  s_waitcnt lgkmcnt(0)
  s_barrier
  v_mfma_f32_16x16x32_bf16 v[32:35], v[128:131], v[144:147], v[32:35]
  ds_read_b128 v[112:115], v245 offset:49152
  v_mfma_f32_16x16x32_bf16 v[36:39], v[128:131], v[148:151], v[36:39]
  ds_read_b64_tr_b16 v[96:97], v247 offset:49152
  v_mfma_f32_16x16x32_bf16 v[40:43], v[128:131], v[152:155], v[40:43]
  ds_read_b64_tr_b16 v[98:99], v247 offset:51200
  v_mfma_f32_16x16x32_bf16 v[44:47], v[128:131], v[156:159], v[44:47]
  ds_read_b128 v[116:119], v245 offset:51200
  v_mfma_f32_16x16x32_bf16 v[48:51], v[132:135], v[144:147], v[48:51]
  ds_read_b128 v[120:123], v245 offset:53248
  v_mfma_f32_16x16x32_bf16 v[52:55], v[132:135], v[148:151], v[52:55]
  ds_read_b128 v[124:127], v245 offset:55296
  v_mfma_f32_16x16x32_bf16 v[56:59], v[132:135], v[152:155], v[56:59]
  ds_read_b64_tr_b16 v[100:101], v248 offset:49152
  v_mfma_f32_16x16x32_bf16 v[60:63], v[132:135], v[156:159], v[60:63]
  ds_read_b64_tr_b16 v[102:103], v248 offset:51200
  v_mfma_f32_16x16x32_bf16 v[64:67], v[136:139], v[144:147], v[64:67]
  ds_read_b64_tr_b16 v[104:105], v249 offset:49152
  v_mfma_f32_16x16x32_bf16 v[68:71], v[136:139], v[148:151], v[68:71]
  ds_read_b64_tr_b16 v[106:107], v249 offset:51200
  v_mfma_f32_16x16x32_bf16 v[72:75], v[136:139], v[152:155], v[72:75]
  ds_read_b64_tr_b16 v[108:109], v250 offset:49152
  v_mfma_f32_16x16x32_bf16 v[76:79], v[136:139], v[156:159], v[76:79]
  ds_read_b64_tr_b16 v[110:111], v250 offset:51200
  v_mfma_f32_16x16x32_bf16 v[80:83], v[140:143], v[144:147], v[80:83]
  v_mfma_f32_16x16x32_bf16 v[84:87], v[140:143], v[148:151], v[84:87]
  v_mfma_f32_16x16x32_bf16 v[88:91], v[140:143], v[152:155], v[88:91]
  v_mfma_f32_16x16x32_bf16 v[92:95], v[140:143], v[156:159], v[92:95]
  s_waitcnt lgkmcnt(9)
  v_mfma_f32_16x16x32_bf16 v[32:35], v[96:99], v[112:115], v[32:35]
  ds_read_b128 v[144:147], v245 offset:50176
  s_waitcnt lgkmcnt(9)
  v_mfma_f32_16x16x32_bf16 v[36:39], v[96:99], v[116:119], v[36:39]
  ds_read_b64_tr_b16 v[128:129], v247 offset:57344
  s_waitcnt lgkmcnt(9)
  v_mfma_f32_16x16x32_bf16 v[40:43], v[96:99], v[120:123], v[40:43]
  ds_read_b64_tr_b16 v[130:131], v247 offset:59392
  s_waitcnt lgkmcnt(9)
  v_mfma_f32_16x16x32_bf16 v[44:47], v[96:99], v[124:127], v[44:47]
  ds_read_b128 v[148:151], v245 offset:52224
  s_waitcnt lgkmcnt(8)
  v_mfma_f32_16x16x32_bf16 v[48:51], v[100:103], v[112:115], v[48:51]
  ds_read_b128 v[152:155], v245 offset:54272
  v_mfma_f32_16x16x32_bf16 v[52:55], v[100:103], v[116:119], v[52:55]
  ds_read_b128 v[156:159], v245 offset:56320
  v_mfma_f32_16x16x32_bf16 v[56:59], v[100:103], v[120:123], v[56:59]
  ds_read_b64_tr_b16 v[132:133], v248 offset:57344
  v_mfma_f32_16x16x32_bf16 v[60:63], v[100:103], v[124:127], v[60:63]
  ds_read_b64_tr_b16 v[134:135], v248 offset:59392
  s_waitcnt lgkmcnt(10)
  v_mfma_f32_16x16x32_bf16 v[64:67], v[104:107], v[112:115], v[64:67]
  ds_read_b64_tr_b16 v[136:137], v249 offset:57344
  v_mfma_f32_16x16x32_bf16 v[68:71], v[104:107], v[116:119], v[68:71]
  ds_read_b64_tr_b16 v[138:139], v249 offset:59392
  v_mfma_f32_16x16x32_bf16 v[72:75], v[104:107], v[120:123], v[72:75]
  ds_read_b64_tr_b16 v[140:141], v250 offset:57344
  v_mfma_f32_16x16x32_bf16 v[76:79], v[104:107], v[124:127], v[76:79]
  ds_read_b64_tr_b16 v[142:143], v250 offset:59392
  s_waitcnt lgkmcnt(12)
  v_mfma_f32_16x16x32_bf16 v[80:83], v[108:111], v[112:115], v[80:83]
  v_mfma_f32_16x16x32_bf16 v[84:87], v[108:111], v[116:119], v[84:87]
  v_mfma_f32_16x16x32_bf16 v[88:91], v[108:111], v[120:123], v[88:91]
  v_mfma_f32_16x16x32_bf16 v[92:95], v[108:111], v[124:127], v[92:95]
  s_waitcnt lgkmcnt(0)
  s_barrier
  v_mfma_f32_16x16x32_bf16 v[32:35], v[128:131], v[144:147], v[32:35]
  ds_read_b128 v[112:115], v246 offset:0
  v_mfma_f32_16x16x32_bf16 v[36:39], v[128:131], v[148:151], v[36:39]
  ds_read_b64_tr_b16 v[96:97], v247 offset:0
  v_mfma_f32_16x16x32_bf16 v[40:43], v[128:131], v[152:155], v[40:43]
  ds_read_b64_tr_b16 v[98:99], v247 offset:2048
  v_mfma_f32_16x16x32_bf16 v[44:47], v[128:131], v[156:159], v[44:47]
  ds_read_b128 v[116:119], v246 offset:2048
  v_mfma_f32_16x16x32_bf16 v[48:51], v[132:135], v[144:147], v[48:51]
  ds_read_b128 v[120:123], v246 offset:4096
  v_mfma_f32_16x16x32_bf16 v[52:55], v[132:135], v[148:151], v[52:55]
  ds_read_b128 v[124:127], v246 offset:6144
  v_mfma_f32_16x16x32_bf16 v[56:59], v[132:135], v[152:155], v[56:59]
  ds_read_b64_tr_b16 v[100:101], v248 offset:0
  v_mfma_f32_16x16x32_bf16 v[60:63], v[132:135], v[156:159], v[60:63]
  ds_read_b64_tr_b16 v[102:103], v248 offset:2048
  v_mfma_f32_16x16x32_bf16 v[64:67], v[136:139], v[144:147], v[64:67]
  ds_read_b64_tr_b16 v[104:105], v249 offset:0
  v_mfma_f32_16x16x32_bf16 v[68:71], v[136:139], v[148:151], v[68:71]
  ds_read_b64_tr_b16 v[106:107], v249 offset:2048
  v_mfma_f32_16x16x32_bf16 v[72:75], v[136:139], v[152:155], v[72:75]
  ds_read_b64_tr_b16 v[108:109], v250 offset:0
  v_mfma_f32_16x16x32_bf16 v[76:79], v[136:139], v[156:159], v[76:79]
  ds_read_b64_tr_b16 v[110:111], v250 offset:2048
  v_mfma_f32_16x16x32_bf16 v[80:83], v[140:143], v[144:147], v[80:83]
  v_mfma_f32_16x16x32_bf16 v[84:87], v[140:143], v[148:151], v[84:87]
  v_mfma_f32_16x16x32_bf16 v[88:91], v[140:143], v[152:155], v[88:91]
  v_mfma_f32_16x16x32_bf16 v[92:95], v[140:143], v[156:159], v[92:95]
  s_waitcnt lgkmcnt(9)
  v_mfma_f32_16x16x32_bf16 v[32:35], v[96:99], v[112:115], v[32:35]
  ds_read_b128 v[144:147], v246 offset:1024
  s_waitcnt lgkmcnt(9)
  v_mfma_f32_16x16x32_bf16 v[36:39], v[96:99], v[116:119], v[36:39]
  ds_read_b64_tr_b16 v[128:129], v247 offset:8192
  s_waitcnt lgkmcnt(9)
  v_mfma_f32_16x16x32_bf16 v[40:43], v[96:99], v[120:123], v[40:43]
  ds_read_b64_tr_b16 v[130:131], v247 offset:10240
  s_waitcnt lgkmcnt(9)
  v_mfma_f32_16x16x32_bf16 v[44:47], v[96:99], v[124:127], v[44:47]
  ds_read_b128 v[148:151], v246 offset:3072
  s_waitcnt lgkmcnt(8)
  v_mfma_f32_16x16x32_bf16 v[48:51], v[100:103], v[112:115], v[48:51]
  ds_read_b128 v[152:155], v246 offset:5120
  v_mfma_f32_16x16x32_bf16 v[52:55], v[100:103], v[116:119], v[52:55]
  ds_read_b128 v[156:159], v246 offset:7168
  v_mfma_f32_16x16x32_bf16 v[56:59], v[100:103], v[120:123], v[56:59]
  ds_read_b64_tr_b16 v[132:133], v248 offset:8192
  v_mfma_f32_16x16x32_bf16 v[60:63], v[100:103], v[124:127], v[60:63]
  ds_read_b64_tr_b16 v[134:135], v248 offset:10240
  s_waitcnt lgkmcnt(10)
  v_mfma_f32_16x16x32_bf16 v[64:67], v[104:107], v[112:115], v[64:67]
  ds_read_b64_tr_b16 v[136:137], v249 offset:8192
  v_mfma_f32_16x16x32_bf16 v[68:71], v[104:107], v[116:119], v[68:71]
  ds_read_b64_tr_b16 v[138:139], v249 offset:10240
  v_mfma_f32_16x16x32_bf16 v[72:75], v[104:107], v[120:123], v[72:75]
  ds_read_b64_tr_b16 v[140:141], v250 offset:8192
  v_mfma_f32_16x16x32_bf16 v[76:79], v[104:107], v[124:127], v[76:79]
  ds_read_b64_tr_b16 v[142:143], v250 offset:10240
  s_waitcnt lgkmcnt(12)
  v_mfma_f32_16x16x32_bf16 v[80:83], v[108:111], v[112:115], v[80:83]
  v_mfma_f32_16x16x32_bf16 v[84:87], v[108:111], v[116:119], v[84:87]
  v_mfma_f32_16x16x32_bf16 v[88:91], v[108:111], v[120:123], v[88:91]
  v_mfma_f32_16x16x32_bf16 v[92:95], v[108:111], v[124:127], v[92:95]
  s_waitcnt lgkmcnt(0)
  s_barrier
  v_mfma_f32_16x16x32_bf16 v[32:35], v[128:131], v[144:147], v[32:35]
  ds_read_b128 v[112:115], v246 offset:16384
  v_mfma_f32_16x16x32_bf16 v[36:39], v[128:131], v[148:151], v[36:39]
  ds_read_b64_tr_b16 v[96:97], v247 offset:16384
  v_mfma_f32_16x16x32_bf16 v[40:43], v[128:131], v[152:155], v[40:43]
  ds_read_b64_tr_b16 v[98:99], v247 offset:18432
  v_mfma_f32_16x16x32_bf16 v[44:47], v[128:131], v[156:159], v[44:47]
  ds_read_b128 v[116:119], v246 offset:18432
  v_mfma_f32_16x16x32_bf16 v[48:51], v[132:135], v[144:147], v[48:51]
  ds_read_b128 v[120:123], v246 offset:20480
  v_mfma_f32_16x16x32_bf16 v[52:55], v[132:135], v[148:151], v[52:55]
  ds_read_b128 v[124:127], v246 offset:22528
  v_mfma_f32_16x16x32_bf16 v[56:59], v[132:135], v[152:155], v[56:59]
  ds_read_b64_tr_b16 v[100:101], v248 offset:16384
  v_mfma_f32_16x16x32_bf16 v[60:63], v[132:135], v[156:159], v[60:63]
  ds_read_b64_tr_b16 v[102:103], v248 offset:18432
  v_mfma_f32_16x16x32_bf16 v[64:67], v[136:139], v[144:147], v[64:67]
  ds_read_b64_tr_b16 v[104:105], v249 offset:16384
  v_mfma_f32_16x16x32_bf16 v[68:71], v[136:139], v[148:151], v[68:71]
  ds_read_b64_tr_b16 v[106:107], v249 offset:18432
  v_mfma_f32_16x16x32_bf16 v[72:75], v[136:139], v[152:155], v[72:75]
  ds_read_b64_tr_b16 v[108:109], v250 offset:16384
  v_mfma_f32_16x16x32_bf16 v[76:79], v[136:139], v[156:159], v[76:79]
  ds_read_b64_tr_b16 v[110:111], v250 offset:18432
  v_mfma_f32_16x16x32_bf16 v[80:83], v[140:143], v[144:147], v[80:83]
  v_mfma_f32_16x16x32_bf16 v[84:87], v[140:143], v[148:151], v[84:87]
  v_mfma_f32_16x16x32_bf16 v[88:91], v[140:143], v[152:155], v[88:91]
  v_mfma_f32_16x16x32_bf16 v[92:95], v[140:143], v[156:159], v[92:95]
  s_waitcnt lgkmcnt(9)
  v_mfma_f32_16x16x32_bf16 v[32:35], v[96:99], v[112:115], v[32:35]
  ds_read_b128 v[144:147], v246 offset:17408
  s_waitcnt lgkmcnt(9)
  v_mfma_f32_16x16x32_bf16 v[36:39], v[96:99], v[116:119], v[36:39]
  ds_read_b64_tr_b16 v[128:129], v247 offset:24576
  s_waitcnt lgkmcnt(9)
  v_mfma_f32_16x16x32_bf16 v[40:43], v[96:99], v[120:123], v[40:43]
  ds_read_b64_tr_b16 v[130:131], v247 offset:26624
  s_waitcnt lgkmcnt(9)
  v_mfma_f32_16x16x32_bf16 v[44:47], v[96:99], v[124:127], v[44:47]
  ds_read_b128 v[148:151], v246 offset:19456
  s_waitcnt lgkmcnt(8)
  v_mfma_f32_16x16x32_bf16 v[48:51], v[100:103], v[112:115], v[48:51]
  ds_read_b128 v[152:155], v246 offset:21504
  v_mfma_f32_16x16x32_bf16 v[52:55], v[100:103], v[116:119], v[52:55]
  ds_read_b128 v[156:159], v246 offset:23552
  v_mfma_f32_16x16x32_bf16 v[56:59], v[100:103], v[120:123], v[56:59]
  ds_read_b64_tr_b16 v[132:133], v248 offset:24576
  v_mfma_f32_16x16x32_bf16 v[60:63], v[100:103], v[124:127], v[60:63]
  ds_read_b64_tr_b16 v[134:135], v248 offset:26624
  s_waitcnt lgkmcnt(10)
  v_mfma_f32_16x16x32_bf16 v[64:67], v[104:107], v[112:115], v[64:67]
  ds_read_b64_tr_b16 v[136:137], v249 offset:24576
  v_mfma_f32_16x16x32_bf16 v[68:71], v[104:107], v[116:119], v[68:71]
  ds_read_b64_tr_b16 v[138:139], v249 offset:26624
  v_mfma_f32_16x16x32_bf16 v[72:75], v[104:107], v[120:123], v[72:75]
  ds_read_b64_tr_b16 v[140:141], v250 offset:24576
  v_mfma_f32_16x16x32_bf16 v[76:79], v[104:107], v[124:127], v[76:79]
  ds_read_b64_tr_b16 v[142:143], v250 offset:26624
  s_waitcnt lgkmcnt(12)
  v_mfma_f32_16x16x32_bf16 v[80:83], v[108:111], v[112:115], v[80:83]
  v_mfma_f32_16x16x32_bf16 v[84:87], v[108:111], v[116:119], v[84:87]
  v_mfma_f32_16x16x32_bf16 v[88:91], v[108:111], v[120:123], v[88:91]
  v_mfma_f32_16x16x32_bf16 v[92:95], v[108:111], v[124:127], v[92:95]
  s_waitcnt lgkmcnt(0)
  s_barrier
  v_mfma_f32_16x16x32_bf16 v[32:35], v[128:131], v[144:147], v[32:35]
  ds_read_b128 v[112:115], v245 offset:0
  v_mfma_f32_16x16x32_bf16 v[36:39], v[128:131], v[148:151], v[36:39]
  ds_read_b64_tr_b16 v[96:97], v247 offset:32768
  v_mfma_f32_16x16x32_bf16 v[40:43], v[128:131], v[152:155], v[40:43]
  ds_read_b64_tr_b16 v[98:99], v247 offset:34816
  v_mfma_f32_16x16x32_bf16 v[44:47], v[128:131], v[156:159], v[44:47]
  ds_read_b128 v[116:119], v245 offset:2048
  v_mfma_f32_16x16x32_bf16 v[48:51], v[132:135], v[144:147], v[48:51]
  ds_read_b128 v[120:123], v245 offset:4096
  v_mfma_f32_16x16x32_bf16 v[52:55], v[132:135], v[148:151], v[52:55]
  ds_read_b128 v[124:127], v245 offset:6144
  v_mfma_f32_16x16x32_bf16 v[56:59], v[132:135], v[152:155], v[56:59]
  ds_read_b64_tr_b16 v[100:101], v248 offset:32768
  v_mfma_f32_16x16x32_bf16 v[60:63], v[132:135], v[156:159], v[60:63]
  ds_read_b64_tr_b16 v[102:103], v248 offset:34816
  v_mfma_f32_16x16x32_bf16 v[64:67], v[136:139], v[144:147], v[64:67]
  ds_read_b64_tr_b16 v[104:105], v249 offset:32768
  v_mfma_f32_16x16x32_bf16 v[68:71], v[136:139], v[148:151], v[68:71]
  ds_read_b64_tr_b16 v[106:107], v249 offset:34816
  v_mfma_f32_16x16x32_bf16 v[72:75], v[136:139], v[152:155], v[72:75]
  ds_read_b64_tr_b16 v[108:109], v250 offset:32768
  v_mfma_f32_16x16x32_bf16 v[76:79], v[136:139], v[156:159], v[76:79]
  ds_read_b64_tr_b16 v[110:111], v250 offset:34816
  v_mfma_f32_16x16x32_bf16 v[80:83], v[140:143], v[144:147], v[80:83]
  v_mfma_f32_16x16x32_bf16 v[84:87], v[140:143], v[148:151], v[84:87]
  v_mfma_f32_16x16x32_bf16 v[88:91], v[140:143], v[152:155], v[88:91]
  v_mfma_f32_16x16x32_bf16 v[92:95], v[140:143], v[156:159], v[92:95]
  s_waitcnt lgkmcnt(9)
  v_mfma_f32_16x16x32_bf16 v[32:35], v[96:99], v[112:115], v[32:35]
  ds_read_b128 v[144:147], v245 offset:1024
  s_waitcnt lgkmcnt(9)
  v_mfma_f32_16x16x32_bf16 v[36:39], v[96:99], v[116:119], v[36:39]
  ds_read_b64_tr_b16 v[128:129], v247 offset:40960
  s_waitcnt lgkmcnt(9)
  v_mfma_f32_16x16x32_bf16 v[40:43], v[96:99], v[120:123], v[40:43]
  ds_read_b64_tr_b16 v[130:131], v247 offset:43008
  s_waitcnt lgkmcnt(9)
  v_mfma_f32_16x16x32_bf16 v[44:47], v[96:99], v[124:127], v[44:47]
  ds_read_b128 v[148:151], v245 offset:3072
  s_waitcnt lgkmcnt(8)
  v_mfma_f32_16x16x32_bf16 v[48:51], v[100:103], v[112:115], v[48:51]
  ds_read_b128 v[152:155], v245 offset:5120
  v_mfma_f32_16x16x32_bf16 v[52:55], v[100:103], v[116:119], v[52:55]
  ds_read_b128 v[156:159], v245 offset:7168
  v_mfma_f32_16x16x32_bf16 v[56:59], v[100:103], v[120:123], v[56:59]
  ds_read_b64_tr_b16 v[132:133], v248 offset:40960
  v_mfma_f32_16x16x32_bf16 v[60:63], v[100:103], v[124:127], v[60:63]
  ds_read_b64_tr_b16 v[134:135], v248 offset:43008
  s_waitcnt lgkmcnt(10)
  v_mfma_f32_16x16x32_bf16 v[64:67], v[104:107], v[112:115], v[64:67]
  ds_read_b64_tr_b16 v[136:137], v249 offset:40960
  v_mfma_f32_16x16x32_bf16 v[68:71], v[104:107], v[116:119], v[68:71]
  ds_read_b64_tr_b16 v[138:139], v249 offset:43008
  v_mfma_f32_16x16x32_bf16 v[72:75], v[104:107], v[120:123], v[72:75]
  ds_read_b64_tr_b16 v[140:141], v250 offset:40960
  v_mfma_f32_16x16x32_bf16 v[76:79], v[104:107], v[124:127], v[76:79]
  ds_read_b64_tr_b16 v[142:143], v250 offset:43008
  s_waitcnt lgkmcnt(12)
  v_mfma_f32_16x16x32_bf16 v[80:83], v[108:111], v[112:115], v[80:83]
  v_mfma_f32_16x16x32_bf16 v[84:87], v[108:111], v[116:119], v[84:87]
  v_mfma_f32_16x16x32_bf16 v[88:91], v[108:111], v[120:123], v[88:91]
  v_mfma_f32_16x16x32_bf16 v[92:95], v[108:111], v[124:127], v[92:95]
  s_waitcnt lgkmcnt(0)
  s_barrier
  v_mfma_f32_16x16x32_bf16 v[32:35], v[128:131], v[144:147], v[32:35]
  ds_read_b128 v[112:115], v245 offset:16384
  v_mfma_f32_16x16x32_bf16 v[36:39], v[128:131], v[148:151], v[36:39]
  ds_read_b64_tr_b16 v[96:97], v247 offset:49152
  v_mfma_f32_16x16x32_bf16 v[40:43], v[128:131], v[152:155], v[40:43]
  ds_read_b64_tr_b16 v[98:99], v247 offset:51200
  v_mfma_f32_16x16x32_bf16 v[44:47], v[128:131], v[156:159], v[44:47]
  ds_read_b128 v[116:119], v245 offset:18432
  v_mfma_f32_16x16x32_bf16 v[48:51], v[132:135], v[144:147], v[48:51]
  ds_read_b128 v[120:123], v245 offset:20480
  v_mfma_f32_16x16x32_bf16 v[52:55], v[132:135], v[148:151], v[52:55]
  ds_read_b128 v[124:127], v245 offset:22528
  v_mfma_f32_16x16x32_bf16 v[56:59], v[132:135], v[152:155], v[56:59]
  ds_read_b64_tr_b16 v[100:101], v248 offset:49152
  v_mfma_f32_16x16x32_bf16 v[60:63], v[132:135], v[156:159], v[60:63]
  ds_read_b64_tr_b16 v[102:103], v248 offset:51200
  v_mfma_f32_16x16x32_bf16 v[64:67], v[136:139], v[144:147], v[64:67]
  ds_read_b64_tr_b16 v[104:105], v249 offset:49152
  v_mfma_f32_16x16x32_bf16 v[68:71], v[136:139], v[148:151], v[68:71]
  ds_read_b64_tr_b16 v[106:107], v249 offset:51200
  v_mfma_f32_16x16x32_bf16 v[72:75], v[136:139], v[152:155], v[72:75]
  ds_read_b64_tr_b16 v[108:109], v250 offset:49152
  v_mfma_f32_16x16x32_bf16 v[76:79], v[136:139], v[156:159], v[76:79]
  ds_read_b64_tr_b16 v[110:111], v250 offset:51200
  v_mfma_f32_16x16x32_bf16 v[80:83], v[140:143], v[144:147], v[80:83]
  v_mfma_f32_16x16x32_bf16 v[84:87], v[140:143], v[148:151], v[84:87]
  v_mfma_f32_16x16x32_bf16 v[88:91], v[140:143], v[152:155], v[88:91]
  v_mfma_f32_16x16x32_bf16 v[92:95], v[140:143], v[156:159], v[92:95]
  s_waitcnt lgkmcnt(9)
  v_mfma_f32_16x16x32_bf16 v[32:35], v[96:99], v[112:115], v[32:35]
  ds_read_b128 v[144:147], v245 offset:17408
  s_waitcnt lgkmcnt(9)
  v_mfma_f32_16x16x32_bf16 v[36:39], v[96:99], v[116:119], v[36:39]
  ds_read_b64_tr_b16 v[128:129], v247 offset:57344
  s_waitcnt lgkmcnt(9)
  v_mfma_f32_16x16x32_bf16 v[40:43], v[96:99], v[120:123], v[40:43]
  ds_read_b64_tr_b16 v[130:131], v247 offset:59392
  s_waitcnt lgkmcnt(9)
  v_mfma_f32_16x16x32_bf16 v[44:47], v[96:99], v[124:127], v[44:47]
  ds_read_b128 v[148:151], v245 offset:19456
  s_waitcnt lgkmcnt(8)
  v_mfma_f32_16x16x32_bf16 v[48:51], v[100:103], v[112:115], v[48:51]
  ds_read_b128 v[152:155], v245 offset:21504
  v_mfma_f32_16x16x32_bf16 v[52:55], v[100:103], v[116:119], v[52:55]
  ds_read_b128 v[156:159], v245 offset:23552
  v_mfma_f32_16x16x32_bf16 v[56:59], v[100:103], v[120:123], v[56:59]
  ds_read_b64_tr_b16 v[132:133], v248 offset:57344
  v_mfma_f32_16x16x32_bf16 v[60:63], v[100:103], v[124:127], v[60:63]
  ds_read_b64_tr_b16 v[134:135], v248 offset:59392
  s_waitcnt lgkmcnt(10)
  v_mfma_f32_16x16x32_bf16 v[64:67], v[104:107], v[112:115], v[64:67]
  ds_read_b64_tr_b16 v[136:137], v249 offset:57344
  v_mfma_f32_16x16x32_bf16 v[68:71], v[104:107], v[116:119], v[68:71]
  ds_read_b64_tr_b16 v[138:139], v249 offset:59392
  v_mfma_f32_16x16x32_bf16 v[72:75], v[104:107], v[120:123], v[72:75]
  ds_read_b64_tr_b16 v[140:141], v250 offset:57344
  v_mfma_f32_16x16x32_bf16 v[76:79], v[104:107], v[124:127], v[76:79]
  ds_read_b64_tr_b16 v[142:143], v250 offset:59392
  s_waitcnt lgkmcnt(12)
  v_mfma_f32_16x16x32_bf16 v[80:83], v[108:111], v[112:115], v[80:83]
  v_mfma_f32_16x16x32_bf16 v[84:87], v[108:111], v[116:119], v[84:87]
  v_mfma_f32_16x16x32_bf16 v[88:91], v[108:111], v[120:123], v[88:91]
  v_mfma_f32_16x16x32_bf16 v[92:95], v[108:111], v[124:127], v[92:95]
  s_waitcnt lgkmcnt(0)
  s_barrier
  v_mfma_f32_16x16x32_bf16 v[32:35], v[128:131], v[144:147], v[32:35]
  ds_read_b128 v[112:115], v245 offset:32768
  v_mfma_f32_16x16x32_bf16 v[36:39], v[128:131], v[148:151], v[36:39]
  ds_read_b64_tr_b16 v[96:97], v247 offset:0
  v_mfma_f32_16x16x32_bf16 v[40:43], v[128:131], v[152:155], v[40:43]
  ds_read_b64_tr_b16 v[98:99], v247 offset:2048
  v_mfma_f32_16x16x32_bf16 v[44:47], v[128:131], v[156:159], v[44:47]
  ds_read_b128 v[116:119], v245 offset:34816
  v_mfma_f32_16x16x32_bf16 v[48:51], v[132:135], v[144:147], v[48:51]
  ds_read_b128 v[120:123], v245 offset:36864
  v_mfma_f32_16x16x32_bf16 v[52:55], v[132:135], v[148:151], v[52:55]
  ds_read_b128 v[124:127], v245 offset:38912
  v_mfma_f32_16x16x32_bf16 v[56:59], v[132:135], v[152:155], v[56:59]
  ds_read_b64_tr_b16 v[100:101], v248 offset:0
  v_mfma_f32_16x16x32_bf16 v[60:63], v[132:135], v[156:159], v[60:63]
  ds_read_b64_tr_b16 v[102:103], v248 offset:2048
  v_mfma_f32_16x16x32_bf16 v[64:67], v[136:139], v[144:147], v[64:67]
  ds_read_b64_tr_b16 v[104:105], v249 offset:0
  v_mfma_f32_16x16x32_bf16 v[68:71], v[136:139], v[148:151], v[68:71]
  ds_read_b64_tr_b16 v[106:107], v249 offset:2048
  v_mfma_f32_16x16x32_bf16 v[72:75], v[136:139], v[152:155], v[72:75]
  ds_read_b64_tr_b16 v[108:109], v250 offset:0
  v_mfma_f32_16x16x32_bf16 v[76:79], v[136:139], v[156:159], v[76:79]
  ds_read_b64_tr_b16 v[110:111], v250 offset:2048
  v_mfma_f32_16x16x32_bf16 v[80:83], v[140:143], v[144:147], v[80:83]
  v_mfma_f32_16x16x32_bf16 v[84:87], v[140:143], v[148:151], v[84:87]
  v_mfma_f32_16x16x32_bf16 v[88:91], v[140:143], v[152:155], v[88:91]
  v_mfma_f32_16x16x32_bf16 v[92:95], v[140:143], v[156:159], v[92:95]
  s_waitcnt lgkmcnt(9)
  v_mfma_f32_16x16x32_bf16 v[32:35], v[96:99], v[112:115], v[32:35]
  ds_read_b128 v[144:147], v245 offset:33792
  s_waitcnt lgkmcnt(9)
  v_mfma_f32_16x16x32_bf16 v[36:39], v[96:99], v[116:119], v[36:39]
  ds_read_b64_tr_b16 v[128:129], v247 offset:8192
  s_waitcnt lgkmcnt(9)
  v_mfma_f32_16x16x32_bf16 v[40:43], v[96:99], v[120:123], v[40:43]
  ds_read_b64_tr_b16 v[130:131], v247 offset:10240
  s_waitcnt lgkmcnt(9)
  v_mfma_f32_16x16x32_bf16 v[44:47], v[96:99], v[124:127], v[44:47]
  ds_read_b128 v[148:151], v245 offset:35840
  s_waitcnt lgkmcnt(8)
  v_mfma_f32_16x16x32_bf16 v[48:51], v[100:103], v[112:115], v[48:51]
  ds_read_b128 v[152:155], v245 offset:37888
  v_mfma_f32_16x16x32_bf16 v[52:55], v[100:103], v[116:119], v[52:55]
  ds_read_b128 v[156:159], v245 offset:39936
  v_mfma_f32_16x16x32_bf16 v[56:59], v[100:103], v[120:123], v[56:59]
  ds_read_b64_tr_b16 v[132:133], v248 offset:8192
  v_mfma_f32_16x16x32_bf16 v[60:63], v[100:103], v[124:127], v[60:63]
  ds_read_b64_tr_b16 v[134:135], v248 offset:10240
  s_waitcnt lgkmcnt(10)
  v_mfma_f32_16x16x32_bf16 v[64:67], v[104:107], v[112:115], v[64:67]
  ds_read_b64_tr_b16 v[136:137], v249 offset:8192
  v_mfma_f32_16x16x32_bf16 v[68:71], v[104:107], v[116:119], v[68:71]
  ds_read_b64_tr_b16 v[138:139], v249 offset:10240
  v_mfma_f32_16x16x32_bf16 v[72:75], v[104:107], v[120:123], v[72:75]
  ds_read_b64_tr_b16 v[140:141], v250 offset:8192
  v_mfma_f32_16x16x32_bf16 v[76:79], v[104:107], v[124:127], v[76:79]
  ds_read_b64_tr_b16 v[142:143], v250 offset:10240
  s_waitcnt lgkmcnt(12)
  v_mfma_f32_16x16x32_bf16 v[80:83], v[108:111], v[112:115], v[80:83]
  v_mfma_f32_16x16x32_bf16 v[84:87], v[108:111], v[116:119], v[84:87]
  v_mfma_f32_16x16x32_bf16 v[88:91], v[108:111], v[120:123], v[88:91]
  v_mfma_f32_16x16x32_bf16 v[92:95], v[108:111], v[124:127], v[92:95]
  s_waitcnt lgkmcnt(0)
  s_barrier
  v_mfma_f32_16x16x32_bf16 v[32:35], v[128:131], v[144:147], v[32:35]
  ds_read_b128 v[112:115], v245 offset:49152
  v_mfma_f32_16x16x32_bf16 v[36:39], v[128:131], v[148:151], v[36:39]
  ds_read_b64_tr_b16 v[96:97], v247 offset:16384
  v_mfma_f32_16x16x32_bf16 v[40:43], v[128:131], v[152:155], v[40:43]
  ds_read_b64_tr_b16 v[98:99], v247 offset:18432
  v_mfma_f32_16x16x32_bf16 v[44:47], v[128:131], v[156:159], v[44:47]
  ds_read_b128 v[116:119], v245 offset:51200
  v_mfma_f32_16x16x32_bf16 v[48:51], v[132:135], v[144:147], v[48:51]
  ds_read_b128 v[120:123], v245 offset:53248
  v_mfma_f32_16x16x32_bf16 v[52:55], v[132:135], v[148:151], v[52:55]
  ds_read_b128 v[124:127], v245 offset:55296
  v_mfma_f32_16x16x32_bf16 v[56:59], v[132:135], v[152:155], v[56:59]
  ds_read_b64_tr_b16 v[100:101], v248 offset:16384
  v_mfma_f32_16x16x32_bf16 v[60:63], v[132:135], v[156:159], v[60:63]
  ds_read_b64_tr_b16 v[102:103], v248 offset:18432
  v_mfma_f32_16x16x32_bf16 v[64:67], v[136:139], v[144:147], v[64:67]
  ds_read_b64_tr_b16 v[104:105], v249 offset:16384
  v_mfma_f32_16x16x32_bf16 v[68:71], v[136:139], v[148:151], v[68:71]
  ds_read_b64_tr_b16 v[106:107], v249 offset:18432
  v_mfma_f32_16x16x32_bf16 v[72:75], v[136:139], v[152:155], v[72:75]
  ds_read_b64_tr_b16 v[108:109], v250 offset:16384
  v_mfma_f32_16x16x32_bf16 v[76:79], v[136:139], v[156:159], v[76:79]
  ds_read_b64_tr_b16 v[110:111], v250 offset:18432
  v_mfma_f32_16x16x32_bf16 v[80:83], v[140:143], v[144:147], v[80:83]
  v_mfma_f32_16x16x32_bf16 v[84:87], v[140:143], v[148:151], v[84:87]
  v_mfma_f32_16x16x32_bf16 v[88:91], v[140:143], v[152:155], v[88:91]
  v_mfma_f32_16x16x32_bf16 v[92:95], v[140:143], v[156:159], v[92:95]
  s_waitcnt lgkmcnt(9)
  v_mfma_f32_16x16x32_bf16 v[32:35], v[96:99], v[112:115], v[32:35]
  ds_read_b128 v[144:147], v245 offset:50176
  s_waitcnt lgkmcnt(9)
  v_mfma_f32_16x16x32_bf16 v[36:39], v[96:99], v[116:119], v[36:39]
  ds_read_b64_tr_b16 v[128:129], v247 offset:24576
  s_waitcnt lgkmcnt(9)
  v_mfma_f32_16x16x32_bf16 v[40:43], v[96:99], v[120:123], v[40:43]
  ds_read_b64_tr_b16 v[130:131], v247 offset:26624
  s_waitcnt lgkmcnt(9)
  v_mfma_f32_16x16x32_bf16 v[44:47], v[96:99], v[124:127], v[44:47]
  ds_read_b128 v[148:151], v245 offset:52224
  s_waitcnt lgkmcnt(8)
  v_mfma_f32_16x16x32_bf16 v[48:51], v[100:103], v[112:115], v[48:51]
  ds_read_b128 v[152:155], v245 offset:54272
  v_mfma_f32_16x16x32_bf16 v[52:55], v[100:103], v[116:119], v[52:55]
  ds_read_b128 v[156:159], v245 offset:56320
  v_mfma_f32_16x16x32_bf16 v[56:59], v[100:103], v[120:123], v[56:59]
  ds_read_b64_tr_b16 v[132:133], v248 offset:24576
  v_mfma_f32_16x16x32_bf16 v[60:63], v[100:103], v[124:127], v[60:63]
  ds_read_b64_tr_b16 v[134:135], v248 offset:26624
  s_waitcnt lgkmcnt(10)
  v_mfma_f32_16x16x32_bf16 v[64:67], v[104:107], v[112:115], v[64:67]
  ds_read_b64_tr_b16 v[136:137], v249 offset:24576
  v_mfma_f32_16x16x32_bf16 v[68:71], v[104:107], v[116:119], v[68:71]
  ds_read_b64_tr_b16 v[138:139], v249 offset:26624
  v_mfma_f32_16x16x32_bf16 v[72:75], v[104:107], v[120:123], v[72:75]
  ds_read_b64_tr_b16 v[140:141], v250 offset:24576
  v_mfma_f32_16x16x32_bf16 v[76:79], v[104:107], v[124:127], v[76:79]
  ds_read_b64_tr_b16 v[142:143], v250 offset:26624
  s_waitcnt lgkmcnt(12)
  v_mfma_f32_16x16x32_bf16 v[80:83], v[108:111], v[112:115], v[80:83]
  v_mfma_f32_16x16x32_bf16 v[84:87], v[108:111], v[116:119], v[84:87]
  v_mfma_f32_16x16x32_bf16 v[88:91], v[108:111], v[120:123], v[88:91]
  v_mfma_f32_16x16x32_bf16 v[92:95], v[108:111], v[124:127], v[92:95]
  s_waitcnt lgkmcnt(0)
  s_barrier
  v_mfma_f32_16x16x32_bf16 v[32:35], v[128:131], v[144:147], v[32:35]
  ds_read_b128 v[112:115], v246 offset:0
  v_mfma_f32_16x16x32_bf16 v[36:39], v[128:131], v[148:151], v[36:39]
  ds_read_b64_tr_b16 v[96:97], v247 offset:32768
  v_mfma_f32_16x16x32_bf16 v[40:43], v[128:131], v[152:155], v[40:43]
  ds_read_b64_tr_b16 v[98:99], v247 offset:34816
  v_mfma_f32_16x16x32_bf16 v[44:47], v[128:131], v[156:159], v[44:47]
  ds_read_b128 v[116:119], v246 offset:2048
  v_mfma_f32_16x16x32_bf16 v[48:51], v[132:135], v[144:147], v[48:51]
  ds_read_b128 v[120:123], v246 offset:4096
  v_mfma_f32_16x16x32_bf16 v[52:55], v[132:135], v[148:151], v[52:55]
  ds_read_b128 v[124:127], v246 offset:6144
  v_mfma_f32_16x16x32_bf16 v[56:59], v[132:135], v[152:155], v[56:59]
  ds_read_b64_tr_b16 v[100:101], v248 offset:32768
  v_mfma_f32_16x16x32_bf16 v[60:63], v[132:135], v[156:159], v[60:63]
  ds_read_b64_tr_b16 v[102:103], v248 offset:34816
  v_mfma_f32_16x16x32_bf16 v[64:67], v[136:139], v[144:147], v[64:67]
  ds_read_b64_tr_b16 v[104:105], v249 offset:32768
  v_mfma_f32_16x16x32_bf16 v[68:71], v[136:139], v[148:151], v[68:71]
  ds_read_b64_tr_b16 v[106:107], v249 offset:34816
  v_mfma_f32_16x16x32_bf16 v[72:75], v[136:139], v[152:155], v[72:75]
  ds_read_b64_tr_b16 v[108:109], v250 offset:32768
  v_mfma_f32_16x16x32_bf16 v[76:79], v[136:139], v[156:159], v[76:79]
  ds_read_b64_tr_b16 v[110:111], v250 offset:34816
  v_mfma_f32_16x16x32_bf16 v[80:83], v[140:143], v[144:147], v[80:83]
  v_mfma_f32_16x16x32_bf16 v[84:87], v[140:143], v[148:151], v[84:87]
  v_mfma_f32_16x16x32_bf16 v[88:91], v[140:143], v[152:155], v[88:91]
  v_mfma_f32_16x16x32_bf16 v[92:95], v[140:143], v[156:159], v[92:95]
  s_waitcnt lgkmcnt(9)
  v_mfma_f32_16x16x32_bf16 v[32:35], v[96:99], v[112:115], v[32:35]
  ds_read_b128 v[144:147], v246 offset:1024
  s_waitcnt lgkmcnt(9)
  v_mfma_f32_16x16x32_bf16 v[36:39], v[96:99], v[116:119], v[36:39]
  ds_read_b64_tr_b16 v[128:129], v247 offset:40960
  s_waitcnt lgkmcnt(9)
  v_mfma_f32_16x16x32_bf16 v[40:43], v[96:99], v[120:123], v[40:43]
  ds_read_b64_tr_b16 v[130:131], v247 offset:43008
  s_waitcnt lgkmcnt(9)
  v_mfma_f32_16x16x32_bf16 v[44:47], v[96:99], v[124:127], v[44:47]
  ds_read_b128 v[148:151], v246 offset:3072
  s_waitcnt lgkmcnt(8)
  v_mfma_f32_16x16x32_bf16 v[48:51], v[100:103], v[112:115], v[48:51]
  ds_read_b128 v[152:155], v246 offset:5120
  v_mfma_f32_16x16x32_bf16 v[52:55], v[100:103], v[116:119], v[52:55]
  ds_read_b128 v[156:159], v246 offset:7168
  v_mfma_f32_16x16x32_bf16 v[56:59], v[100:103], v[120:123], v[56:59]
  ds_read_b64_tr_b16 v[132:133], v248 offset:40960
  v_mfma_f32_16x16x32_bf16 v[60:63], v[100:103], v[124:127], v[60:63]
  ds_read_b64_tr_b16 v[134:135], v248 offset:43008
  s_waitcnt lgkmcnt(10)
  v_mfma_f32_16x16x32_bf16 v[64:67], v[104:107], v[112:115], v[64:67]
  ds_read_b64_tr_b16 v[136:137], v249 offset:40960
  v_mfma_f32_16x16x32_bf16 v[68:71], v[104:107], v[116:119], v[68:71]
  ds_read_b64_tr_b16 v[138:139], v249 offset:43008
  v_mfma_f32_16x16x32_bf16 v[72:75], v[104:107], v[120:123], v[72:75]
  ds_read_b64_tr_b16 v[140:141], v250 offset:40960
  v_mfma_f32_16x16x32_bf16 v[76:79], v[104:107], v[124:127], v[76:79]
  ds_read_b64_tr_b16 v[142:143], v250 offset:43008
  s_waitcnt lgkmcnt(12)
  v_mfma_f32_16x16x32_bf16 v[80:83], v[108:111], v[112:115], v[80:83]
  v_mfma_f32_16x16x32_bf16 v[84:87], v[108:111], v[116:119], v[84:87]
  v_mfma_f32_16x16x32_bf16 v[88:91], v[108:111], v[120:123], v[88:91]
  v_mfma_f32_16x16x32_bf16 v[92:95], v[108:111], v[124:127], v[92:95]
  s_waitcnt lgkmcnt(0)
  s_barrier
  v_mfma_f32_16x16x32_bf16 v[32:35], v[128:131], v[144:147], v[32:35]
  ds_read_b128 v[112:115], v246 offset:16384
  v_mfma_f32_16x16x32_bf16 v[36:39], v[128:131], v[148:151], v[36:39]
  ds_read_b64_tr_b16 v[96:97], v247 offset:49152
  v_mfma_f32_16x16x32_bf16 v[40:43], v[128:131], v[152:155], v[40:43]
  ds_read_b64_tr_b16 v[98:99], v247 offset:51200
  v_mfma_f32_16x16x32_bf16 v[44:47], v[128:131], v[156:159], v[44:47]
  ds_read_b128 v[116:119], v246 offset:18432
  v_mfma_f32_16x16x32_bf16 v[48:51], v[132:135], v[144:147], v[48:51]
  ds_read_b128 v[120:123], v246 offset:20480
  v_mfma_f32_16x16x32_bf16 v[52:55], v[132:135], v[148:151], v[52:55]
  ds_read_b128 v[124:127], v246 offset:22528
  v_mfma_f32_16x16x32_bf16 v[56:59], v[132:135], v[152:155], v[56:59]
  ds_read_b64_tr_b16 v[100:101], v248 offset:49152
  v_mfma_f32_16x16x32_bf16 v[60:63], v[132:135], v[156:159], v[60:63]
  ds_read_b64_tr_b16 v[102:103], v248 offset:51200
  v_mfma_f32_16x16x32_bf16 v[64:67], v[136:139], v[144:147], v[64:67]
  ds_read_b64_tr_b16 v[104:105], v249 offset:49152
  v_mfma_f32_16x16x32_bf16 v[68:71], v[136:139], v[148:151], v[68:71]
  ds_read_b64_tr_b16 v[106:107], v249 offset:51200
  v_mfma_f32_16x16x32_bf16 v[72:75], v[136:139], v[152:155], v[72:75]
  ds_read_b64_tr_b16 v[108:109], v250 offset:49152
  v_mfma_f32_16x16x32_bf16 v[76:79], v[136:139], v[156:159], v[76:79]
  ds_read_b64_tr_b16 v[110:111], v250 offset:51200
  v_mfma_f32_16x16x32_bf16 v[80:83], v[140:143], v[144:147], v[80:83]
  v_mfma_f32_16x16x32_bf16 v[84:87], v[140:143], v[148:151], v[84:87]
  v_mfma_f32_16x16x32_bf16 v[88:91], v[140:143], v[152:155], v[88:91]
  v_mfma_f32_16x16x32_bf16 v[92:95], v[140:143], v[156:159], v[92:95]
  s_waitcnt lgkmcnt(9)
  v_mfma_f32_16x16x32_bf16 v[32:35], v[96:99], v[112:115], v[32:35]
  ds_read_b128 v[144:147], v246 offset:17408
  s_waitcnt lgkmcnt(9)
  v_mfma_f32_16x16x32_bf16 v[36:39], v[96:99], v[116:119], v[36:39]
  ds_read_b64_tr_b16 v[128:129], v247 offset:57344
  s_waitcnt lgkmcnt(9)
  v_mfma_f32_16x16x32_bf16 v[40:43], v[96:99], v[120:123], v[40:43]
  ds_read_b64_tr_b16 v[130:131], v247 offset:59392
  s_waitcnt lgkmcnt(9)
  v_mfma_f32_16x16x32_bf16 v[44:47], v[96:99], v[124:127], v[44:47]
  ds_read_b128 v[148:151], v246 offset:19456
  s_waitcnt lgkmcnt(8)
  v_mfma_f32_16x16x32_bf16 v[48:51], v[100:103], v[112:115], v[48:51]
  ds_read_b128 v[152:155], v246 offset:21504
  v_mfma_f32_16x16x32_bf16 v[52:55], v[100:103], v[116:119], v[52:55]
  ds_read_b128 v[156:159], v246 offset:23552
  v_mfma_f32_16x16x32_bf16 v[56:59], v[100:103], v[120:123], v[56:59]
  ds_read_b64_tr_b16 v[132:133], v248 offset:57344
  v_mfma_f32_16x16x32_bf16 v[60:63], v[100:103], v[124:127], v[60:63]
  ds_read_b64_tr_b16 v[134:135], v248 offset:59392
  s_waitcnt lgkmcnt(10)
  v_mfma_f32_16x16x32_bf16 v[64:67], v[104:107], v[112:115], v[64:67]
  ds_read_b64_tr_b16 v[136:137], v249 offset:57344
  v_mfma_f32_16x16x32_bf16 v[68:71], v[104:107], v[116:119], v[68:71]
  ds_read_b64_tr_b16 v[138:139], v249 offset:59392
  v_mfma_f32_16x16x32_bf16 v[72:75], v[104:107], v[120:123], v[72:75]
  ds_read_b64_tr_b16 v[140:141], v250 offset:57344
  v_mfma_f32_16x16x32_bf16 v[76:79], v[104:107], v[124:127], v[76:79]
  ds_read_b64_tr_b16 v[142:143], v250 offset:59392
  s_waitcnt lgkmcnt(12)
  v_mfma_f32_16x16x32_bf16 v[80:83], v[108:111], v[112:115], v[80:83]
  v_mfma_f32_16x16x32_bf16 v[84:87], v[108:111], v[116:119], v[84:87]
  v_mfma_f32_16x16x32_bf16 v[88:91], v[108:111], v[120:123], v[88:91]
  v_mfma_f32_16x16x32_bf16 v[92:95], v[108:111], v[124:127], v[92:95]
  s_waitcnt lgkmcnt(0)
  v_mfma_f32_16x16x32_bf16 v[32:35], v[128:131], v[144:147], v[32:35]
  v_mfma_f32_16x16x32_bf16 v[48:51], v[132:135], v[144:147], v[48:51]
  v_mfma_f32_16x16x32_bf16 v[64:67], v[136:139], v[144:147], v[64:67]
  v_mfma_f32_16x16x32_bf16 v[80:83], v[140:143], v[144:147], v[80:83]
  v_mfma_f32_16x16x32_bf16 v[36:39], v[128:131], v[148:151], v[36:39]
  v_mfma_f32_16x16x32_bf16 v[52:55], v[132:135], v[148:151], v[52:55]
  v_mfma_f32_16x16x32_bf16 v[68:71], v[136:139], v[148:151], v[68:71]
  v_mfma_f32_16x16x32_bf16 v[84:87], v[140:143], v[148:151], v[84:87]
  v_mfma_f32_16x16x32_bf16 v[40:43], v[128:131], v[152:155], v[40:43]
  v_mfma_f32_16x16x32_bf16 v[56:59], v[132:135], v[152:155], v[56:59]
  v_mfma_f32_16x16x32_bf16 v[72:75], v[136:139], v[152:155], v[72:75]
  v_mfma_f32_16x16x32_bf16 v[88:91], v[140:143], v[152:155], v[88:91]
  v_cvt_pk_bf16_f32 v96, v32, v33
  v_cvt_pk_bf16_f32 v97, v34, v35
  v_cvt_pk_bf16_f32 v98, v48, v49
  v_cvt_pk_bf16_f32 v99, v50, v51
  v_cvt_pk_bf16_f32 v100, v64, v65
  v_cvt_pk_bf16_f32 v101, v66, v67
  v_cvt_pk_bf16_f32 v102, v80, v81
  v_cvt_pk_bf16_f32 v103, v82, v83
  s_nop 1
  v_permlane16_swap_b32 v96, v98
  v_permlane16_swap_b32 v97, v99
  v_permlane16_swap_b32 v100, v102
  v_permlane16_swap_b32 v101, v103
  s_nop 0
  ds_write_b128 v24, v[96:99] offset:0
  ds_write_b128 v25, v[100:103] offset:0
  ds_read_b128 v[160:163], v255 offset:0
  ds_read_b128 v[164:167], v255 offset:1024
  v_mfma_f32_16x16x32_bf16 v[44:47], v[128:131], v[156:159], v[44:47]
  v_mfma_f32_16x16x32_bf16 v[60:63], v[132:135], v[156:159], v[60:63]
  v_mfma_f32_16x16x32_bf16 v[76:79], v[136:139], v[156:159], v[76:79]
  v_mfma_f32_16x16x32_bf16 v[92:95], v[140:143], v[156:159], v[92:95]
  v_cvt_pk_bf16_f32 v104, v36, v37
  v_cvt_pk_bf16_f32 v105, v38, v39
  v_cvt_pk_bf16_f32 v106, v52, v53
  v_cvt_pk_bf16_f32 v107, v54, v55
  v_cvt_pk_bf16_f32 v108, v68, v69
  v_cvt_pk_bf16_f32 v109, v70, v71
  v_cvt_pk_bf16_f32 v110, v84, v85
  v_cvt_pk_bf16_f32 v111, v86, v87
  s_nop 1
  v_permlane16_swap_b32 v104, v106
  v_permlane16_swap_b32 v105, v107
  v_permlane16_swap_b32 v108, v110
  v_permlane16_swap_b32 v109, v111
  s_nop 0
  ds_write_b128 v24, v[104:107] offset:2048
  ds_write_b128 v25, v[108:111] offset:2048
  ds_read_b128 v[168:171], v255 offset:2048
  ds_read_b128 v[172:175], v255 offset:3072
  s_add_u32 s30, s63, 0
  s_waitcnt lgkmcnt(5)
  buffer_store_dwordx4 v[160:163], v253, s[4:7], s30 offen sc0 sc1
  s_add_u32 s30, s63, 32768
  s_waitcnt lgkmcnt(4)
  buffer_store_dwordx4 v[164:167], v253, s[4:7], s30 offen sc0 sc1
  v_cvt_pk_bf16_f32 v112, v40, v41
  v_cvt_pk_bf16_f32 v113, v42, v43
  v_cvt_pk_bf16_f32 v114, v56, v57
  v_cvt_pk_bf16_f32 v115, v58, v59
  v_cvt_pk_bf16_f32 v116, v72, v73
  v_cvt_pk_bf16_f32 v117, v74, v75
  v_cvt_pk_bf16_f32 v118, v88, v89
  v_cvt_pk_bf16_f32 v119, v90, v91
  s_nop 1
  v_permlane16_swap_b32 v112, v114
  v_permlane16_swap_b32 v113, v115
  v_permlane16_swap_b32 v116, v118
  v_permlane16_swap_b32 v117, v119
  s_nop 0
  ds_write_b128 v24, v[112:115] offset:4096
  ds_write_b128 v25, v[116:119] offset:4096
  ds_read_b128 v[176:179], v255 offset:4096
  ds_read_b128 v[180:183], v255 offset:5120
  s_add_u32 s30, s63, 65536
  s_waitcnt lgkmcnt(5)
  buffer_store_dwordx4 v[168:171], v253, s[4:7], s30 offen sc0 sc1
  s_add_u32 s30, s63, 98304
  s_waitcnt lgkmcnt(4)
  buffer_store_dwordx4 v[172:175], v253, s[4:7], s30 offen sc0 sc1
  s_nop 3
  v_cvt_pk_bf16_f32 v120, v44, v45
  v_cvt_pk_bf16_f32 v121, v46, v47
  v_cvt_pk_bf16_f32 v122, v60, v61
  v_cvt_pk_bf16_f32 v123, v62, v63
  v_cvt_pk_bf16_f32 v124, v76, v77
  v_cvt_pk_bf16_f32 v125, v78, v79
  v_cvt_pk_bf16_f32 v126, v92, v93
  v_cvt_pk_bf16_f32 v127, v94, v95
  s_nop 1
  v_permlane16_swap_b32 v120, v122
  v_permlane16_swap_b32 v121, v123
  v_permlane16_swap_b32 v124, v126
  v_permlane16_swap_b32 v125, v127
  s_nop 0
  ds_write_b128 v24, v[120:123] offset:6144
  ds_write_b128 v25, v[124:127] offset:6144
  ds_read_b128 v[184:187], v255 offset:6144
  ds_read_b128 v[188:191], v255 offset:7168
  s_add_u32 s30, s63, 131072
  s_waitcnt lgkmcnt(5)
  buffer_store_dwordx4 v[176:179], v253, s[4:7], s30 offen sc0 sc1
  s_add_u32 s30, s63, 163840
  s_waitcnt lgkmcnt(4)
  buffer_store_dwordx4 v[180:183], v253, s[4:7], s30 offen sc0 sc1
  s_add_u32 s30, s63, 196608
  s_waitcnt lgkmcnt(1)
  buffer_store_dwordx4 v[184:187], v253, s[4:7], s30 offen sc0 sc1
  s_add_u32 s30, s63, 229376
  s_waitcnt lgkmcnt(0)
  buffer_store_dwordx4 v[188:191], v253, s[4:7], s30 offen sc0 sc1
  s_endpgm
L_loader:
  v_lshrrev_b32 v26, 3, v0
  v_lshrrev_b32 v27, 4, v0
  v_and_b32 v28, 7, v0
  v_xor_b32 v28, v28, v27
  v_lshlrev_b32 v28, 4, v28
  v_lshl_add_u32 v2, v26, 11, v28
  v_xor_b32 v29, 64, v2
  v_add_u32 v4, 30720, v2
  v_add_u32 v3, 15360, v29
  v_add_u32 v5, 46080, v29
  s_lshl_b32 s30, s28, 18
  s_lshr_b32 s31, s29, 1
  s_lshl_b32 s31, s31, 16
  s_add_u32 s64, s30, s31
  s_lshl_b32 s31, s26, 7
  s_add_u32 s64, s64, s31
  s_waitcnt lgkmcnt(0)
  s_cmp_lg_u32 s27, 0
  s_cselect_b32 s4, s46, s36
  s_cselect_b32 s5, s47, s37
  s_and_b32 s5, s5, 0xffff
  s_mov_b32 s6, 4194304
  s_mov_b32 s7, 0x00020000
  s_add_u32 m0, s66, 0
  s_add_u32 s67, s64, 0
  buffer_load_dwordx4 v2, s[4:7], s67 offen offset:0 lds
  buffer_load_dwordx4 v3, s[4:7], s67 offen offset:1024 lds
  buffer_load_dwordx4 v4, s[4:7], s67 offen offset:2048 lds
  buffer_load_dwordx4 v5, s[4:7], s67 offen offset:3072 lds
  v_lshrrev_b32 v28, 5, v0
  v_lshlrev_b32 v28, 1, v28
  v_and_b32 v29, 3, v0
  v_xor_b32 v28, v28, v29
  v_lshlrev_b32 v28, 4, v28
  v_lshrrev_b32 v29, 2, v0
  v_lshl_add_u32 v10, v29, 6, v28
  s_cmp_lg_u32 s27, 0
  s_cselect_b32 s30, s50, s40
  s_cselect_b32 s31, s51, s41
  s_cselect_b32 s32, s52, s42
  s_cselect_b32 s33, s53, s43
  s_cselect_b32 s8, s48, s38
  s_cselect_b32 s9, s49, s39
  s_cmp_lg_u32 s82, 0
  s_cselect_b32 s12, s32, s30
  s_cselect_b32 s13, s33, s31
  s_and_b32 s13, s13, 0xffff
  s_mov_b32 s14, 65536
  s_mov_b32 s15, 0x00020000
  s_and_b32 s9, s9, 0xffff
  s_mov_b32 s10, 2097152
  s_mov_b32 s11, 0x00020000
  s_lshl_b32 s30, s28, 18
  s_lshl_b32 s31, s26, 16
  s_add_u32 s62, s30, s31
  s_lshl_b32 s31, s26, 15
  s_lshl_b32 s32, s29, 8
  s_add_u32 s63, s31, s32
  s_lshl_b32 s71, s29, 1
  s_and_b32 s34, s28, 1
  s_add_u32 s71, s71, s34
  s_add_u32 m0, s66, 16384
  s_add_u32 s68, s66, 0
  buffer_load_dwordx4 v10, s[12:15], s68 offen offset:0 lds
  buffer_load_dwordx4 v10, s[12:15], s68 offen offset:1024 lds
  buffer_load_dwordx4 v10, s[12:15], s68 offen offset:2048 lds
  buffer_load_dwordx4 v10, s[12:15], s68 offen offset:3072 lds
  s_add_u32 m0, s66, 32768
  s_add_u32 s67, s64, 512
  buffer_load_dwordx4 v2, s[4:7], s67 offen offset:0 lds
  buffer_load_dwordx4 v3, s[4:7], s67 offen offset:1024 lds
  buffer_load_dwordx4 v4, s[4:7], s67 offen offset:2048 lds
  buffer_load_dwordx4 v5, s[4:7], s67 offen offset:3072 lds
  s_add_u32 m0, s66, 49152
  s_add_u32 s68, s66, 16384
  buffer_load_dwordx4 v10, s[12:15], s68 offen offset:0 lds
  buffer_load_dwordx4 v10, s[12:15], s68 offen offset:1024 lds
  buffer_load_dwordx4 v10, s[12:15], s68 offen offset:2048 lds
  buffer_load_dwordx4 v10, s[12:15], s68 offen offset:3072 lds
  s_add_u32 m0, s66, 65536
  s_add_u32 s67, s64, 1024
  buffer_load_dwordx4 v2, s[4:7], s67 offen offset:0 lds
  buffer_load_dwordx4 v3, s[4:7], s67 offen offset:1024 lds
  buffer_load_dwordx4 v4, s[4:7], s67 offen offset:2048 lds
  buffer_load_dwordx4 v5, s[4:7], s67 offen offset:3072 lds
  s_add_u32 m0, s66, 81920
  s_add_u32 s68, s66, 32768
  buffer_load_dwordx4 v10, s[12:15], s68 offen offset:0 lds
  buffer_load_dwordx4 v10, s[12:15], s68 offen offset:1024 lds
  buffer_load_dwordx4 v10, s[12:15], s68 offen offset:2048 lds
  buffer_load_dwordx4 v10, s[12:15], s68 offen offset:3072 lds
  s_add_u32 m0, s66, 98304
  s_add_u32 s67, s64, 1536
  buffer_load_dwordx4 v2, s[4:7], s67 offen offset:0 lds
  buffer_load_dwordx4 v3, s[4:7], s67 offen offset:1024 lds
  buffer_load_dwordx4 v4, s[4:7], s67 offen offset:2048 lds
  buffer_load_dwordx4 v5, s[4:7], s67 offen offset:3072 lds
  s_add_u32 m0, s66, 114688
  s_add_u32 s68, s66, 49152
  buffer_load_dwordx4 v10, s[12:15], s68 offen offset:0 lds
  buffer_load_dwordx4 v10, s[12:15], s68 offen offset:1024 lds
  buffer_load_dwordx4 v10, s[12:15], s68 offen offset:2048 lds
  buffer_load_dwordx4 v10, s[12:15], s68 offen offset:3072 lds
  v_lshrrev_b32 v27, 4, v0
  v_and_b32 v28, 15, v0
  v_lshrrev_b32 v29, 1, v28
  v_or_b32 v30, 0, v27
  v_xor_b32 v29, v29, v30
  v_lshlrev_b32 v29, 5, v29
  v_and_b32 v28, 1, v28
  v_lshlrev_b32 v28, 4, v28
  v_add_u32 v28, v28, v29
  v_lshlrev_b32 v29, 11, v27
  v_add_u32 v28, v28, v29
  v_add_u32 v6, 0, v28
  v_and_b32 v28, 15, v0
  v_lshrrev_b32 v29, 1, v28
  v_or_b32 v30, 0, v27
  v_xor_b32 v29, v29, v30
  v_lshlrev_b32 v29, 5, v29
  v_and_b32 v28, 1, v28
  v_lshlrev_b32 v28, 4, v28
  v_add_u32 v28, v28, v29
  v_lshlrev_b32 v29, 11, v27
  v_add_u32 v28, v28, v29
  v_add_u32 v7, 7168, v28
  v_and_b32 v28, 15, v0
  v_lshrrev_b32 v29, 1, v28
  v_or_b32 v30, 4, v27
  v_xor_b32 v29, v29, v30
  v_lshlrev_b32 v29, 5, v29
  v_and_b32 v28, 1, v28
  v_lshlrev_b32 v28, 4, v28
  v_add_u32 v28, v28, v29
  v_lshlrev_b32 v29, 11, v27
  v_add_u32 v28, v28, v29
  v_add_u32 v8, 14336, v28
  v_and_b32 v28, 15, v0
  v_lshrrev_b32 v29, 1, v28
  v_or_b32 v30, 4, v27
  v_xor_b32 v29, v29, v30
  v_lshlrev_b32 v29, 5, v29
  v_and_b32 v28, 1, v28
  v_lshlrev_b32 v28, 4, v28
  v_add_u32 v28, v28, v29
  v_lshlrev_b32 v29, 11, v27
  v_add_u32 v28, v28, v29
  v_add_u32 v9, 21504, v28
  s_add_u32 s34, s71, 0
  s_and_b32 s34, s34, 15
  s_lshl_b32 s67, s34, 7
  s_add_u32 s67, s67, s62
  s_lshl_b32 s68, s34, 17
  s_add_u32 s68, s68, s63
  s_add_u32 m0, s66, 147456
  s_nop 0
  buffer_load_dwordx4 v6, s[8:11], s68 offen offset:0 lds
  buffer_load_dwordx4 v7, s[8:11], s68 offen offset:1024 lds
  buffer_load_dwordx4 v8, s[8:11], s68 offen offset:2048 lds
  buffer_load_dwordx4 v9, s[8:11], s68 offen offset:3072 lds
  s_add_u32 m0, s66, 131072
  s_nop 0
  buffer_load_dwordx4 v2, s[4:7], s67 offen offset:0 lds
  buffer_load_dwordx4 v3, s[4:7], s67 offen offset:1024 lds
  buffer_load_dwordx4 v4, s[4:7], s67 offen offset:2048 lds
  buffer_load_dwordx4 v5, s[4:7], s67 offen offset:3072 lds
  v_lshrrev_b32 v27, 4, v0
  v_and_b32 v28, 15, v0
  v_lshrrev_b32 v29, 1, v28
  v_or_b32 v30, 0, v27
  v_xor_b32 v29, v29, v30
  v_lshlrev_b32 v29, 5, v29
  v_and_b32 v28, 1, v28
  v_lshlrev_b32 v28, 4, v28
  v_add_u32 v28, v28, v29
  v_lshlrev_b32 v29, 11, v27
  v_add_u32 v28, v28, v29
  v_add_u32 v13, 0, v28
  v_and_b32 v28, 15, v0
  v_lshrrev_b32 v29, 1, v28
  v_or_b32 v30, 4, v27
  v_xor_b32 v29, v29, v30
  v_lshlrev_b32 v29, 5, v29
  v_and_b32 v28, 1, v28
  v_lshlrev_b32 v28, 4, v28
  v_add_u32 v28, v28, v29
  v_lshlrev_b32 v29, 11, v27
  v_add_u32 v28, v28, v29
  v_add_u32 v14, 7168, v28
  v_and_b32 v28, 15, v0
  v_lshrrev_b32 v29, 1, v28
  v_or_b32 v30, 0, v27
  v_xor_b32 v29, v29, v30
  v_lshlrev_b32 v29, 5, v29
  v_and_b32 v28, 1, v28
  v_lshlrev_b32 v28, 4, v28
  v_add_u32 v28, v28, v29
  v_lshlrev_b32 v29, 11, v27
  v_add_u32 v28, v28, v29
  v_add_u32 v15, 14336, v28
  v_and_b32 v28, 15, v0
  v_lshrrev_b32 v29, 1, v28
  v_or_b32 v30, 4, v27
  v_xor_b32 v29, v29, v30
  v_lshlrev_b32 v29, 5, v29
  v_and_b32 v28, 1, v28
  v_lshlrev_b32 v28, 4, v28
  v_add_u32 v28, v28, v29
  v_lshlrev_b32 v29, 11, v27
  v_add_u32 v28, v28, v29
  v_add_u32 v16, 21504, v28
  v_lshlrev_b32 v11, 4, v0
  v_lshlrev_b32 v17, 4, v0
  v_add_u32 v18, 30720, v17
  s_lshl_b32 s30, s27, 18
  s_add_u32 s16, s60, s30
  s_addc_u32 s17, s61, 0
  s_and_b32 s17, s17, 0xffff
  s_mov_b32 s18, 262144
  s_mov_b32 s19, 0x00020000
  s_lshl_b32 s30, s27, 22
  s_add_u32 s30, s30, 1048576
  s_add_u32 s20, s60, s30
  s_addc_u32 s21, s61, 0
  s_and_b32 s21, s21, 0xffff
  s_mov_b32 s22, 4194304
  s_mov_b32 s23, 0x00020000
  s_lshl_b32 s30, s27, 7
  s_add_u32 s24, s58, s30
  s_addc_u32 s25, s59, 0
  s_lshl_b32 s30, s27, 4
  s_add_u32 s30, s30, s28
  s_lshl_b32 s30, s30, 7
  s_add_u32 s30, s30, 10485760
  s_add_u32 s74, s60, s30
  s_addc_u32 s75, s61, 0
  s_lshl_b32 s30, s29, 2
  v_mov_b32 v26, s30
  v_mov_b32 v27, 0
  s_cmp_lg_u32 s26, 0
  s_cbranch_scc1 L_nozero
  s_mov_b64 exec, 1
  global_store_dword v26, v27, s[74:75] sc1
  s_mov_b64 exec, -1
L_nozero:
  s_lshl_b32 s70, s26, 13
  s_waitcnt vmcnt(32)
  s_barrier
  s_waitcnt vmcnt(24)
  s_barrier
  s_add_u32 s34, s71, 1
  s_and_b32 s34, s34, 15
  s_lshl_b32 s67, s34, 7
  s_add_u32 s67, s67, s62
  s_lshl_b32 s68, s34, 17
  s_add_u32 s68, s68, s63
  s_add_u32 m0, s66, 16384
  s_nop 0
  buffer_load_dwordx4 v6, s[8:11], s68 offen offset:0 lds
  buffer_load_dwordx4 v7, s[8:11], s68 offen offset:1024 lds
  buffer_load_dwordx4 v8, s[8:11], s68 offen offset:2048 lds
  buffer_load_dwordx4 v9, s[8:11], s68 offen offset:3072 lds
  s_add_u32 m0, s66, 0
  s_nop 0
  buffer_load_dwordx4 v2, s[4:7], s67 offen offset:0 lds
  buffer_load_dwordx4 v3, s[4:7], s67 offen offset:1024 lds
  buffer_load_dwordx4 v4, s[4:7], s67 offen offset:2048 lds
  buffer_load_dwordx4 v5, s[4:7], s67 offen offset:3072 lds
  s_waitcnt vmcnt(24)
  s_barrier
  s_add_u32 s34, s71, 2
  s_and_b32 s34, s34, 15
  s_lshl_b32 s67, s34, 7
  s_add_u32 s67, s67, s62
  s_lshl_b32 s68, s34, 17
  s_add_u32 s68, s68, s63
  s_add_u32 m0, s66, 49152
  s_nop 0
  buffer_load_dwordx4 v6, s[8:11], s68 offen offset:0 lds
  buffer_load_dwordx4 v7, s[8:11], s68 offen offset:1024 lds
  buffer_load_dwordx4 v8, s[8:11], s68 offen offset:2048 lds
  buffer_load_dwordx4 v9, s[8:11], s68 offen offset:3072 lds
  s_add_u32 m0, s66, 32768
  s_nop 0
  buffer_load_dwordx4 v2, s[4:7], s67 offen offset:0 lds
  buffer_load_dwordx4 v3, s[4:7], s67 offen offset:1024 lds
  buffer_load_dwordx4 v4, s[4:7], s67 offen offset:2048 lds
  buffer_load_dwordx4 v5, s[4:7], s67 offen offset:3072 lds
  s_waitcnt vmcnt(24)
  s_barrier
  s_add_u32 s34, s71, 3
  s_and_b32 s34, s34, 15
  s_lshl_b32 s67, s34, 7
  s_add_u32 s67, s67, s62
  s_lshl_b32 s68, s34, 17
  s_add_u32 s68, s68, s63
  s_add_u32 m0, s66, 81920
  s_nop 0
  buffer_load_dwordx4 v6, s[8:11], s68 offen offset:0 lds
  buffer_load_dwordx4 v7, s[8:11], s68 offen offset:1024 lds
  buffer_load_dwordx4 v8, s[8:11], s68 offen offset:2048 lds
  buffer_load_dwordx4 v9, s[8:11], s68 offen offset:3072 lds
  s_add_u32 m0, s66, 65536
  s_nop 0
  buffer_load_dwordx4 v2, s[4:7], s67 offen offset:0 lds
  buffer_load_dwordx4 v3, s[4:7], s67 offen offset:1024 lds
  buffer_load_dwordx4 v4, s[4:7], s67 offen offset:2048 lds
  buffer_load_dwordx4 v5, s[4:7], s67 offen offset:3072 lds
  s_waitcnt vmcnt(24)
  s_barrier
  s_add_u32 s34, s71, 4
  s_and_b32 s34, s34, 15
  s_lshl_b32 s67, s34, 7
  s_add_u32 s67, s67, s62
  s_lshl_b32 s68, s34, 17
  s_add_u32 s68, s68, s63
  s_add_u32 m0, s66, 114688
  s_nop 0
  buffer_load_dwordx4 v6, s[8:11], s68 offen offset:0 lds
  buffer_load_dwordx4 v7, s[8:11], s68 offen offset:1024 lds
  buffer_load_dwordx4 v8, s[8:11], s68 offen offset:2048 lds
  buffer_load_dwordx4 v9, s[8:11], s68 offen offset:3072 lds
  s_add_u32 m0, s66, 98304
  s_nop 0
  buffer_load_dwordx4 v2, s[4:7], s67 offen offset:0 lds
  buffer_load_dwordx4 v3, s[4:7], s67 offen offset:1024 lds
  buffer_load_dwordx4 v4, s[4:7], s67 offen offset:2048 lds
  buffer_load_dwordx4 v5, s[4:7], s67 offen offset:3072 lds
  s_waitcnt vmcnt(24)
  s_barrier
  s_add_u32 s34, s71, 5
  s_and_b32 s34, s34, 15
  s_lshl_b32 s67, s34, 7
  s_add_u32 s67, s67, s62
  s_lshl_b32 s68, s34, 17
  s_add_u32 s68, s68, s63
  s_add_u32 m0, s66, 147456
  s_nop 0
  buffer_load_dwordx4 v6, s[8:11], s68 offen offset:0 lds
  buffer_load_dwordx4 v7, s[8:11], s68 offen offset:1024 lds
  buffer_load_dwordx4 v8, s[8:11], s68 offen offset:2048 lds
  buffer_load_dwordx4 v9, s[8:11], s68 offen offset:3072 lds
  s_add_u32 m0, s66, 131072
  s_nop 0
  buffer_load_dwordx4 v2, s[4:7], s67 offen offset:0 lds
  buffer_load_dwordx4 v3, s[4:7], s67 offen offset:1024 lds
  buffer_load_dwordx4 v4, s[4:7], s67 offen offset:2048 lds
  buffer_load_dwordx4 v5, s[4:7], s67 offen offset:3072 lds
  s_waitcnt vmcnt(24)
  s_barrier
  s_add_u32 s34, s71, 6
  s_and_b32 s34, s34, 15
  s_lshl_b32 s67, s34, 7
  s_add_u32 s67, s67, s62
  s_lshl_b32 s68, s34, 17
  s_add_u32 s68, s68, s63
  s_add_u32 m0, s66, 16384
  s_nop 0
  buffer_load_dwordx4 v6, s[8:11], s68 offen offset:0 lds
  buffer_load_dwordx4 v7, s[8:11], s68 offen offset:1024 lds
  buffer_load_dwordx4 v8, s[8:11], s68 offen offset:2048 lds
  buffer_load_dwordx4 v9, s[8:11], s68 offen offset:3072 lds
  s_add_u32 m0, s66, 0
  s_nop 0
  buffer_load_dwordx4 v2, s[4:7], s67 offen offset:0 lds
  buffer_load_dwordx4 v3, s[4:7], s67 offen offset:1024 lds
  buffer_load_dwordx4 v4, s[4:7], s67 offen offset:2048 lds
  buffer_load_dwordx4 v5, s[4:7], s67 offen offset:3072 lds
  s_waitcnt vmcnt(24)
  s_barrier
  s_add_u32 s34, s71, 7
  s_and_b32 s34, s34, 15
  s_lshl_b32 s67, s34, 7
  s_add_u32 s67, s67, s62
  s_lshl_b32 s68, s34, 17
  s_add_u32 s68, s68, s63
  s_add_u32 m0, s66, 49152
  s_nop 0
  buffer_load_dwordx4 v6, s[8:11], s68 offen offset:0 lds
  buffer_load_dwordx4 v7, s[8:11], s68 offen offset:1024 lds
  buffer_load_dwordx4 v8, s[8:11], s68 offen offset:2048 lds
  buffer_load_dwordx4 v9, s[8:11], s68 offen offset:3072 lds
  s_add_u32 m0, s66, 32768
  s_nop 0
  buffer_load_dwordx4 v2, s[4:7], s67 offen offset:0 lds
  buffer_load_dwordx4 v3, s[4:7], s67 offen offset:1024 lds
  buffer_load_dwordx4 v4, s[4:7], s67 offen offset:2048 lds
  buffer_load_dwordx4 v5, s[4:7], s67 offen offset:3072 lds
  s_waitcnt vmcnt(24)
  s_barrier
  s_add_u32 s34, s71, 8
  s_and_b32 s34, s34, 15
  s_lshl_b32 s67, s34, 7
  s_add_u32 s67, s67, s62
  s_lshl_b32 s68, s34, 17
  s_add_u32 s68, s68, s63
  s_add_u32 m0, s66, 81920
  s_nop 0
  buffer_load_dwordx4 v6, s[8:11], s68 offen offset:0 lds
  buffer_load_dwordx4 v7, s[8:11], s68 offen offset:1024 lds
  buffer_load_dwordx4 v8, s[8:11], s68 offen offset:2048 lds
  buffer_load_dwordx4 v9, s[8:11], s68 offen offset:3072 lds
  s_add_u32 m0, s66, 65536
  s_nop 0
  buffer_load_dwordx4 v2, s[4:7], s67 offen offset:0 lds
  buffer_load_dwordx4 v3, s[4:7], s67 offen offset:1024 lds
  buffer_load_dwordx4 v4, s[4:7], s67 offen offset:2048 lds
  buffer_load_dwordx4 v5, s[4:7], s67 offen offset:3072 lds
  s_waitcnt vmcnt(24)
  s_barrier
  s_add_u32 s34, s71, 9
  s_and_b32 s34, s34, 15
  s_lshl_b32 s67, s34, 7
  s_add_u32 s67, s67, s62
  s_lshl_b32 s68, s34, 17
  s_add_u32 s68, s68, s63
  s_add_u32 m0, s66, 114688
  s_nop 0
  buffer_load_dwordx4 v6, s[8:11], s68 offen offset:0 lds
  buffer_load_dwordx4 v7, s[8:11], s68 offen offset:1024 lds
  buffer_load_dwordx4 v8, s[8:11], s68 offen offset:2048 lds
  buffer_load_dwordx4 v9, s[8:11], s68 offen offset:3072 lds
  s_add_u32 m0, s66, 98304
  s_nop 0
  buffer_load_dwordx4 v2, s[4:7], s67 offen offset:0 lds
  buffer_load_dwordx4 v3, s[4:7], s67 offen offset:1024 lds
  buffer_load_dwordx4 v4, s[4:7], s67 offen offset:2048 lds
  buffer_load_dwordx4 v5, s[4:7], s67 offen offset:3072 lds
  s_waitcnt vmcnt(24)
  s_barrier
  s_add_u32 s34, s71, 10
  s_and_b32 s34, s34, 15
  s_lshl_b32 s67, s34, 7
  s_add_u32 s67, s67, s62
  s_lshl_b32 s68, s34, 17
  s_add_u32 s68, s68, s63
  s_add_u32 m0, s66, 147456
  s_nop 0
  buffer_load_dwordx4 v6, s[8:11], s68 offen offset:0 lds
  buffer_load_dwordx4 v7, s[8:11], s68 offen offset:1024 lds
  buffer_load_dwordx4 v8, s[8:11], s68 offen offset:2048 lds
  buffer_load_dwordx4 v9, s[8:11], s68 offen offset:3072 lds
  s_add_u32 m0, s66, 131072
  s_nop 0
  buffer_load_dwordx4 v2, s[4:7], s67 offen offset:0 lds
  buffer_load_dwordx4 v3, s[4:7], s67 offen offset:1024 lds
  buffer_load_dwordx4 v4, s[4:7], s67 offen offset:2048 lds
  buffer_load_dwordx4 v5, s[4:7], s67 offen offset:3072 lds
  s_waitcnt vmcnt(24)
  s_barrier
  s_add_u32 s34, s71, 11
  s_and_b32 s34, s34, 15
  s_lshl_b32 s67, s34, 7
  s_add_u32 s67, s67, s62
  s_lshl_b32 s68, s34, 17
  s_add_u32 s68, s68, s63
  s_add_u32 m0, s66, 16384
  s_nop 0
  buffer_load_dwordx4 v6, s[8:11], s68 offen offset:0 lds
  buffer_load_dwordx4 v7, s[8:11], s68 offen offset:1024 lds
  buffer_load_dwordx4 v8, s[8:11], s68 offen offset:2048 lds
  buffer_load_dwordx4 v9, s[8:11], s68 offen offset:3072 lds
  s_add_u32 m0, s66, 0
  s_nop 0
  buffer_load_dwordx4 v2, s[4:7], s67 offen offset:0 lds
  buffer_load_dwordx4 v3, s[4:7], s67 offen offset:1024 lds
  buffer_load_dwordx4 v4, s[4:7], s67 offen offset:2048 lds
  buffer_load_dwordx4 v5, s[4:7], s67 offen offset:3072 lds
  s_waitcnt vmcnt(24)
  s_barrier
  s_add_u32 s34, s71, 12
  s_and_b32 s34, s34, 15
  s_lshl_b32 s67, s34, 7
  s_add_u32 s67, s67, s62
  s_lshl_b32 s68, s34, 17
  s_add_u32 s68, s68, s63
  s_add_u32 m0, s66, 49152
  s_nop 0
  buffer_load_dwordx4 v6, s[8:11], s68 offen offset:0 lds
  buffer_load_dwordx4 v7, s[8:11], s68 offen offset:1024 lds
  buffer_load_dwordx4 v8, s[8:11], s68 offen offset:2048 lds
  buffer_load_dwordx4 v9, s[8:11], s68 offen offset:3072 lds
  s_add_u32 m0, s66, 32768
  s_nop 0
  buffer_load_dwordx4 v2, s[4:7], s67 offen offset:0 lds
  buffer_load_dwordx4 v3, s[4:7], s67 offen offset:1024 lds
  buffer_load_dwordx4 v4, s[4:7], s67 offen offset:2048 lds
  buffer_load_dwordx4 v5, s[4:7], s67 offen offset:3072 lds
  s_waitcnt vmcnt(24)
  s_barrier
  s_add_u32 s34, s71, 13
  s_and_b32 s34, s34, 15
  s_lshl_b32 s67, s34, 7
  s_add_u32 s67, s67, s62
  s_lshl_b32 s68, s34, 17
  s_add_u32 s68, s68, s63
  s_add_u32 m0, s66, 81920
  s_nop 0
  buffer_load_dwordx4 v6, s[8:11], s68 offen offset:0 lds
  buffer_load_dwordx4 v7, s[8:11], s68 offen offset:1024 lds
  buffer_load_dwordx4 v8, s[8:11], s68 offen offset:2048 lds
  buffer_load_dwordx4 v9, s[8:11], s68 offen offset:3072 lds
  s_add_u32 m0, s66, 65536
  s_nop 0
  buffer_load_dwordx4 v2, s[4:7], s67 offen offset:0 lds
  buffer_load_dwordx4 v3, s[4:7], s67 offen offset:1024 lds
  buffer_load_dwordx4 v4, s[4:7], s67 offen offset:2048 lds
  buffer_load_dwordx4 v5, s[4:7], s67 offen offset:3072 lds
  s_waitcnt vmcnt(24)
  s_barrier
  v_mov_b32 v26, 0
  global_load_dword v12, v26, s[24:25] sc1
  s_add_u32 s34, s71, 14
  s_and_b32 s34, s34, 15
  s_lshl_b32 s67, s34, 7
  s_add_u32 s67, s67, s62
  s_lshl_b32 s68, s34, 17
  s_add_u32 s68, s68, s63
  s_add_u32 m0, s66, 114688
  s_nop 0
  buffer_load_dwordx4 v6, s[8:11], s68 offen offset:0 lds
  buffer_load_dwordx4 v7, s[8:11], s68 offen offset:1024 lds
  buffer_load_dwordx4 v8, s[8:11], s68 offen offset:2048 lds
  buffer_load_dwordx4 v9, s[8:11], s68 offen offset:3072 lds
  s_add_u32 m0, s66, 98304
  s_nop 0
  buffer_load_dwordx4 v2, s[4:7], s67 offen offset:0 lds
  buffer_load_dwordx4 v3, s[4:7], s67 offen offset:1024 lds
  buffer_load_dwordx4 v4, s[4:7], s67 offen offset:2048 lds
  buffer_load_dwordx4 v5, s[4:7], s67 offen offset:3072 lds
  s_waitcnt vmcnt(25)
  s_barrier
  s_add_u32 s34, s71, 15
  s_and_b32 s34, s34, 15
  s_lshl_b32 s67, s34, 7
  s_add_u32 s67, s67, s62
  s_lshl_b32 s68, s34, 17
  s_add_u32 s68, s68, s63
  s_add_u32 m0, s66, 147456
  s_nop 0
  buffer_load_dwordx4 v6, s[8:11], s68 offen offset:0 lds
  buffer_load_dwordx4 v7, s[8:11], s68 offen offset:1024 lds
  buffer_load_dwordx4 v8, s[8:11], s68 offen offset:2048 lds
  buffer_load_dwordx4 v9, s[8:11], s68 offen offset:3072 lds
  s_add_u32 m0, s66, 131072
  s_nop 0
  buffer_load_dwordx4 v2, s[4:7], s67 offen offset:0 lds
  buffer_load_dwordx4 v3, s[4:7], s67 offen offset:1024 lds
  buffer_load_dwordx4 v4, s[4:7], s67 offen offset:2048 lds
  buffer_load_dwordx4 v5, s[4:7], s67 offen offset:3072 lds
  s_waitcnt vmcnt(16)
  s_barrier
  v_readfirstlane_b32 s30, v12
  s_nop 3
  s_cmp_ge_u32 s30, 128
  s_cbranch_scc1 L_kvready
  s_mov_b32 s69, 400000
L_spin:
  s_sub_u32 s69, s69, 1
  s_cbranch_scc1 L_kvready
  s_sleep 2
  v_mov_b32 v26, 0
  global_load_dword v12, v26, s[24:25] sc1
  s_waitcnt vmcnt(0)
  v_readfirstlane_b32 s30, v12
  s_nop 3
  s_cmp_lt_u32 s30, 128
  s_cbranch_scc1 L_spin
L_kvready:
  s_add_u32 m0, s70, 0
  s_add_u32 s67, s70, 0
  buffer_load_dwordx4 v11, s[16:19], s67 offen offset:0 sc1 lds
  buffer_load_dwordx4 v11, s[16:19], s67 offen offset:1024 sc1 lds
  buffer_load_dwordx4 v11, s[16:19], s67 offen offset:2048 sc1 lds
  buffer_load_dwordx4 v11, s[16:19], s67 offen offset:3072 sc1 lds
  s_add_u32 m0, s70, 4096
  s_add_u32 s67, s70, 4096
  buffer_load_dwordx4 v11, s[16:19], s67 offen offset:0 sc1 lds
  buffer_load_dwordx4 v11, s[16:19], s67 offen offset:1024 sc1 lds
  buffer_load_dwordx4 v11, s[16:19], s67 offen offset:2048 sc1 lds
  buffer_load_dwordx4 v11, s[16:19], s67 offen offset:3072 sc1 lds
  s_waitcnt vmcnt(25)
  s_barrier
  s_add_u32 m0, s70, 32768
  s_add_u32 s67, s70, 32768
  buffer_load_dwordx4 v11, s[16:19], s67 offen offset:0 sc1 lds
  buffer_load_dwordx4 v11, s[16:19], s67 offen offset:1024 sc1 lds
  buffer_load_dwordx4 v11, s[16:19], s67 offen offset:2048 sc1 lds
  buffer_load_dwordx4 v11, s[16:19], s67 offen offset:3072 sc1 lds
  s_add_u32 m0, s70, 36864
  s_add_u32 s67, s70, 36864
  buffer_load_dwordx4 v11, s[16:19], s67 offen offset:0 sc1 lds
  buffer_load_dwordx4 v11, s[16:19], s67 offen offset:1024 sc1 lds
  buffer_load_dwordx4 v11, s[16:19], s67 offen offset:2048 sc1 lds
  buffer_load_dwordx4 v11, s[16:19], s67 offen offset:3072 sc1 lds
  s_waitcnt vmcnt(24)
  s_barrier
  s_waitcnt vmcnt(16)
  s_barrier
  s_waitcnt vmcnt(8)
  s_barrier
  s_cmp_lg_u32 s27, 0
  s_cselect_b32 s12, s54, s44
  s_cselect_b32 s13, s55, s45
  s_and_b32 s13, s13, 0xffff
  s_mov_b32 s14, 2097152
  s_mov_b32 s15, 0x00020000
  s_lshr_b32 s30, s26, 1
  s_lshl_b32 s30, s30, 17
  s_and_b32 s31, s26, 1
  s_lshl_b32 s31, s31, 15
  s_add_u32 s30, s30, s31
  s_lshl_b32 s31, s29, 8
  s_add_u32 s63, s30, s31
  s_lshl_b32 s30, s28, 3
  s_lshl_b32 s31, s26, 1
  s_add_u32 s30, s30, s31
  s_lshl_b32 s62, s30, 15
  v_lshrrev_b32 v30, 1, v0
  v_lshlrev_b32 v30, 11, v30
  v_and_b32 v31, 1, v0
  v_lshlrev_b32 v31, 7, v31
  v_add_u32 v30, v30, v31
  v_add_u32 v20, 0, v11
  v_add_u32 v21, 1024, v11
  v_add_u32 v22, 30720, v11
  v_add_u32 v23, 31744, v11
  s_lshl_b32 s30, s29, 2
  v_mov_b32 v26, s30
  v_and_b32 v29, 7, v0
  v_lshlrev_b32 v29, 2, v29
  s_waitcnt vmcnt(0)
  s_barrier
  s_add_u32 m0, s70, 131072
  s_add_u32 s67, s70, 65536
  buffer_load_dwordx4 v11, s[16:19], s67 offen offset:0 sc1 lds
  buffer_load_dwordx4 v11, s[16:19], s67 offen offset:1024 sc1 lds
  buffer_load_dwordx4 v11, s[16:19], s67 offen offset:2048 sc1 lds
  buffer_load_dwordx4 v11, s[16:19], s67 offen offset:3072 sc1 lds
  s_add_u32 m0, s70, 135168
  s_add_u32 s67, s70, 69632
  buffer_load_dwordx4 v11, s[16:19], s67 offen offset:0 sc1 lds
  buffer_load_dwordx4 v11, s[16:19], s67 offen offset:1024 sc1 lds
  buffer_load_dwordx4 v11, s[16:19], s67 offen offset:2048 sc1 lds
  buffer_load_dwordx4 v11, s[16:19], s67 offen offset:3072 sc1 lds
  s_add_u32 m0, s66, 65536
  s_add_u32 s68, s29, 0
  s_and_b32 s68, s68, 7
  s_lshl_b32 s68, s68, 18
  s_add_u32 s68, s68, s63
  buffer_load_dwordx4 v13, s[12:15], s68 offen offset:0 lds
  buffer_load_dwordx4 v14, s[12:15], s68 offen offset:1024 lds
  buffer_load_dwordx4 v15, s[12:15], s68 offen offset:2048 lds
  buffer_load_dwordx4 v16, s[12:15], s68 offen offset:3072 lds
  s_add_u32 m0, s66, 81920
  s_add_u32 s68, s29, 1
  s_and_b32 s68, s68, 7
  s_lshl_b32 s68, s68, 18
  s_add_u32 s68, s68, s63
  buffer_load_dwordx4 v13, s[12:15], s68 offen offset:0 lds
  buffer_load_dwordx4 v14, s[12:15], s68 offen offset:1024 lds
  buffer_load_dwordx4 v15, s[12:15], s68 offen offset:2048 lds
  buffer_load_dwordx4 v16, s[12:15], s68 offen offset:3072 lds
  s_waitcnt vmcnt(8)
  s_barrier
  s_add_u32 m0, s70, 0
  s_add_u32 s67, s70, 98304
  buffer_load_dwordx4 v11, s[16:19], s67 offen offset:0 sc1 lds
  buffer_load_dwordx4 v11, s[16:19], s67 offen offset:1024 sc1 lds
  buffer_load_dwordx4 v11, s[16:19], s67 offen offset:2048 sc1 lds
  buffer_load_dwordx4 v11, s[16:19], s67 offen offset:3072 sc1 lds
  s_add_u32 m0, s70, 4096
  s_add_u32 s67, s70, 102400
  buffer_load_dwordx4 v11, s[16:19], s67 offen offset:0 sc1 lds
  buffer_load_dwordx4 v11, s[16:19], s67 offen offset:1024 sc1 lds
  buffer_load_dwordx4 v11, s[16:19], s67 offen offset:2048 sc1 lds
  buffer_load_dwordx4 v11, s[16:19], s67 offen offset:3072 sc1 lds
  s_add_u32 m0, s66, 98304
  s_add_u32 s68, s29, 2
  s_and_b32 s68, s68, 7
  s_lshl_b32 s68, s68, 18
  s_add_u32 s68, s68, s63
  buffer_load_dwordx4 v13, s[12:15], s68 offen offset:0 lds
  buffer_load_dwordx4 v14, s[12:15], s68 offen offset:1024 lds
  buffer_load_dwordx4 v15, s[12:15], s68 offen offset:2048 lds
  buffer_load_dwordx4 v16, s[12:15], s68 offen offset:3072 lds
  s_add_u32 m0, s66, 114688
  s_add_u32 s68, s29, 3
  s_and_b32 s68, s68, 7
  s_lshl_b32 s68, s68, 18
  s_add_u32 s68, s68, s63
  buffer_load_dwordx4 v13, s[12:15], s68 offen offset:0 lds
  buffer_load_dwordx4 v14, s[12:15], s68 offen offset:1024 lds
  buffer_load_dwordx4 v15, s[12:15], s68 offen offset:2048 lds
  buffer_load_dwordx4 v16, s[12:15], s68 offen offset:3072 lds
  s_waitcnt vmcnt(8)
  s_barrier
  s_add_u32 m0, s70, 32768
  s_add_u32 s67, s70, 131072
  buffer_load_dwordx4 v11, s[16:19], s67 offen offset:0 sc1 lds
  buffer_load_dwordx4 v11, s[16:19], s67 offen offset:1024 sc1 lds
  buffer_load_dwordx4 v11, s[16:19], s67 offen offset:2048 sc1 lds
  buffer_load_dwordx4 v11, s[16:19], s67 offen offset:3072 sc1 lds
  s_add_u32 m0, s70, 36864
  s_add_u32 s67, s70, 135168
  buffer_load_dwordx4 v11, s[16:19], s67 offen offset:0 sc1 lds
  buffer_load_dwordx4 v11, s[16:19], s67 offen offset:1024 sc1 lds
  buffer_load_dwordx4 v11, s[16:19], s67 offen offset:2048 sc1 lds
  buffer_load_dwordx4 v11, s[16:19], s67 offen offset:3072 sc1 lds
  s_add_u32 s68, s29, 4
  s_and_b32 s68, s68, 7
  s_lshl_b32 s68, s68, 18
  s_add_u32 s68, s68, s63
  buffer_load_dword v44, v30, s[12:15], s68 offen
  s_add_u32 s68, s29, 5
  s_and_b32 s68, s68, 7
  s_lshl_b32 s68, s68, 18
  s_add_u32 s68, s68, s63
  buffer_load_dword v45, v30, s[12:15], s68 offen
  s_waitcnt vmcnt(2)
  s_barrier
  s_add_u32 m0, s70, 131072
  s_add_u32 s67, s70, 163840
  buffer_load_dwordx4 v11, s[16:19], s67 offen offset:0 sc1 lds
  buffer_load_dwordx4 v11, s[16:19], s67 offen offset:1024 sc1 lds
  buffer_load_dwordx4 v11, s[16:19], s67 offen offset:2048 sc1 lds
  buffer_load_dwordx4 v11, s[16:19], s67 offen offset:3072 sc1 lds
  s_add_u32 m0, s70, 135168
  s_add_u32 s67, s70, 167936
  buffer_load_dwordx4 v11, s[16:19], s67 offen offset:0 sc1 lds
  buffer_load_dwordx4 v11, s[16:19], s67 offen offset:1024 sc1 lds
  buffer_load_dwordx4 v11, s[16:19], s67 offen offset:2048 sc1 lds
  buffer_load_dwordx4 v11, s[16:19], s67 offen offset:3072 sc1 lds
  s_add_u32 s68, s29, 6
  s_and_b32 s68, s68, 7
  s_lshl_b32 s68, s68, 18
  s_add_u32 s68, s68, s63
  buffer_load_dword v46, v30, s[12:15], s68 offen
  s_add_u32 s68, s29, 7
  s_and_b32 s68, s68, 7
  s_lshl_b32 s68, s68, 18
  s_add_u32 s68, s68, s63
  buffer_load_dword v47, v30, s[12:15], s68 offen
  s_waitcnt vmcnt(2)
  s_barrier
  s_add_u32 m0, s70, 0
  s_add_u32 s67, s70, 196608
  buffer_load_dwordx4 v11, s[16:19], s67 offen offset:0 sc1 lds
  buffer_load_dwordx4 v11, s[16:19], s67 offen offset:1024 sc1 lds
  buffer_load_dwordx4 v11, s[16:19], s67 offen offset:2048 sc1 lds
  buffer_load_dwordx4 v11, s[16:19], s67 offen offset:3072 sc1 lds
  s_add_u32 m0, s70, 4096
  s_add_u32 s67, s70, 200704
  buffer_load_dwordx4 v11, s[16:19], s67 offen offset:0 sc1 lds
  buffer_load_dwordx4 v11, s[16:19], s67 offen offset:1024 sc1 lds
  buffer_load_dwordx4 v11, s[16:19], s67 offen offset:2048 sc1 lds
  buffer_load_dwordx4 v11, s[16:19], s67 offen offset:3072 sc1 lds
  s_add_u32 s68, s29, 8
  s_and_b32 s68, s68, 7
  s_lshl_b32 s68, s68, 18
  s_add_u32 s68, s68, s63
  s_add_u32 s68, s68, 65536
  buffer_load_dword v48, v30, s[12:15], s68 offen
  s_add_u32 s68, s29, 9
  s_and_b32 s68, s68, 7
  s_lshl_b32 s68, s68, 18
  s_add_u32 s68, s68, s63
  s_add_u32 s68, s68, 65536
  buffer_load_dword v49, v30, s[12:15], s68 offen
  s_waitcnt vmcnt(2)
  s_barrier
  s_add_u32 m0, s70, 32768
  s_add_u32 s67, s70, 229376
  buffer_load_dwordx4 v11, s[16:19], s67 offen offset:0 sc1 lds
  buffer_load_dwordx4 v11, s[16:19], s67 offen offset:1024 sc1 lds
  buffer_load_dwordx4 v11, s[16:19], s67 offen offset:2048 sc1 lds
  buffer_load_dwordx4 v11, s[16:19], s67 offen offset:3072 sc1 lds
  s_add_u32 m0, s70, 36864
  s_add_u32 s67, s70, 233472
  buffer_load_dwordx4 v11, s[16:19], s67 offen offset:0 sc1 lds
  buffer_load_dwordx4 v11, s[16:19], s67 offen offset:1024 sc1 lds
  buffer_load_dwordx4 v11, s[16:19], s67 offen offset:2048 sc1 lds
  buffer_load_dwordx4 v11, s[16:19], s67 offen offset:3072 sc1 lds
  s_add_u32 s68, s29, 10
  s_and_b32 s68, s68, 7
  s_lshl_b32 s68, s68, 18
  s_add_u32 s68, s68, s63
  s_add_u32 s68, s68, 65536
  buffer_load_dword v50, v30, s[12:15], s68 offen
  s_add_u32 s68, s29, 11
  s_and_b32 s68, s68, 7
  s_lshl_b32 s68, s68, 18
  s_add_u32 s68, s68, s63
  s_add_u32 s68, s68, 65536
  buffer_load_dword v51, v30, s[12:15], s68 offen
  s_waitcnt vmcnt(2)
  s_barrier
  s_add_u32 m0, s70, 131072
  s_add_u32 s67, s70, 196608
  buffer_load_dwordx4 v11, s[16:19], s67 offen offset:0 sc1 lds
  buffer_load_dwordx4 v11, s[16:19], s67 offen offset:1024 sc1 lds
  buffer_load_dwordx4 v11, s[16:19], s67 offen offset:2048 sc1 lds
  buffer_load_dwordx4 v11, s[16:19], s67 offen offset:3072 sc1 lds
  s_add_u32 m0, s70, 135168
  s_add_u32 s67, s70, 200704
  buffer_load_dwordx4 v11, s[16:19], s67 offen offset:0 sc1 lds
  buffer_load_dwordx4 v11, s[16:19], s67 offen offset:1024 sc1 lds
  buffer_load_dwordx4 v11, s[16:19], s67 offen offset:2048 sc1 lds
  buffer_load_dwordx4 v11, s[16:19], s67 offen offset:3072 sc1 lds
  s_add_u32 s68, s29, 12
  s_and_b32 s68, s68, 7
  s_lshl_b32 s68, s68, 18
  s_add_u32 s68, s68, s63
  s_add_u32 s68, s68, 65536
  buffer_load_dword v52, v30, s[12:15], s68 offen
  s_add_u32 s68, s29, 13
  s_and_b32 s68, s68, 7
  s_lshl_b32 s68, s68, 18
  s_add_u32 s68, s68, s63
  s_add_u32 s68, s68, 65536
  buffer_load_dword v53, v30, s[12:15], s68 offen
  s_waitcnt vmcnt(2)
  s_barrier
  s_add_u32 m0, s70, 0
  s_add_u32 s67, s70, 229376
  buffer_load_dwordx4 v11, s[16:19], s67 offen offset:0 sc1 lds
  buffer_load_dwordx4 v11, s[16:19], s67 offen offset:1024 sc1 lds
  buffer_load_dwordx4 v11, s[16:19], s67 offen offset:2048 sc1 lds
  buffer_load_dwordx4 v11, s[16:19], s67 offen offset:3072 sc1 lds
  s_add_u32 m0, s70, 4096
  s_add_u32 s67, s70, 233472
  buffer_load_dwordx4 v11, s[16:19], s67 offen offset:0 sc1 lds
  buffer_load_dwordx4 v11, s[16:19], s67 offen offset:1024 sc1 lds
  buffer_load_dwordx4 v11, s[16:19], s67 offen offset:2048 sc1 lds
  buffer_load_dwordx4 v11, s[16:19], s67 offen offset:3072 sc1 lds
  s_add_u32 s68, s29, 14
  s_and_b32 s68, s68, 7
  s_lshl_b32 s68, s68, 18
  s_add_u32 s68, s68, s63
  s_add_u32 s68, s68, 65536
  buffer_load_dword v54, v30, s[12:15], s68 offen
  s_add_u32 s68, s29, 15
  s_and_b32 s68, s68, 7
  s_lshl_b32 s68, s68, 18
  s_add_u32 s68, s68, s63
  s_add_u32 s68, s68, 65536
  buffer_load_dword v55, v30, s[12:15], s68 offen
  s_waitcnt vmcnt(2)
  s_barrier
  v_mov_b32 v27, 1
  s_cmp_lg_u32 s26, 0
  s_cbranch_scc1 L_nf1
  s_mov_b64 exec, 1
  global_store_dword v26, v27, s[74:75] sc1
  s_mov_b64 exec, -1
L_nf1:
  s_barrier
  s_mov_b32 s69, 400000
L_sp1:
  s_sub_u32 s69, s69, 1
  s_cbranch_scc1 L_sp1_ok
  global_load_dword v12, v29, s[74:75] sc1
  s_waitcnt vmcnt(0)
  v_cmp_le_u32 vcc, 1, v12
  s_nop 4
  s_cmp_eq_u64 vcc, exec
  s_cbranch_scc1 L_sp1_ok
  s_sleep 1
  s_branch L_sp1
L_sp1_ok:
  s_add_u32 m0, s66, 32768
  s_add_u32 s67, s29, 0
  s_and_b32 s67, s67, 7
  s_lshl_b32 s67, s67, 12
  s_add_u32 s67, s67, s62
  buffer_load_dwordx4 v20, s[20:23], s67 offen offset:0 sc1 lds
  buffer_load_dwordx4 v21, s[20:23], s67 offen offset:1024 sc1 lds
  buffer_load_dwordx4 v22, s[20:23], s67 offen offset:2048 sc1 lds
  buffer_load_dwordx4 v23, s[20:23], s67 offen offset:3072 sc1 lds
  s_add_u32 m0, s66, 49152
  s_add_u32 s67, s29, 1
  s_and_b32 s67, s67, 7
  s_lshl_b32 s67, s67, 12
  s_add_u32 s67, s67, s62
  buffer_load_dwordx4 v20, s[20:23], s67 offen offset:0 sc1 lds
  buffer_load_dwordx4 v21, s[20:23], s67 offen offset:1024 sc1 lds
  buffer_load_dwordx4 v22, s[20:23], s67 offen offset:2048 sc1 lds
  buffer_load_dwordx4 v23, s[20:23], s67 offen offset:3072 sc1 lds
  s_add_u32 m0, s66, 131072
  s_add_u32 s67, s29, 2
  s_and_b32 s67, s67, 7
  s_lshl_b32 s67, s67, 12
  s_add_u32 s67, s67, s62
  buffer_load_dwordx4 v20, s[20:23], s67 offen offset:0 sc1 lds
  buffer_load_dwordx4 v21, s[20:23], s67 offen offset:1024 sc1 lds
  buffer_load_dwordx4 v22, s[20:23], s67 offen offset:2048 sc1 lds
  buffer_load_dwordx4 v23, s[20:23], s67 offen offset:3072 sc1 lds
  s_add_u32 m0, s66, 147456
  s_add_u32 s67, s29, 3
  s_and_b32 s67, s67, 7
  s_lshl_b32 s67, s67, 12
  s_add_u32 s67, s67, s62
  buffer_load_dwordx4 v20, s[20:23], s67 offen offset:0 sc1 lds
  buffer_load_dwordx4 v21, s[20:23], s67 offen offset:1024 sc1 lds
  buffer_load_dwordx4 v22, s[20:23], s67 offen offset:2048 sc1 lds
  buffer_load_dwordx4 v23, s[20:23], s67 offen offset:3072 sc1 lds
  s_waitcnt vmcnt(12)
  s_barrier
  s_add_u32 m0, s66, 0
  s_add_u32 s67, s29, 4
  s_and_b32 s67, s67, 7
  s_lshl_b32 s67, s67, 12
  s_add_u32 s67, s67, s62
  buffer_load_dwordx4 v20, s[20:23], s67 offen offset:0 sc1 lds
  buffer_load_dwordx4 v21, s[20:23], s67 offen offset:1024 sc1 lds
  buffer_load_dwordx4 v22, s[20:23], s67 offen offset:2048 sc1 lds
  buffer_load_dwordx4 v23, s[20:23], s67 offen offset:3072 sc1 lds
  s_add_u32 m0, s66, 16384
  s_add_u32 s67, s29, 5
  s_and_b32 s67, s67, 7
  s_lshl_b32 s67, s67, 12
  s_add_u32 s67, s67, s62
  buffer_load_dwordx4 v20, s[20:23], s67 offen offset:0 sc1 lds
  buffer_load_dwordx4 v21, s[20:23], s67 offen offset:1024 sc1 lds
  buffer_load_dwordx4 v22, s[20:23], s67 offen offset:2048 sc1 lds
  buffer_load_dwordx4 v23, s[20:23], s67 offen offset:3072 sc1 lds
  s_waitcnt vmcnt(16)
  s_barrier
  s_add_u32 m0, s66, 65536
  s_add_u32 s68, s29, 4
  s_and_b32 s68, s68, 7
  s_lshl_b32 s68, s68, 18
  s_add_u32 s68, s68, s63
  buffer_load_dwordx4 v13, s[12:15], s68 offen offset:0 lds
  buffer_load_dwordx4 v14, s[12:15], s68 offen offset:1024 lds
  buffer_load_dwordx4 v15, s[12:15], s68 offen offset:2048 lds
  buffer_load_dwordx4 v16, s[12:15], s68 offen offset:3072 lds
  s_add_u32 m0, s66, 32768
  s_add_u32 s67, s29, 6
  s_and_b32 s67, s67, 7
  s_lshl_b32 s67, s67, 12
  s_add_u32 s67, s67, s62
  buffer_load_dwordx4 v20, s[20:23], s67 offen offset:0 sc1 lds
  buffer_load_dwordx4 v21, s[20:23], s67 offen offset:1024 sc1 lds
  buffer_load_dwordx4 v22, s[20:23], s67 offen offset:2048 sc1 lds
  buffer_load_dwordx4 v23, s[20:23], s67 offen offset:3072 sc1 lds
  s_waitcnt vmcnt(20)
  s_barrier
  v_mov_b32 v27, 2
  s_cmp_lg_u32 s26, 0
  s_cbranch_scc1 L_nf2
  s_mov_b64 exec, 1
  global_store_dword v26, v27, s[74:75] sc1
  s_mov_b64 exec, -1
L_nf2:
  s_add_u32 m0, s66, 81920
  s_add_u32 s68, s29, 5
  s_and_b32 s68, s68, 7
  s_lshl_b32 s68, s68, 18
  s_add_u32 s68, s68, s63
  buffer_load_dwordx4 v13, s[12:15], s68 offen offset:0 lds
  buffer_load_dwordx4 v14, s[12:15], s68 offen offset:1024 lds
  buffer_load_dwordx4 v15, s[12:15], s68 offen offset:2048 lds
  buffer_load_dwordx4 v16, s[12:15], s68 offen offset:3072 lds
  s_add_u32 m0, s66, 49152
  s_add_u32 s67, s29, 7
  s_and_b32 s67, s67, 7
  s_lshl_b32 s67, s67, 12
  s_add_u32 s67, s67, s62
  buffer_load_dwordx4 v20, s[20:23], s67 offen offset:0 sc1 lds
  buffer_load_dwordx4 v21, s[20:23], s67 offen offset:1024 sc1 lds
  buffer_load_dwordx4 v22, s[20:23], s67 offen offset:2048 sc1 lds
  buffer_load_dwordx4 v23, s[20:23], s67 offen offset:3072 sc1 lds
  s_waitcnt vmcnt(24)
  s_barrier
  s_add_u32 m0, s66, 98304
  s_add_u32 s68, s29, 6
  s_and_b32 s68, s68, 7
  s_lshl_b32 s68, s68, 18
  s_add_u32 s68, s68, s63
  buffer_load_dwordx4 v13, s[12:15], s68 offen offset:0 lds
  buffer_load_dwordx4 v14, s[12:15], s68 offen offset:1024 lds
  buffer_load_dwordx4 v15, s[12:15], s68 offen offset:2048 lds
  buffer_load_dwordx4 v16, s[12:15], s68 offen offset:3072 lds
  s_add_u32 m0, s66, 131072
  s_add_u32 s67, s29, 8
  s_and_b32 s67, s67, 7
  s_lshl_b32 s67, s67, 12
  s_add_u32 s67, s67, s62
  s_add_u32 s67, s67, 1024
  buffer_load_dwordx4 v20, s[20:23], s67 offen offset:0 sc1 lds
  buffer_load_dwordx4 v21, s[20:23], s67 offen offset:1024 sc1 lds
  buffer_load_dwordx4 v22, s[20:23], s67 offen offset:2048 sc1 lds
  buffer_load_dwordx4 v23, s[20:23], s67 offen offset:3072 sc1 lds
  s_waitcnt vmcnt(20)
  s_barrier
  s_add_u32 m0, s66, 114688
  s_add_u32 s68, s29, 7
  s_and_b32 s68, s68, 7
  s_lshl_b32 s68, s68, 18
  s_add_u32 s68, s68, s63
  buffer_load_dwordx4 v13, s[12:15], s68 offen offset:0 lds
  buffer_load_dwordx4 v14, s[12:15], s68 offen offset:1024 lds
  buffer_load_dwordx4 v15, s[12:15], s68 offen offset:2048 lds
  buffer_load_dwordx4 v16, s[12:15], s68 offen offset:3072 lds
  s_waitcnt vmcnt(16)
  s_barrier
  s_add_u32 m0, s66, 65536
  s_add_u32 s68, s29, 8
  s_and_b32 s68, s68, 7
  s_lshl_b32 s68, s68, 18
  s_add_u32 s68, s68, s63
  s_add_u32 s68, s68, 65536
  buffer_load_dwordx4 v13, s[12:15], s68 offen offset:0 lds
  buffer_load_dwordx4 v14, s[12:15], s68 offen offset:1024 lds
  buffer_load_dwordx4 v15, s[12:15], s68 offen offset:2048 lds
  buffer_load_dwordx4 v16, s[12:15], s68 offen offset:3072 lds
  s_waitcnt vmcnt(12)
  s_barrier
  s_add_u32 m0, s66, 81920
  s_add_u32 s68, s29, 9
  s_and_b32 s68, s68, 7
  s_lshl_b32 s68, s68, 18
  s_add_u32 s68, s68, s63
  s_add_u32 s68, s68, 65536
  buffer_load_dwordx4 v13, s[12:15], s68 offen offset:0 lds
  buffer_load_dwordx4 v14, s[12:15], s68 offen offset:1024 lds
  buffer_load_dwordx4 v15, s[12:15], s68 offen offset:2048 lds
  buffer_load_dwordx4 v16, s[12:15], s68 offen offset:3072 lds
  s_mov_b32 s69, 400000
L_sp2:
  s_sub_u32 s69, s69, 1
  s_cbranch_scc1 L_sp2_ok
  global_load_dword v12, v29, s[74:75] sc1
  s_waitcnt vmcnt(0)
  v_cmp_le_u32 vcc, 2, v12
  s_nop 4
  s_cmp_eq_u64 vcc, exec
  s_cbranch_scc1 L_sp2_ok
  s_sleep 1
  s_branch L_sp2
L_sp2_ok:
  s_add_u32 m0, s66, 147456
  s_add_u32 s67, s29, 9
  s_and_b32 s67, s67, 7
  s_lshl_b32 s67, s67, 12
  s_add_u32 s67, s67, s62
  s_add_u32 s67, s67, 1024
  buffer_load_dwordx4 v20, s[20:23], s67 offen offset:0 sc1 lds
  buffer_load_dwordx4 v21, s[20:23], s67 offen offset:1024 sc1 lds
  buffer_load_dwordx4 v22, s[20:23], s67 offen offset:2048 sc1 lds
  buffer_load_dwordx4 v23, s[20:23], s67 offen offset:3072 sc1 lds
  s_add_u32 m0, s66, 0
  s_add_u32 s67, s29, 10
  s_and_b32 s67, s67, 7
  s_lshl_b32 s67, s67, 12
  s_add_u32 s67, s67, s62
  s_add_u32 s67, s67, 1024
  buffer_load_dwordx4 v20, s[20:23], s67 offen offset:0 sc1 lds
  buffer_load_dwordx4 v21, s[20:23], s67 offen offset:1024 sc1 lds
  buffer_load_dwordx4 v22, s[20:23], s67 offen offset:2048 sc1 lds
  buffer_load_dwordx4 v23, s[20:23], s67 offen offset:3072 sc1 lds
  s_add_u32 m0, s66, 16384
  s_add_u32 s67, s29, 11
  s_and_b32 s67, s67, 7
  s_lshl_b32 s67, s67, 12
  s_add_u32 s67, s67, s62
  s_add_u32 s67, s67, 1024
  buffer_load_dwordx4 v20, s[20:23], s67 offen offset:0 sc1 lds
  buffer_load_dwordx4 v21, s[20:23], s67 offen offset:1024 sc1 lds
  buffer_load_dwordx4 v22, s[20:23], s67 offen offset:2048 sc1 lds
  buffer_load_dwordx4 v23, s[20:23], s67 offen offset:3072 sc1 lds
  s_waitcnt vmcnt(13)
  s_barrier
  s_add_u32 m0, s66, 98304
  s_add_u32 s68, s29, 10
  s_and_b32 s68, s68, 7
  s_lshl_b32 s68, s68, 18
  s_add_u32 s68, s68, s63
  s_add_u32 s68, s68, 65536
  buffer_load_dwordx4 v13, s[12:15], s68 offen offset:0 lds
  buffer_load_dwordx4 v14, s[12:15], s68 offen offset:1024 lds
  buffer_load_dwordx4 v15, s[12:15], s68 offen offset:2048 lds
  buffer_load_dwordx4 v16, s[12:15], s68 offen offset:3072 lds
  s_add_u32 m0, s66, 32768
  s_add_u32 s67, s29, 12
  s_and_b32 s67, s67, 7
  s_lshl_b32 s67, s67, 12
  s_add_u32 s67, s67, s62
  s_add_u32 s67, s67, 1024
  buffer_load_dwordx4 v20, s[20:23], s67 offen offset:0 sc1 lds
  buffer_load_dwordx4 v21, s[20:23], s67 offen offset:1024 sc1 lds
  buffer_load_dwordx4 v22, s[20:23], s67 offen offset:2048 sc1 lds
  buffer_load_dwordx4 v23, s[20:23], s67 offen offset:3072 sc1 lds
  s_waitcnt vmcnt(20)
  s_barrier
  s_add_u32 m0, s66, 114688
  s_add_u32 s68, s29, 11
  s_and_b32 s68, s68, 7
  s_lshl_b32 s68, s68, 18
  s_add_u32 s68, s68, s63
  s_add_u32 s68, s68, 65536
  buffer_load_dwordx4 v13, s[12:15], s68 offen offset:0 lds
  buffer_load_dwordx4 v14, s[12:15], s68 offen offset:1024 lds
  buffer_load_dwordx4 v15, s[12:15], s68 offen offset:2048 lds
  buffer_load_dwordx4 v16, s[12:15], s68 offen offset:3072 lds
  s_add_u32 m0, s66, 49152
  s_add_u32 s67, s29, 13
  s_and_b32 s67, s67, 7
  s_lshl_b32 s67, s67, 12
  s_add_u32 s67, s67, s62
  s_add_u32 s67, s67, 1024
  buffer_load_dwordx4 v20, s[20:23], s67 offen offset:0 sc1 lds
  buffer_load_dwordx4 v21, s[20:23], s67 offen offset:1024 sc1 lds
  buffer_load_dwordx4 v22, s[20:23], s67 offen offset:2048 sc1 lds
  buffer_load_dwordx4 v23, s[20:23], s67 offen offset:3072 sc1 lds
  s_waitcnt vmcnt(24)
  s_barrier
  s_add_u32 m0, s66, 65536
  s_add_u32 s68, s29, 12
  s_and_b32 s68, s68, 7
  s_lshl_b32 s68, s68, 18
  s_add_u32 s68, s68, s63
  s_add_u32 s68, s68, 65536
  buffer_load_dwordx4 v13, s[12:15], s68 offen offset:0 lds
  buffer_load_dwordx4 v14, s[12:15], s68 offen offset:1024 lds
  buffer_load_dwordx4 v15, s[12:15], s68 offen offset:2048 lds
  buffer_load_dwordx4 v16, s[12:15], s68 offen offset:3072 lds
  s_add_u32 m0, s66, 131072
  s_add_u32 s67, s29, 14
  s_and_b32 s67, s67, 7
  s_lshl_b32 s67, s67, 12
  s_add_u32 s67, s67, s62
  s_add_u32 s67, s67, 1024
  buffer_load_dwordx4 v20, s[20:23], s67 offen offset:0 sc1 lds
  buffer_load_dwordx4 v21, s[20:23], s67 offen offset:1024 sc1 lds
  buffer_load_dwordx4 v22, s[20:23], s67 offen offset:2048 sc1 lds
  buffer_load_dwordx4 v23, s[20:23], s67 offen offset:3072 sc1 lds
  s_waitcnt vmcnt(20)
  s_barrier
  s_add_u32 m0, s66, 81920
  s_add_u32 s68, s29, 13
  s_and_b32 s68, s68, 7
  s_lshl_b32 s68, s68, 18
  s_add_u32 s68, s68, s63
  s_add_u32 s68, s68, 65536
  buffer_load_dwordx4 v13, s[12:15], s68 offen offset:0 lds
  buffer_load_dwordx4 v14, s[12:15], s68 offen offset:1024 lds
  buffer_load_dwordx4 v15, s[12:15], s68 offen offset:2048 lds
  buffer_load_dwordx4 v16, s[12:15], s68 offen offset:3072 lds
  s_add_u32 m0, s66, 147456
  s_add_u32 s67, s29, 15
  s_and_b32 s67, s67, 7
  s_lshl_b32 s67, s67, 12
  s_add_u32 s67, s67, s62
  s_add_u32 s67, s67, 1024
  buffer_load_dwordx4 v20, s[20:23], s67 offen offset:0 sc1 lds
  buffer_load_dwordx4 v21, s[20:23], s67 offen offset:1024 sc1 lds
  buffer_load_dwordx4 v22, s[20:23], s67 offen offset:2048 sc1 lds
  buffer_load_dwordx4 v23, s[20:23], s67 offen offset:3072 sc1 lds
  s_waitcnt vmcnt(20)
  s_barrier
  s_add_u32 m0, s66, 98304
  s_add_u32 s68, s29, 14
  s_and_b32 s68, s68, 7
  s_lshl_b32 s68, s68, 18
  s_add_u32 s68, s68, s63
  s_add_u32 s68, s68, 65536
  buffer_load_dwordx4 v13, s[12:15], s68 offen offset:0 lds
  buffer_load_dwordx4 v14, s[12:15], s68 offen offset:1024 lds
  buffer_load_dwordx4 v15, s[12:15], s68 offen offset:2048 lds
  buffer_load_dwordx4 v16, s[12:15], s68 offen offset:3072 lds
  s_waitcnt vmcnt(16)
  s_barrier
  s_add_u32 m0, s66, 114688
  s_add_u32 s68, s29, 15
  s_and_b32 s68, s68, 7
  s_lshl_b32 s68, s68, 18
  s_add_u32 s68, s68, s63
  s_add_u32 s68, s68, 65536
  buffer_load_dwordx4 v13, s[12:15], s68 offen offset:0 lds
  buffer_load_dwordx4 v14, s[12:15], s68 offen offset:1024 lds
  buffer_load_dwordx4 v15, s[12:15], s68 offen offset:2048 lds
  buffer_load_dwordx4 v16, s[12:15], s68 offen offset:3072 lds
  s_waitcnt vmcnt(12)
  s_barrier
  s_waitcnt vmcnt(4)
  s_barrier
  s_waitcnt vmcnt(0)
  s_barrier
L_end:
  s_endpgm
L_code_end:
  s_endpgm
.section .rodata,"a"
.p2align 6
.amdhsa_kernel concat_heads__grouped_kv_mqa__grouped_kv_mqa__prompt_kernel
  .amdhsa_next_free_vgpr 256
  .amdhsa_next_free_sgpr 102
  .amdhsa_accum_offset 256
  .amdhsa_group_segment_fixed_size 0
  .amdhsa_kernarg_size 104
  .amdhsa_user_sgpr_count 2
  .amdhsa_user_sgpr_kernarg_segment_ptr 1
  .amdhsa_system_sgpr_workgroup_id_x 1
.end_amdhsa_kernel
```
